```python
import torch

def _softmax(x, axis=-1):
    return torch.softmax(x, dim=axis)
def _gelu(x):
    return torch.nn.functional.gelu(x, approximate="tanh")
def _silu(x):
    return torch.nn.functional.silu(x)
def _sigmoid(x):
    return torch.sigmoid(x)
def _layernorm(x, axis=-1, eps=1e-5):
    m = x.mean(dim=axis, keepdim=True)
    v = x.var(dim=axis, keepdim=True, unbiased=False)
    return (x - m) / torch.sqrt(v + eps)
def _scatter_add(tgt, idx, src, axis=0):
    return tgt.clone().index_add_(axis, idx, src)
def _segment_sum(src, seg, n):
    out = torch.zeros((n,) + src.shape[1:], dtype=src.dtype)
    return out.index_add_(0, seg, src)
def _pad(x, pw):
    flat = tuple(v for pair in reversed(pw) for v in pair)
    return torch.nn.functional.pad(x, flat)

kernel_name = 'gated_mix__linear_kernel_hedgehog__glu_gated_glu__prompt'

def setup_inputs():

    _w = (lambda a: (lambda t: t.to(torch.bfloat16) if t.is_floating_point() else t)(torch.as_tensor(a)))
    def _A_setup():
        B, S, D, H = 1, 2048, 512, 32
        Dh = D // H
        return {
            "x": _w((lambda *s: torch.randn(*s, dtype=torch.bfloat16) * 0.05)(B, S, D)),
            "wqkv": _w((lambda *s: torch.randn(*s, dtype=torch.bfloat16) * 0.8)(D, 3 * D)),
            "w_phi": _w((lambda *s: torch.randn(*s, dtype=torch.bfloat16) * 0.8)(H, Dh, Dh) * (Dh ** -0.5)),
            "wo": _w((lambda *s: torch.randn(*s, dtype=torch.bfloat16) * 0.1)(D, D)),
        }
    _A_in = _A_setup()

    def _B_setup():
        B, S, D, F = 1, 2048, 512, 1792
        return {
            "x": _w((lambda *s: torch.randn(*s, dtype=torch.bfloat16) * 0.05)(B, S, D)),
            "w_gate": _w((lambda *s: torch.randn(*s, dtype=torch.bfloat16) * 0.4)(D, F)),
            "w_up": _w((lambda *s: torch.randn(*s, dtype=torch.bfloat16) * 0.05)(D, F)),
            "w_down": _w((lambda *s: torch.randn(*s, dtype=torch.bfloat16) * 0.05)(F, D)),
        }
    _B_in = _B_setup()

    return {
        "A_x": _A_in["x"],
        "A_wqkv": _A_in["wqkv"],
        "A_w_phi": _A_in["w_phi"],
        "A_wo": _A_in["wo"],
        "B_x": _B_in["x"],
        "B_w_gate": _B_in["w_gate"],
        "B_w_up": _B_in["w_up"],
        "B_w_down": _B_in["w_down"],
        "gate_w": _w((lambda *s: torch.randn(*s, dtype=torch.bfloat16) * 0.05)(512) * 16.0),
    }

def reference(A_x, A_wqkv, A_w_phi, A_wo, B_x, B_w_gate, B_w_up, B_w_down, gate_w):
    def _A_ref(x, wqkv, w_phi, wo):
        B, S, D = x.shape
        H = 32; Dh = D // H
        qkv = (lambda x, *d: x.permute(*d))((x @ wqkv).reshape(B, S, 3, H, Dh), 2, 0, 3, 1, 4)
        q, k, v = qkv[0], qkv[1], qkv[2]
        pq = torch.einsum("bhsd,hdf->bhsf", q, w_phi)
        pk = torch.einsum("bhsd,hdf->bhsf", k, w_phi)
        phi_q = torch.concatenate([_softmax(pq, axis=-1), _softmax(-pq, axis=-1)], axis=-1)
        phi_k = torch.concatenate([_softmax(pk, axis=-1), _softmax(-pk, axis=-1)], axis=-1)
        kv = torch.einsum("bhsf,bhsd->bhfd", phi_k, v)
        z  = torch.einsum("bhsf->bhf", phi_k)
        num = torch.einsum("bhqf,bhfd->bhqd", phi_q, kv)
        den = torch.einsum("bhqf,bhf->bhq", phi_q, z)[..., None] + 1e-6
        o = num / den
        return (lambda x, *d: x.permute(*d))(o, 0, 2, 1, 3).reshape(B, S, D) @ wo

    def _B_ref(x, w_gate, w_up, w_down):
        g = torch.einsum("bsd,df->bsf", x, w_gate)
        u = torch.einsum("bsd,df->bsf", x, w_up)
        h = _sigmoid(g) * u
        return torch.einsum("bsf,fd->bsd", h, w_down)

    x = A_x
    g = _sigmoid((x * gate_w).sum(-1, keepdims=True))
    a = _A_ref(x, A_wqkv, A_w_phi, A_wo)
    b = _B_ref(x, B_w_gate, B_w_up, B_w_down)
    return g * a + (1 - g) * b
```

```asm
; @launch grid=(256,1,1) block=(256,1,1) lds=163840
.amdgcn_target "amdgcn-amd-amdhsa--gfx950"
.text
.globl gated_mix__linear_kernel_hedgehog__glu_gated_glu__prompt_kernel
.p2align 8
.type gated_mix__linear_kernel_hedgehog__glu_gated_glu__prompt_kernel,@function
gated_mix__linear_kernel_hedgehog__glu_gated_glu__prompt_kernel:
    s_cmp_ge_u32 s2, 256
    s_cbranch_scc1 L_exit
    s_load_dwordx8 s[4:11], s[0:1], 0
    s_load_dwordx8 s[12:19], s[0:1], 40
    s_load_dwordx4 s[20:23], s[0:1], 72
    s_load_dwordx2 s[24:25], s[0:1], 88
    s_getpc_b64 s[72:73]
L_pc:
    s_and_b32 s3, s2, 7
    s_bitcmp1_b32 240, s3
    s_cselect_b32 s74, L_typeB-L_pc, 0
    s_mov_b32 s75, L_endA-L_pc-64
    s_cselect_b32 s75, L_endB-L_pc-64, s75
    s_bfe_u32 s3, s2, 0x20003
    s_lshl_b32 s3, s3, 13
    s_add_u32 s74, s74, s3
    v_lshl_add_u32 v18, v0, 5, s74
    v_min_u32 v18, s75, v18
    global_load_dword v18, v18, s[72:73]
    v_lshrrev_b32 v1, 6, v0
    v_and_b32 v0, 63, v0
    v_readfirstlane_b32 s88, v1
    s_and_b32 s100, s2, 7
    s_lshr_b32 s101, s2, 3
    s_and_b32 s95, s101, 7
    s_lshr_b32 s99, s101, 3
    s_lshl_b32 s94, s100, 2
    s_add_u32 s94, s94, s99
    s_lshl_b32 s100, s100, 2
    s_lshr_b32 s100, 0x76543210, s100
    s_and_b32 s100, s100, 7
    s_and_b32 s91, s100, 1
    s_lshl_b32 s91, s91, 3
    s_add_u32 s91, s91, s95
    s_and_b32 s3, s99, 1
    s_and_b32 s93, s100, 6
    s_lshl_b32 s93, s93, 1
    s_add_u32 s93, s93, s99
    s_lshr_b32 s99, s93, 3
    s_and_b32 s92, s93, 7
    s_and_b32 s3, s92, 1
    s_lshr_b32 s89, s88, 1
    s_and_b32 s90, s88, 1
    s_lshl_b32 s96, s88, 12
    s_mov_b32 s97, 0x3fb8aa3b
    s_mov_b32 s98, 0xbfb8aa3b
    v_lshlrev_b32 v11, 4, v0
    v_lshrrev_b32 v64, 3, v0
    v_and_b32 v65, 7, v0
    v_lshrrev_b32 v66, 4, v0
    v_xor_b32 v66, v66, v65
    v_lshlrev_b32 v66, 4, v66
    v_lshl_add_u32 v66, v64, 10, v66
    s_lshl_b32 s100, s88, 15
    v_add_u32 v224, s100, v66
    v_xor_b32 v225, 64, v224
    v_add_u32 v225, 7168, v225
    v_add_u32 v226, 14336, v224
    v_add_u32 v227, 14336, v225
    v_bfe_u32 v66, v0, 4, 1
    v_lshlrev_b32 v66, 1, v66
    v_xor_b32 v66, v66, v65
    v_lshlrev_b32 v66, 4, v66
    s_lshl_b32 s100, s88, 4
    v_add_u32 v67, s100, v64
    v_mul_u32_u24 v1, 3072, v67
    v_mul_u32_u24 v3, 3584, v67
    v_add_u32 v1, v1, v66
    v_add_u32 v3, v3, v66
    v_xor_b32 v2, 64, v1
    v_xor_b32 v4, 64, v3
    v_add_u32 v2, 23552, v2
    v_add_u32 v4, 27648, v4
    s_mov_b32 s87, s99
    s_add_u32 s79, s91, s92
    s_mul_i32 s84, s92, s87
    s_cmp_eq_u32 s87, 0
    s_cselect_b32 s84, 1, 1
    s_cselect_b32 s85, 6, 6
    s_lshl_b32 s79, s79, s84
    s_and_b32 s79, s79, s85
    s_lshl_b32 s84, s92, 7
    s_add_u32 s84, s84, 1024
    s_add_u32 s85, s84, 194560
    s_mul_i32 s100, s92, 448
    s_mul_i32 s101, s3, 192
    s_add_u32 s100, s100, s101
    s_sub_u32 s101, s100, 2048
    s_cmp_eq_u32 s87, 0
    s_cselect_b32 s84, s84, s100
    s_cselect_b32 s85, s85, s101
    s_cselect_b32 s34, 1572864, 0
    s_cselect_b32 s101, 0, 1835008
    s_cselect_b32 s86, 196608, 0
    s_cselect_b32 s100, 0, 229376
    s_cselect_b64 vcc, -1, 0
    s_add_u32 s34, s34, s101
    s_sub_u32 s38, s34, s85
    s_sub_u32 s34, s34, s84
    s_add_u32 s100, s100, s86
    s_mul_i32 s101, s100, s79
    s_ashr_i32 s86, s85, 31
    s_mov_b32 s35, 0x20000
    s_mov_b32 s39, 0x20000
    s_mov_b32 s30, 131072
    s_mov_b32 s31, 0x20000
    v_cndmask_b32 v228, v3, v1, vcc
    v_cndmask_b32 v229, v4, v2, vcc
    s_lshl_b32 s99, s79, 7
    s_lshl_b32 s100, s91, 17
    s_waitcnt lgkmcnt(0)
    s_add_u32 s28, s4, s100
    s_addc_u32 s29, s5, 0
    s_add_u32 m0, s96, 81920
    s_cmp_eq_u32 s87, 0
    buffer_load_dwordx4 v224, s[28:31], s99 offen lds
    s_cselect_b32 s32, s6, s12
    s_cselect_b32 s33, s7, s13
    buffer_load_dwordx4 v225, s[28:31], s99 offen offset:1024 lds
    s_cselect_b32 s36, s6, s14
    s_cselect_b32 s37, s7, s15
    buffer_load_dwordx4 v226, s[28:31], s99 offen offset:2048 lds
    s_add_u32 s32, s32, s84
    s_addc_u32 s33, s33, 0
    buffer_load_dwordx4 v227, s[28:31], s99 offen offset:3072 lds
    s_add_u32 s36, s36, s85
    s_addc_u32 s37, s37, s86
    s_add_u32 m0, s96, 0
    s_add_u32 s99, s99, 128
    s_and_b32 s99, s99, 1023
    buffer_load_dwordx4 v228, s[32:35], s101 offen lds
    buffer_load_dwordx4 v229, s[32:35], s101 offen offset:1024 lds
    buffer_load_dwordx4 v228, s[36:39], s101 offen offset:2048 lds
    buffer_load_dwordx4 v229, s[36:39], s101 offen offset:3072 lds
    s_add_u32 m0, s96, 98304
    s_mov_b32 s26, s18
    buffer_load_dwordx4 v224, s[28:31], s99 offen lds
    buffer_load_dwordx4 v225, s[28:31], s99 offen offset:1024 lds
    buffer_load_dwordx4 v226, s[28:31], s99 offen offset:2048 lds
    buffer_load_dwordx4 v227, s[28:31], s99 offen offset:3072 lds
    s_mov_b32 s27, s19
    s_mov_b32 s5, s79
    s_mov_b32 s99, s87
    s_add_u32 s72, s24, 0
    s_addc_u32 s73, s25, 0
    s_mov_b32 s74, 16777216
    s_mov_b32 s75, 0x20000
    s_add_u32 s80, s22, 0
    s_addc_u32 s81, s23, 0
    s_mov_b32 s82, 256
    s_mov_b32 s83, 0x20000
    s_add_u32 s84, s8, 0
    s_addc_u32 s85, s9, 0
    s_mov_b32 s86, 16384
    s_mov_b32 s87, 0x20000
    s_cmp_eq_u32 s99, 0
    s_cbranch_scc0 L_typeB

    s_lshl_b32 s100, s92, 7
    s_add_u32 s100, s100, 2048
    s_add_u32 s40, s6, s100
    s_addc_u32 s41, s7, 0
    s_mov_b32 s42, 1572864
    s_mov_b32 s43, 0x20000
    s_sub_u32 s42, s42, s100
    s_add_u32 s44, s40, 194560
    s_addc_u32 s45, s41, 0
    s_mov_b32 s46, 0
    s_mov_b32 s47, 0x20000
    s_sub_u32 s46, s42, 194560
    v_and_b32 v73, 3, v0
    s_lshl_b32 s100, s91, 2
    s_add_u32 s100, s100, s88
    v_lshl_add_u32 v73, v73, 6, s100
    v_mul_u32_u24 v20, 3072, v73
    v_mul_u32_u24 v22, 3584, v73
    s_lshl_b32 s101, s93, 2
    s_add_u32 s101, s101, s88
    s_lshl_b32 s101, s101, 11
    v_and_b32 v73, 1, v0
    v_bfe_u32 v74, v0, 1, 2
    v_lshlrev_b32 v162, 7, v74
    v_lshl_add_u32 v162, v73, 10, v162
    v_add_u32 v162, s101, v162
    v_min_u32 v73, 6, v0
    s_lshl_b32 s100, s94, 2
    s_add_u32 s100, s100, s88
    s_mul_i32 s100, s100, 7
    v_add_lshl_u32 v19, v73, s100, 10
    v_mov_b32 v172, 0
    v_mov_b32 v173, 0
    v_mov_b32 v174, 0
    v_mov_b32 v175, 0
    s_or_b32 s101, s93, s88
    s_cmp_eq_u32 s101, 0
    s_cselect_b32 s101, 16, 0
    v_lshlrev_b32 v68, 7, v0
    v_mov_b32 v69, 1073741824
    v_cmp_gt_u32 vcc, s101, v0
    s_nop 1
    v_cndmask_b32 v68, v69, v68, vcc
    s_lshl_b32 s25, s91, 11
    s_add_u32 s25, s25, 10551296
    v_add_u32 v157, s25, v68
    s_min_u32 s101, s101, 1
    s_lshl_b32 s100, s91, 2
    s_add_u32 s100, s100, 64
    v_mov_b32 v152, s100
    v_cmp_gt_u32 vcc, s101, v0
    s_nop 1
    v_cndmask_b32 v152, v69, v152, vcc
    s_lshl_b32 s100, s95, 7
    s_add_u32 s56, s16, s100
    s_addc_u32 s57, s17, 0
    s_mov_b32 s58, 1835008
    s_mov_b32 s59, 0x20000
    s_add_u32 s64, s10, s100
    s_addc_u32 s65, s11, 0
    s_mov_b32 s66, 524288
    s_mov_b32 s67, 0x20000
    s_sub_u32 s58, s58, s100
    s_sub_u32 s66, s66, s100
    s_add_u32 s60, s56, 14336
    s_addc_u32 s61, s57, 0
    s_mov_b32 s62, 0
    s_mov_b32 s63, 0x20000
    s_add_u32 s68, s64, 2048
    s_addc_u32 s69, s65, 0
    s_mov_b32 s70, 0
    s_mov_b32 s71, 0x20000
    s_sub_u32 s62, s58, 14336
    s_sub_u32 s70, s66, 2048
    s_lshl_b32 s101, s94, 16
    s_add_u32 s100, s100, s101
    s_add_u32 s76, s20, s100
    s_addc_u32 s77, s21, 0
    s_mov_b32 s78, 2097152
    s_mov_b32 s79, 0x20000
    s_sub_u32 s78, s78, s100
    s_mul_i32 s100, s92, 448
    s_mul_i32 s101, s3, 192
    s_sub_u32 s100, s100, s101
    s_add_u32 s100, s100, 256
    s_add_u32 s48, s12, s100
    s_addc_u32 s49, s13, 0
    s_mov_b32 s50, 1835008
    s_mov_b32 s51, 0x20000
    s_sub_u32 s50, s50, s100
    s_add_u32 s52, s14, s100
    s_addc_u32 s53, s15, 0
    s_mov_b32 s54, 1837056
    s_mov_b32 s55, 0x20000
    s_sub_u32 s54, s54, s100
    s_sub_u32 s52, s52, 2048
    s_subb_u32 s53, s53, 0
    s_lshr_b32 s20, s100, 6
    s_add_u32 s20, s20, s90
    s_mul_i32 s21, s92, 7
    s_xor_b32 s101, s3, 1
    s_mul_i32 s101, s101, 6
    s_add_u32 s21, s21, s101
    s_xor_b32 s6, s89, 1
    s_lshl_b32 s6, s6, 5
    s_lshl_b32 s100, s92, 11
    s_lshl_b32 s101, s90, 10
    s_add_u32 s100, s100, s101
    v_add_u32 v156, s100, v11
    v_and_b32 v154, 31, v0
    v_lshlrev_b32 v154, 5, v154
    v_lshrrev_b32 v71, 5, v0
    v_lshl_add_u32 v155, v71, 10, v154
    s_lshl_b32 s100, s93, 2
    s_add_u32 s100, s100, s88
    s_lshl_b32 s25, s100, 11
    v_add_u32 v155, s25, v155
    s_lshl_b32 s100, s100, 3
    s_lshl_b32 s101, s91, 9
    s_add_u32 s24, s100, s101
    s_add_u32 s24, s24, 10485760
    v_lshlrev_b32 v71, 2, v71
    v_cmp_eq_u32 vcc, 0, v154
    s_nop 1
    v_cndmask_b32 v146, v69, v71, vcc
    v_and_b32 v74, 15, v0
    v_lshrrev_b32 v75, 4, v0
    v_lshlrev_b32 v75, 4, v75
    v_and_b32 v16, 7, v0
    v_lshl_add_u32 v16, v16, 6, v75
    v_bfe_u32 v17, v0, 3, 1
    v_mul_u32_u24 v17, 10240, v17
    v_add_u32 v16, v16, v17
    v_add_u32 v75, 512, v75
    v_cmp_eq_u32 vcc, 0, v74
    s_nop 1
    v_cndmask_b32 v17, v69, v75, vcc
    s_mul_i32 s100, s92, 163840
    s_add_u32 s100, s100, 11534336
    s_mul_i32 s101, s91, 10240
    s_add_u32 s10, s100, s101
    s_add_u32 s11, s10, 3840
    s_add_u32 s12, s10, 7680
    s_mul_i32 s101, s91, 640
    s_add_u32 s100, s100, s101
    s_lshl_b32 s101, s90, 1
    s_add_u32 s101, s101, s89
    s_mul_i32 s101, s101, 40960
    s_add_u32 s8, s100, s101
    s_add_u32 s9, s8, 20480
    s_bitcmp1_b32 s91, 0
    s_cselect_b32 s100, 32, 36
    s_cmp_eq_u32 s88, 0
    s_cselect_b32 s100, s100, 0
    v_cmp_gt_u32 vcc, s100, v0
    s_nop 1
    v_cndmask_b32 v24, v69, v11, vcc
    s_and_b32 s101, s91, 1
    s_lshl_b32 s101, s101, 8
    v_lshlrev_b32 v74, 3, v0
    v_lshrrev_b32 v75, 5, v0
    v_lshl_add_u32 v74, v75, 8, v74
    v_add_u32 v74, s101, v74
    v_cndmask_b32 v25, v69, v74, vcc
    s_mul_i32 s100, s92, 4352
    s_lshr_b32 s101, s91, 1
    s_mul_i32 s101, s101, 544
    s_add_u32 s100, s100, s101
    s_add_u32 s13, s100, 13631488
    v_mov_b32 v216, -1
    v_mov_b32 v217, -1
    v_mov_b32 v218, -1
    v_mov_b32 v219, -1
    v_lshlrev_b32 v220, 3, v0
    s_lshl_b32 s100, s91, 1
    s_add_u32 s100, s100, s89
    s_mul_i32 s100, s100, 72
    s_add_u32 s20, s20, s100
    s_lshl_b32 s20, s20, 12
    s_add_u32 s21, s21, s100
    s_lshl_b32 s21, s21, 12
    s_mul_i32 s100, s94, 72
    s_mul_i32 s101, s88, 14
    s_lshl_b32 s17, s101, 15
    s_add_u32 s101, s101, s100
    s_lshl_b32 s15, s101, 12
    s_lshl_b32 s101, s88, 2
    s_lshl_b32 s18, s101, 15
    s_add_u32 s101, s101, s100
    s_add_u32 s101, s101, 56
    s_lshl_b32 s16, s101, 12
    s_lshl_b32 s100, s91, 4
    s_add_u32 s100, s100, s93
    s_lshl_b32 s100, s100, 5
    s_add_u32 s100, s100, s88
    s_lshl_b32 s100, s100, 2
    s_add_u32 s14, s100, 10551296
    v_lshrrev_b32 v74, 5, v0
    v_lshlrev_b32 v74, 12, v74
    v_bfe_u32 v75, v0, 4, 1
    v_lshl_add_u32 v74, v75, 10, v74
    v_bfe_u32 v75, v0, 2, 2
    v_lshl_add_u32 v74, v75, 7, v74
    v_and_b32 v75, 3, v0
    v_lshl_add_u32 v74, v75, 3, v74
    v_bfe_u32 v75, v0, 3, 2
    v_lshl_add_u32 v74, v75, 5, v74
    s_lshl_b32 s100, s90, 6
    s_or_b32 s100, s100, s6
    v_xor_b32 v7, s100, v74
    v_xor_b32 v8, 32, v7
    v_add_u32 v9, 0x10000, v7
    v_add_u32 v10, 0x10000, v8
    v_and_b32 v74, 15, v0
    v_lshrrev_b32 v75, 4, v0
    v_bfe_u32 v192, v0, 1, 3
    v_xor_b32 v75, v75, v192
    v_lshlrev_b32 v75, 4, v75
    v_lshl_add_u32 v74, v74, 7, v75
    s_lshl_b32 s100, s89, 13
    s_add_u32 s100, s100, 81920
    v_add_u32 v192, s100, v74
    v_xor_b32 v193, 4096, v192
    v_xor_b32 v194, 64, v192
    v_xor_b32 v195, 64, v193
    v_lshrrev_b32 v74, 5, v0
    v_lshlrev_b32 v74, 8, v74
    v_bfe_u32 v75, v0, 2, 2
    v_lshl_add_u32 v74, v75, 5, v74
    v_bfe_u32 v75, v0, 4, 1
    v_lshl_add_u32 v74, v75, 4, v74
    v_bfe_u32 v75, v0, 1, 1
    v_lshl_add_u32 v74, v75, 3, v74
    s_add_u32 s100, s96, 147456
    v_add_u32 v148, s100, v74
    s_lshl_b32 s101, s6, 4
    v_xor_b32 v148, s101, v148
    v_xor_b32 v149, 512, v148
    v_bfe_u32 v75, v0, 2, 1
    v_mul_u32_u24 v75, 0x8000, v75
    v_lshl_or_b32 v150, v75, 16, v75
    v_lshrrev_b32 v74, 5, v0
    v_lshlrev_b32 v74, 10, v74
    v_and_b32 v75, 31, v0
    v_lshl_add_u32 v74, v75, 5, v74
    v_add_u32 v14, s100, v74
    v_lshlrev_b32 v74, 3, v0
    v_add_u32 v15, s100, v74
    v_mov_b32 v28, 0x3f803f80
    v_mov_b32 v29, 0x3f803f80
    v_mov_b32 v30, 0x3f803f80
    v_mov_b32 v31, 0x3f803f80
    v_and_b32 v74, 7, v0
    v_bfe_u32 v75, v0, 4, 2
    v_lshlrev_b32 v75, 1, v75
    v_xor_b32 v74, v74, v75
    v_lshlrev_b32 v74, 4, v74
    v_lshrrev_b32 v75, 3, v0
    v_lshl_add_u32 v5, v75, 10, v74
    v_add_u32 v6, 7168, v5
    s_lshl_b32 s100, s90, 9
    s_add_u32 s21, s21, s100
    s_and_b32 s7, s95, 3
    s_xor_b32 s7, s7, s88
    s_add_u32 s0, s96, 147456
    s_add_u32 m0, s96, 147456
    s_nop 0
    buffer_load_dwordx4 v156, s[84:87], 0 offen lds
    buffer_load_dwordx4 v[128:131], v155, s[28:31], 0 offen
    buffer_load_dwordx4 v[132:135], v155, s[28:31], 0 offen offset:16
    global_load_dwordx4 v[136:139], v154, s[26:27]
    global_load_dwordx4 v[140:143], v154, s[26:27] offset:16
    buffer_store_dwordx4 v[172:175], v157, s[72:75], 0 offen sc1
    s_add_u32 m0, s96, 114688
    s_add_u32 s99, s5, 2
    s_and_b32 s99, s99, 7
    s_lshl_b32 s99, s99, 7
    buffer_load_dwordx4 v224, s[28:31], s99 offen offset:0 lds
    buffer_load_dwordx4 v225, s[28:31], s99 offen offset:1024 lds
    buffer_load_dwordx4 v226, s[28:31], s99 offen offset:2048 lds
    buffer_load_dwordx4 v227, s[28:31], s99 offen offset:3072 lds
    s_add_u32 m0, s96, 16384
    s_add_u32 s99, s5, 2
    s_and_b32 s99, s99, 7
    s_mul_i32 s99, s99, 196608
    buffer_load_dwordx4 v1, s[32:35], s99 offen offset:0 lds
    buffer_load_dwordx4 v2, s[32:35], s99 offen offset:1024 lds
    buffer_load_dwordx4 v1, s[36:39], s99 offen offset:2048 lds
    buffer_load_dwordx4 v2, s[36:39], s99 offen offset:3072 lds
    s_waitcnt vmcnt(14)
    s_barrier
    ds_read_b64_tr_b16 v[32:33], v7 offset:0
    ds_read_b64_tr_b16 v[34:35], v7 offset:512
    ds_read_b64_tr_b16 v[36:37], v7 offset:8192
    ds_read_b64_tr_b16 v[38:39], v7 offset:8704
    ds_read_b128 a[0:3], v192 offset:0
    ds_read_b128 a[16:19], v194 offset:0
    ds_read_b128 a[4:7], v192 offset:2048
    ds_read_b128 a[20:23], v194 offset:2048
    ds_read_b128 a[8:11], v193 offset:0
    ds_read_b128 a[24:27], v195 offset:0
    ds_read_b128 a[12:15], v193 offset:2048
    ds_read_b128 a[28:31], v195 offset:2048
    ds_read_b64_tr_b16 v[40:41], v8 offset:0
    ds_read_b64_tr_b16 v[42:43], v8 offset:512
    ds_read_b64_tr_b16 v[44:45], v8 offset:8192
    ds_read_b64_tr_b16 v[46:47], v8 offset:8704
    s_waitcnt lgkmcnt(11)
    v_mfma_f32_16x16x32_bf16 v[64:67], v[32:35], a[0:3], 0
    ds_read_b128 a[32:35], v192 offset:16384
    s_add_u32 m0, s96, 131072
    s_add_u32 s99, s5, 3
    s_and_b32 s99, s99, 7
    s_lshl_b32 s99, s99, 7
    buffer_load_dwordx4 v224, s[28:31], s99 offen offset:0 lds
    s_waitcnt lgkmcnt(11)
    v_mfma_f32_16x16x32_bf16 v[64:67], v[36:39], a[16:19], v[64:67]
    ds_read_b128 a[48:51], v194 offset:16384
    buffer_load_dwordx4 v225, s[28:31], s99 offen offset:1024 lds
    s_waitcnt lgkmcnt(11)
    v_mfma_f32_16x16x32_bf16 v[68:71], v[32:35], a[4:7], 0
    ds_read_b128 a[36:39], v192 offset:18432
    buffer_load_dwordx4 v226, s[28:31], s99 offen offset:2048 lds
    s_waitcnt lgkmcnt(11)
    v_mfma_f32_16x16x32_bf16 v[68:71], v[36:39], a[20:23], v[68:71]
    ds_read_b128 a[52:55], v194 offset:18432
    buffer_load_dwordx4 v227, s[28:31], s99 offen offset:3072 lds
    s_waitcnt lgkmcnt(11)
    v_mfma_f32_16x16x32_bf16 v[72:75], v[32:35], a[8:11], 0
    ds_read_b64_tr_b16 v[48:49], v7 offset:2048
    s_add_u32 m0, s96, 49152
    s_add_u32 s99, s5, 4
    s_and_b32 s99, s99, 7
    s_lshl_b32 s99, s99, 7
    buffer_load_dwordx4 v224, s[28:31], s99 offen offset:0 lds
    s_waitcnt lgkmcnt(11)
    v_mfma_f32_16x16x32_bf16 v[72:75], v[36:39], a[24:27], v[72:75]
    ds_read_b64_tr_b16 v[50:51], v7 offset:2560
    buffer_load_dwordx4 v225, s[28:31], s99 offen offset:1024 lds
    s_waitcnt lgkmcnt(11)
    v_mfma_f32_16x16x32_bf16 v[76:79], v[32:35], a[12:15], 0
    ds_read_b64_tr_b16 v[52:53], v7 offset:10240
    buffer_load_dwordx4 v226, s[28:31], s99 offen offset:2048 lds
    s_waitcnt lgkmcnt(11)
    v_mfma_f32_16x16x32_bf16 v[76:79], v[36:39], a[28:31], v[76:79]
    ds_read_b64_tr_b16 v[54:55], v7 offset:10752
    buffer_load_dwordx4 v227, s[28:31], s99 offen offset:3072 lds
    s_waitcnt lgkmcnt(8)
    v_mfma_f32_16x16x32_bf16 v[80:83], v[40:43], a[0:3], 0
    ds_read_b128 a[40:43], v193 offset:16384
    s_add_u32 m0, s96, 32768
    s_add_u32 s99, s5, 4
    s_and_b32 s99, s99, 7
    s_mul_i32 s99, s99, 196608
    buffer_load_dwordx4 v1, s[32:35], s99 offen offset:0 lds
    v_mfma_f32_16x16x32_bf16 v[80:83], v[44:47], a[16:19], v[80:83]
    ds_read_b128 a[56:59], v195 offset:16384
    buffer_load_dwordx4 v2, s[32:35], s99 offen offset:1024 lds
    v_mfma_f32_16x16x32_bf16 v[84:87], v[40:43], a[4:7], 0
    ds_read_b128 a[44:47], v193 offset:18432
    buffer_load_dwordx4 v1, s[36:39], s99 offen offset:2048 lds
    v_mfma_f32_16x16x32_bf16 v[84:87], v[44:47], a[20:23], v[84:87]
    ds_read_b128 a[60:63], v195 offset:18432
    buffer_load_dwordx4 v2, s[36:39], s99 offen offset:3072 lds
    v_mfma_f32_16x16x32_bf16 v[88:91], v[40:43], a[8:11], 0
    ds_read_b64_tr_b16 v[32:33], v8 offset:2048
    s_add_u32 m0, s96, 65536
    s_add_u32 s99, s5, 5
    s_and_b32 s99, s99, 7
    s_lshl_b32 s99, s99, 7
    buffer_load_dwordx4 v224, s[28:31], s99 offen offset:0 lds
    v_mfma_f32_16x16x32_bf16 v[88:91], v[44:47], a[24:27], v[88:91]
    ds_read_b64_tr_b16 v[34:35], v8 offset:2560
    buffer_load_dwordx4 v225, s[28:31], s99 offen offset:1024 lds
    v_mfma_f32_16x16x32_bf16 v[92:95], v[40:43], a[12:15], 0
    ds_read_b64_tr_b16 v[36:37], v8 offset:10240
    buffer_load_dwordx4 v226, s[28:31], s99 offen offset:2048 lds
    v_mfma_f32_16x16x32_bf16 v[92:95], v[44:47], a[28:31], v[92:95]
    ds_read_b64_tr_b16 v[38:39], v8 offset:10752
    buffer_load_dwordx4 v227, s[28:31], s99 offen offset:3072 lds
    s_waitcnt vmcnt(12) lgkmcnt(4)
    s_barrier
    v_mfma_f32_16x16x32_bf16 v[64:67], v[48:51], a[32:35], v[64:67]
    ds_read_b128 a[64:67], v192 offset:32768
    s_add_u32 m0, s96, 81920
    v_mfma_f32_16x16x32_bf16 v[64:67], v[52:55], a[48:51], v[64:67]
    ds_read_b128 a[80:83], v194 offset:32768
    s_add_u32 s99, s5, 6
    v_mfma_f32_16x16x32_bf16 v[68:71], v[48:51], a[36:39], v[68:71]
    ds_read_b128 a[68:71], v192 offset:34816
    s_and_b32 s99, s99, 7
    v_mfma_f32_16x16x32_bf16 v[68:71], v[52:55], a[52:55], v[68:71]
    ds_read_b128 a[84:87], v194 offset:34816
    s_lshl_b32 s99, s99, 7
    buffer_load_dwordx4 v224, s[28:31], s99 offen offset:0 lds
    v_mfma_f32_16x16x32_bf16 v[72:75], v[48:51], a[40:43], v[72:75]
    ds_read_b64_tr_b16 v[40:41], v7 offset:16384
    v_mfma_f32_16x16x32_bf16 v[72:75], v[52:55], a[56:59], v[72:75]
    ds_read_b64_tr_b16 v[42:43], v7 offset:16896
    v_mfma_f32_16x16x32_bf16 v[76:79], v[48:51], a[44:47], v[76:79]
    ds_read_b64_tr_b16 v[44:45], v7 offset:24576
    buffer_load_dwordx4 v225, s[28:31], s99 offen offset:1024 lds
    v_mfma_f32_16x16x32_bf16 v[76:79], v[52:55], a[60:63], v[76:79]
    ds_read_b64_tr_b16 v[46:47], v7 offset:25088
    s_waitcnt lgkmcnt(8)
    v_mfma_f32_16x16x32_bf16 v[80:83], v[32:35], a[32:35], v[80:83]
    ds_read_b128 a[72:75], v193 offset:32768
    v_mfma_f32_16x16x32_bf16 v[80:83], v[36:39], a[48:51], v[80:83]
    ds_read_b128 a[88:91], v195 offset:32768
    v_mfma_f32_16x16x32_bf16 v[84:87], v[32:35], a[36:39], v[84:87]
    ds_read_b128 a[76:79], v193 offset:34816
    v_mfma_f32_16x16x32_bf16 v[84:87], v[36:39], a[52:55], v[84:87]
    ds_read_b128 a[92:95], v195 offset:34816
    buffer_load_dwordx4 v226, s[28:31], s99 offen offset:2048 lds
    v_mfma_f32_16x16x32_bf16 v[88:91], v[32:35], a[40:43], v[88:91]
    ds_read_b64_tr_b16 v[48:49], v8 offset:16384
    v_mfma_f32_16x16x32_bf16 v[88:91], v[36:39], a[56:59], v[88:91]
    ds_read_b64_tr_b16 v[50:51], v8 offset:16896
    v_mfma_f32_16x16x32_bf16 v[92:95], v[32:35], a[44:47], v[92:95]
    ds_read_b64_tr_b16 v[52:53], v8 offset:24576
    buffer_load_dwordx4 v227, s[28:31], s99 offen offset:3072 lds
    v_mfma_f32_16x16x32_bf16 v[92:95], v[36:39], a[60:63], v[92:95]
    ds_read_b64_tr_b16 v[54:55], v8 offset:25088
    s_waitcnt lgkmcnt(4)
    v_mfma_f32_16x16x32_bf16 v[64:67], v[40:43], a[64:67], v[64:67]
    ds_read_b128 a[96:99], v192 offset:49152
    s_add_u32 m0, s96, 98304
    v_mfma_f32_16x16x32_bf16 v[64:67], v[44:47], a[80:83], v[64:67]
    ds_read_b128 a[112:115], v194 offset:49152
    s_add_u32 s99, s5, 7
    v_mfma_f32_16x16x32_bf16 v[68:71], v[40:43], a[68:71], v[68:71]
    ds_read_b128 a[100:103], v192 offset:51200
    s_and_b32 s99, s99, 7
    v_mfma_f32_16x16x32_bf16 v[68:71], v[44:47], a[84:87], v[68:71]
    ds_read_b128 a[116:119], v194 offset:51200
    s_lshl_b32 s99, s99, 7
    buffer_load_dwordx4 v224, s[28:31], s99 offen offset:0 lds
    v_mfma_f32_16x16x32_bf16 v[72:75], v[40:43], a[72:75], v[72:75]
    ds_read_b64_tr_b16 v[32:33], v7 offset:18432
    v_mfma_f32_16x16x32_bf16 v[72:75], v[44:47], a[88:91], v[72:75]
    ds_read_b64_tr_b16 v[34:35], v7 offset:18944
    v_mfma_f32_16x16x32_bf16 v[76:79], v[40:43], a[76:79], v[76:79]
    ds_read_b64_tr_b16 v[36:37], v7 offset:26624
    buffer_load_dwordx4 v225, s[28:31], s99 offen offset:1024 lds
    v_mfma_f32_16x16x32_bf16 v[76:79], v[44:47], a[92:95], v[76:79]
    ds_read_b64_tr_b16 v[38:39], v7 offset:27136
    s_waitcnt lgkmcnt(8)
    v_mfma_f32_16x16x32_bf16 v[80:83], v[48:51], a[64:67], v[80:83]
    ds_read_b128 a[104:107], v193 offset:49152
    v_mfma_f32_16x16x32_bf16 v[80:83], v[52:55], a[80:83], v[80:83]
    ds_read_b128 a[120:123], v195 offset:49152
    v_mfma_f32_16x16x32_bf16 v[84:87], v[48:51], a[68:71], v[84:87]
    ds_read_b128 a[108:111], v193 offset:51200
    v_mfma_f32_16x16x32_bf16 v[84:87], v[52:55], a[84:87], v[84:87]
    ds_read_b128 a[124:127], v195 offset:51200
    buffer_load_dwordx4 v226, s[28:31], s99 offen offset:2048 lds
    v_mfma_f32_16x16x32_bf16 v[88:91], v[48:51], a[72:75], v[88:91]
    ds_read_b64_tr_b16 v[40:41], v8 offset:18432
    v_mfma_f32_16x16x32_bf16 v[88:91], v[52:55], a[88:91], v[88:91]
    ds_read_b64_tr_b16 v[42:43], v8 offset:18944
    v_mfma_f32_16x16x32_bf16 v[92:95], v[48:51], a[76:79], v[92:95]
    ds_read_b64_tr_b16 v[44:45], v8 offset:26624
    buffer_load_dwordx4 v227, s[28:31], s99 offen offset:3072 lds
    v_mfma_f32_16x16x32_bf16 v[92:95], v[52:55], a[92:95], v[92:95]
    ds_read_b64_tr_b16 v[46:47], v8 offset:27136
    s_waitcnt vmcnt(8) lgkmcnt(4)
    s_barrier
    v_subrev_u32 v192, 32768, v192
    v_subrev_u32 v193, 32768, v193
    v_subrev_u32 v194, 32768, v194
    v_subrev_u32 v195, 32768, v195
    v_mfma_f32_16x16x32_bf16 v[64:67], v[32:35], a[96:99], v[64:67]
    ds_read_b128 a[128:131], v192 offset:0
    s_add_u32 m0, s96, 0
    v_mfma_f32_16x16x32_bf16 v[64:67], v[36:39], a[112:115], v[64:67]
    ds_read_b128 a[144:147], v194 offset:0
    s_add_u32 s99, s5, 6
    v_mfma_f32_16x16x32_bf16 v[68:71], v[32:35], a[100:103], v[68:71]
    ds_read_b128 a[132:135], v192 offset:2048
    s_and_b32 s99, s99, 7
    v_mfma_f32_16x16x32_bf16 v[68:71], v[36:39], a[116:119], v[68:71]
    ds_read_b128 a[148:151], v194 offset:2048
    s_mul_i32 s99, s99, 196608
    buffer_load_dwordx4 v1, s[32:35], s99 offen offset:0 lds
    v_mfma_f32_16x16x32_bf16 v[72:75], v[32:35], a[104:107], v[72:75]
    ds_read_b64_tr_b16 v[48:49], v7 offset:32768
    v_mfma_f32_16x16x32_bf16 v[72:75], v[36:39], a[120:123], v[72:75]
    ds_read_b64_tr_b16 v[50:51], v7 offset:33280
    v_mfma_f32_16x16x32_bf16 v[76:79], v[32:35], a[108:111], v[76:79]
    ds_read_b64_tr_b16 v[52:53], v7 offset:40960
    buffer_load_dwordx4 v2, s[32:35], s99 offen offset:1024 lds
    v_mfma_f32_16x16x32_bf16 v[76:79], v[36:39], a[124:127], v[76:79]
    ds_read_b64_tr_b16 v[54:55], v7 offset:41472
    s_waitcnt lgkmcnt(8)
    v_mfma_f32_16x16x32_bf16 v[80:83], v[40:43], a[96:99], v[80:83]
    ds_read_b128 a[136:139], v193 offset:0
    v_mfma_f32_16x16x32_bf16 v[80:83], v[44:47], a[112:115], v[80:83]
    ds_read_b128 a[152:155], v195 offset:0
    v_mfma_f32_16x16x32_bf16 v[84:87], v[40:43], a[100:103], v[84:87]
    ds_read_b128 a[140:143], v193 offset:2048
    v_mfma_f32_16x16x32_bf16 v[84:87], v[44:47], a[116:119], v[84:87]
    ds_read_b128 a[156:159], v195 offset:2048
    buffer_load_dwordx4 v1, s[36:39], s99 offen offset:2048 lds
    v_mfma_f32_16x16x32_bf16 v[88:91], v[40:43], a[104:107], v[88:91]
    ds_read_b64_tr_b16 v[32:33], v8 offset:32768
    v_mfma_f32_16x16x32_bf16 v[88:91], v[44:47], a[120:123], v[88:91]
    ds_read_b64_tr_b16 v[34:35], v8 offset:33280
    v_mfma_f32_16x16x32_bf16 v[92:95], v[40:43], a[108:111], v[92:95]
    ds_read_b64_tr_b16 v[36:37], v8 offset:40960
    buffer_load_dwordx4 v2, s[36:39], s99 offen offset:3072 lds
    v_mfma_f32_16x16x32_bf16 v[92:95], v[44:47], a[124:127], v[92:95]
    ds_read_b64_tr_b16 v[38:39], v8 offset:41472
    s_waitcnt lgkmcnt(4)
    v_mfma_f32_16x16x32_bf16 v[64:67], v[48:51], a[128:131], v[64:67]
    ds_read_b128 a[160:163], v192 offset:16384
    s_add_u32 m0, s96, 114688
    v_mfma_f32_16x16x32_bf16 v[64:67], v[52:55], a[144:147], v[64:67]
    ds_read_b128 a[176:179], v194 offset:16384
    s_add_u32 s99, s5, 0
    v_mfma_f32_16x16x32_bf16 v[68:71], v[48:51], a[132:135], v[68:71]
    ds_read_b128 a[164:167], v192 offset:18432
    s_and_b32 s99, s99, 7
    v_mfma_f32_16x16x32_bf16 v[68:71], v[52:55], a[148:151], v[68:71]
    ds_read_b128 a[180:183], v194 offset:18432
    s_mul_i32 s99, s99, 229376
    buffer_load_dwordx4 v3, s[48:51], s99 offen offset:0 lds
    v_mfma_f32_16x16x32_bf16 v[72:75], v[48:51], a[136:139], v[72:75]
    ds_read_b64_tr_b16 v[40:41], v7 offset:34816
    v_mfma_f32_16x16x32_bf16 v[72:75], v[52:55], a[152:155], v[72:75]
    ds_read_b64_tr_b16 v[42:43], v7 offset:35328
    v_mfma_f32_16x16x32_bf16 v[76:79], v[48:51], a[140:143], v[76:79]
    ds_read_b64_tr_b16 v[44:45], v7 offset:43008
    buffer_load_dwordx4 v4, s[48:51], s99 offen offset:1024 lds
    v_mfma_f32_16x16x32_bf16 v[76:79], v[52:55], a[156:159], v[76:79]
    ds_read_b64_tr_b16 v[46:47], v7 offset:43520
    s_waitcnt lgkmcnt(8)
    v_mfma_f32_16x16x32_bf16 v[80:83], v[32:35], a[128:131], v[80:83]
    ds_read_b128 a[168:171], v193 offset:16384
    v_mfma_f32_16x16x32_bf16 v[80:83], v[36:39], a[144:147], v[80:83]
    ds_read_b128 a[184:187], v195 offset:16384
    v_mfma_f32_16x16x32_bf16 v[84:87], v[32:35], a[132:135], v[84:87]
    ds_read_b128 a[172:175], v193 offset:18432
    v_mfma_f32_16x16x32_bf16 v[84:87], v[36:39], a[148:151], v[84:87]
    ds_read_b128 a[188:191], v195 offset:18432
    buffer_load_dwordx4 v3, s[52:55], s99 offen offset:2048 lds
    v_mfma_f32_16x16x32_bf16 v[88:91], v[32:35], a[136:139], v[88:91]
    ds_read_b64_tr_b16 v[48:49], v8 offset:34816
    v_mfma_f32_16x16x32_bf16 v[88:91], v[36:39], a[152:155], v[88:91]
    ds_read_b64_tr_b16 v[50:51], v8 offset:35328
    v_mfma_f32_16x16x32_bf16 v[92:95], v[32:35], a[140:143], v[92:95]
    ds_read_b64_tr_b16 v[52:53], v8 offset:43008
    buffer_load_dwordx4 v4, s[52:55], s99 offen offset:3072 lds
    v_mfma_f32_16x16x32_bf16 v[92:95], v[36:39], a[156:159], v[92:95]
    ds_read_b64_tr_b16 v[54:55], v8 offset:43520
    s_waitcnt vmcnt(4) lgkmcnt(4)
    s_barrier
    v_mfma_f32_16x16x32_bf16 v[64:67], v[40:43], a[160:163], v[64:67]
    ds_read_b128 a[192:195], v192 offset:32768
    v_mfma_f32_16x16x32_bf16 v[64:67], v[44:47], a[176:179], v[64:67]
    ds_read_b128 a[208:211], v194 offset:32768
    v_mfma_f32_16x16x32_bf16 v[68:71], v[40:43], a[164:167], v[68:71]
    ds_read_b128 a[196:199], v192 offset:34816
    v_mov_b32 v27, 1
    buffer_store_dword v27, v152, s[80:83], 0 offen sc1
    v_mfma_f32_16x16x32_bf16 v[68:71], v[44:47], a[180:183], v[68:71]
    ds_read_b128 a[212:215], v194 offset:34816
    s_add_u32 m0, s96, 16384
    v_mfma_f32_16x16x32_bf16 v[72:75], v[40:43], a[168:171], v[72:75]
    ds_read_b64_tr_b16 v[32:33], v7 offset:0
    s_add_u32 s99, s5, 1
    s_and_b32 s99, s99, 7
    s_mul_i32 s99, s99, 229376
    buffer_load_dwordx4 v3, s[48:51], s99 offen offset:0 lds
    v_mfma_f32_16x16x32_bf16 v[72:75], v[44:47], a[184:187], v[72:75]
    ds_read_b64_tr_b16 v[34:35], v7 offset:512
    v_mfma_f32_16x16x32_bf16 v[76:79], v[40:43], a[172:175], v[76:79]
    ds_read_b64_tr_b16 v[36:37], v7 offset:8192
    buffer_load_dwordx4 v4, s[48:51], s99 offen offset:1024 lds
    v_mfma_f32_16x16x32_bf16 v[76:79], v[44:47], a[188:191], v[76:79]
    ds_read_b64_tr_b16 v[38:39], v7 offset:8704
    s_waitcnt lgkmcnt(8)
    v_mfma_f32_16x16x32_bf16 v[80:83], v[48:51], a[160:163], v[80:83]
    ds_read_b128 a[200:203], v193 offset:32768
    v_mfma_f32_16x16x32_bf16 v[80:83], v[52:55], a[176:179], v[80:83]
    ds_read_b128 a[216:219], v195 offset:32768
    v_mfma_f32_16x16x32_bf16 v[84:87], v[48:51], a[164:167], v[84:87]
    ds_read_b128 a[204:207], v193 offset:34816
    v_mfma_f32_16x16x32_bf16 v[84:87], v[52:55], a[180:183], v[84:87]
    ds_read_b128 a[220:223], v195 offset:34816
    buffer_load_dwordx4 v3, s[52:55], s99 offen offset:2048 lds
    v_mfma_f32_16x16x32_bf16 v[88:91], v[48:51], a[168:171], v[88:91]
    ds_read_b64_tr_b16 v[40:41], v8 offset:0
    v_mfma_f32_16x16x32_bf16 v[88:91], v[52:55], a[184:187], v[88:91]
    ds_read_b64_tr_b16 v[42:43], v8 offset:512
    v_mfma_f32_16x16x32_bf16 v[92:95], v[48:51], a[172:175], v[92:95]
    ds_read_b64_tr_b16 v[44:45], v8 offset:8192
    buffer_load_dwordx4 v4, s[52:55], s99 offen offset:3072 lds
    v_mfma_f32_16x16x32_bf16 v[92:95], v[52:55], a[188:191], v[92:95]
    ds_read_b64_tr_b16 v[46:47], v8 offset:8704
    s_waitcnt lgkmcnt(4)
    v_mfma_f32_16x16x32_bf16 v[64:67], v[32:35], a[192:195], v[64:67]
    ds_read_b128 a[224:227], v192 offset:49152
    s_add_u32 m0, s96, 49152
    v_mfma_f32_16x16x32_bf16 v[64:67], v[36:39], a[208:211], v[64:67]
    ds_read_b128 a[240:243], v194 offset:49152
    s_add_u32 s99, s5, 2
    v_mfma_f32_16x16x32_bf16 v[68:71], v[32:35], a[196:199], v[68:71]
    ds_read_b128 a[228:231], v192 offset:51200
    s_and_b32 s99, s99, 7
    v_mfma_f32_16x16x32_bf16 v[68:71], v[36:39], a[212:215], v[68:71]
    ds_read_b128 a[244:247], v194 offset:51200
    s_mul_i32 s99, s99, 229376
    buffer_load_dwordx4 v3, s[48:51], s99 offen offset:0 lds
    v_mfma_f32_16x16x32_bf16 v[72:75], v[32:35], a[200:203], v[72:75]
    ds_read_b64_tr_b16 v[48:49], v7 offset:2048
    v_mfma_f32_16x16x32_bf16 v[72:75], v[36:39], a[216:219], v[72:75]
    ds_read_b64_tr_b16 v[50:51], v7 offset:2560
    v_mfma_f32_16x16x32_bf16 v[76:79], v[32:35], a[204:207], v[76:79]
    ds_read_b64_tr_b16 v[52:53], v7 offset:10240
    buffer_load_dwordx4 v4, s[48:51], s99 offen offset:1024 lds
    v_mfma_f32_16x16x32_bf16 v[76:79], v[36:39], a[220:223], v[76:79]
    ds_read_b64_tr_b16 v[54:55], v7 offset:10752
    s_waitcnt lgkmcnt(8)
    v_mfma_f32_16x16x32_bf16 v[80:83], v[40:43], a[192:195], v[80:83]
    ds_read_b128 a[232:235], v193 offset:49152
    v_mfma_f32_16x16x32_bf16 v[80:83], v[44:47], a[208:211], v[80:83]
    ds_read_b128 a[248:251], v195 offset:49152
    v_mfma_f32_16x16x32_bf16 v[84:87], v[40:43], a[196:199], v[84:87]
    ds_read_b128 a[236:239], v193 offset:51200
    v_mfma_f32_16x16x32_bf16 v[84:87], v[44:47], a[212:215], v[84:87]
    ds_read_b128 a[252:255], v195 offset:51200
    buffer_load_dwordx4 v3, s[52:55], s99 offen offset:2048 lds
    v_mfma_f32_16x16x32_bf16 v[88:91], v[40:43], a[200:203], v[88:91]
    ds_read_b64_tr_b16 v[32:33], v8 offset:2048
    v_mfma_f32_16x16x32_bf16 v[88:91], v[44:47], a[216:219], v[88:91]
    ds_read_b64_tr_b16 v[34:35], v8 offset:2560
    v_mfma_f32_16x16x32_bf16 v[92:95], v[40:43], a[204:207], v[92:95]
    ds_read_b64_tr_b16 v[36:37], v8 offset:10240
    buffer_load_dwordx4 v4, s[52:55], s99 offen offset:3072 lds
    v_mfma_f32_16x16x32_bf16 v[92:95], v[44:47], a[220:223], v[92:95]
    ds_read_b64_tr_b16 v[38:39], v8 offset:10752
    s_waitcnt vmcnt(9) lgkmcnt(4)
    s_barrier
    v_xor_b32 v7, s6, v7
    v_xor_b32 v8, s6, v8
    v_xor_b32 v9, s6, v9
    v_xor_b32 v10, s6, v10
    v_mfma_f32_16x16x32_bf16 v[64:67], v[48:51], a[224:227], v[64:67]
    ds_read_b64_tr_b16 v[40:41], v9 offset:49152
    s_add_u32 m0, s96, 32768
    v_mfma_f32_16x16x32_bf16 v[64:67], v[52:55], a[240:243], v[64:67]
    ds_read_b64_tr_b16 v[42:43], v9 offset:49664
    s_add_u32 s99, s5, 3
    v_mfma_f32_16x16x32_bf16 v[68:71], v[48:51], a[228:231], v[68:71]
    ds_read_b64_tr_b16 v[44:45], v9 offset:57344
    s_and_b32 s99, s99, 7
    v_mfma_f32_16x16x32_bf16 v[68:71], v[52:55], a[244:247], v[68:71]
    ds_read_b64_tr_b16 v[46:47], v9 offset:57856
    s_mul_i32 s99, s99, 229376
    v_mfma_f32_16x16x32_bf16 v[72:75], v[48:51], a[232:235], v[72:75]
    ds_read_b64_tr_b16 v[56:57], v148 offset:0
    v_mfma_f32_16x16x32_bf16 v[72:75], v[52:55], a[248:251], v[72:75]
    ds_read_b64_tr_b16 v[58:59], v148 offset:128
    v_mfma_f32_16x16x32_bf16 v[76:79], v[48:51], a[236:239], v[76:79]
    buffer_load_dwordx4 v3, s[48:51], s99 offen offset:0 lds
    v_mfma_f32_16x16x32_bf16 v[76:79], v[52:55], a[252:255], v[76:79]
    s_waitcnt lgkmcnt(6)
    v_dot2_f32_bf16 v144, v128, v136, 0
    v_mfma_f32_16x16x32_bf16 v[80:83], v[32:35], a[224:227], v[80:83]
    ds_read_b64_tr_b16 v[48:49], v10 offset:49152
    v_mfma_f32_16x16x32_bf16 v[80:83], v[36:39], a[240:243], v[80:83]
    ds_read_b64_tr_b16 v[50:51], v10 offset:49664
    v_mfma_f32_16x16x32_bf16 v[84:87], v[32:35], a[228:231], v[84:87]
    ds_read_b64_tr_b16 v[52:53], v10 offset:57344
    v_mfma_f32_16x16x32_bf16 v[84:87], v[36:39], a[244:247], v[84:87]
    ds_read_b64_tr_b16 v[54:55], v10 offset:57856
    v_mfma_f32_16x16x32_bf16 v[88:91], v[32:35], a[232:235], v[88:91]
    ds_read_b64_tr_b16 v[60:61], v149 offset:0
    s_waitcnt lgkmcnt(6)
    v_xor_b32 v56, v150, v56
    v_mfma_f32_16x16x32_bf16 v[88:91], v[36:39], a[248:251], v[88:91]
    ds_read_b64_tr_b16 v[62:63], v149 offset:128
    v_xor_b32 v57, v150, v57
    v_mfma_f32_16x16x32_bf16 v[92:95], v[32:35], a[236:239], v[92:95]
    buffer_load_dwordx4 v4, s[48:51], s99 offen offset:1024 lds
    s_waitcnt lgkmcnt(6)
    v_xor_b32 v58, v150, v58
    v_mfma_f32_16x16x32_bf16 v[92:95], v[36:39], a[252:255], v[92:95]
    v_dot2_f32_bf16 v144, v129, v137, v144
    v_dot2_f32_bf16 v144, v130, v138, v144
    v_dot2_f32_bf16 v144, v131, v139, v144
    v_dot2_f32_bf16 v144, v132, v140, v144
    v_dot2_f32_bf16 v144, v133, v141, v144
    v_dot2_f32_bf16 v144, v134, v142, v144
    v_dot2_f32_bf16 v144, v135, v143, v144
    v_xor_b32 v59, v150, v59
    s_nop 1
    v_add_f32_dpp v144, v144, v144 row_ror:8 row_mask:0xf bank_mask:0xf
    s_nop 1
    v_add_f32_dpp v144, v144, v144 row_ror:4 row_mask:0xf bank_mask:0xf
    s_nop 1
    v_add_f32_dpp v144, v144, v144 row_ror:2 row_mask:0xf bank_mask:0xf
    s_nop 1
    v_add_f32_dpp v144, v144, v144 row_ror:1 row_mask:0xf bank_mask:0xf
    v_mov_b32 v145, v144
    s_nop 1
    v_permlane16_swap_b32 v144, v145
    v_add_f32 v144, v144, v145
    v_mul_f32 v144, s98, v144
    v_exp_f32 v144, v144
    s_waitcnt lgkmcnt(1)
    v_xor_b32 v60, v150, v60
    v_add_f32 v144, 1.0, v144
    v_rcp_f32 v144, v144
    buffer_store_dword v144, v146, s[72:75], s24 offen sc1
    v_xor_b32 v61, v150, v61
    s_waitcnt lgkmcnt(0)
    v_xor_b32 v62, v150, v62
    v_xor_b32 v63, v150, v63
    v_mfma_f32_16x16x32_bf16 v[128:131], v[40:43], a[0:3], 0
    ds_read_b64_tr_b16 v[32:33], v9 offset:51200
    v_cvt_pk_bf16_f32 v64, v64, v65
    v_mfma_f32_16x16x32_bf16 v[128:131], v[44:47], a[16:19], v[128:131]
    ds_read_b64_tr_b16 v[34:35], v9 offset:51712
    v_cvt_pk_bf16_f32 v65, v66, v67
    v_mfma_f32_16x16x32_bf16 v[132:135], v[40:43], a[4:7], 0
    ds_read_b64_tr_b16 v[36:37], v9 offset:59392
    v_cvt_pk_bf16_f32 v66, v68, v69
    v_mfma_f32_16x16x32_bf16 v[132:135], v[44:47], a[20:23], v[132:135]
    ds_read_b64_tr_b16 v[38:39], v9 offset:59904
    v_cvt_pk_bf16_f32 v67, v70, v71
    v_mfma_f32_16x16x32_bf16 v[136:139], v[40:43], a[8:11], 0
    v_permlane16_swap_b32 v64, v66
    v_permlane16_swap_b32 v65, v67
    v_mfma_f32_16x16x32_bf16 v[136:139], v[44:47], a[24:27], v[136:139]
    v_cvt_pk_bf16_f32 v72, v72, v73
    v_cvt_pk_bf16_f32 v73, v74, v75
    v_mfma_f32_32x32x16_bf16 v[224:239], v[56:59], v[64:67], 0
    v_cvt_pk_bf16_f32 v74, v76, v77
    v_cvt_pk_bf16_f32 v75, v78, v79
    v_cvt_pk_bf16_f32 v80, v80, v81
    v_permlane16_swap_b32 v72, v74
    v_permlane16_swap_b32 v73, v75
    v_cvt_pk_bf16_f32 v81, v82, v83
    v_mfma_f32_16x16x32_bf16 v[140:143], v[40:43], a[12:15], 0
    buffer_load_dwordx4 v3, s[52:55], s99 offen offset:2048 lds
    v_cvt_pk_bf16_f32 v82, v84, v85
    v_mfma_f32_32x32x16_bf16 v[240:255], v[56:59], v[72:75], 0
    v_cvt_pk_bf16_f32 v83, v86, v87
    v_permlane16_swap_b32 v80, v82
    v_max3_f32 v12, v224, v225, v226
    v_max3_f32 v12, v12, v227, v228
    v_max3_f32 v12, v12, v229, v230
    v_max3_f32 v12, v12, v231, v232
    v_mfma_f32_16x16x32_bf16 v[140:143], v[44:47], a[28:31], v[140:143]
    v_max3_f32 v12, v12, v233, v234
    v_max3_f32 v12, v12, v235, v236
    v_mfma_f32_16x16x32_bf16 v[144:147], v[48:51], a[0:3], 0
    ds_read_b64_tr_b16 v[40:41], v10 offset:51200
    v_max3_f32 v12, v12, v237, v238
    v_mfma_f32_16x16x32_bf16 v[144:147], v[52:55], a[16:19], v[144:147]
    ds_read_b64_tr_b16 v[42:43], v10 offset:51712
    v_max_f32 v12, v12, v239
    v_mfma_f32_16x16x32_bf16 v[148:151], v[48:51], a[4:7], 0
    ds_read_b64_tr_b16 v[44:45], v10 offset:59392
    v_mul_f32 v12, s98, v12
    v_mfma_f32_16x16x32_bf16 v[148:151], v[52:55], a[20:23], v[148:151]
    ds_read_b64_tr_b16 v[46:47], v10 offset:59904
    v_fma_f32 v224, v224, s97, v12
    v_mfma_f32_16x16x32_bf16 v[152:155], v[48:51], a[8:11], 0
    v_exp_f32 v224, v224
    v_mfma_f32_16x16x32_bf16 v[152:155], v[52:55], a[24:27], v[152:155]
    v_fma_f32 v225, v225, s97, v12
    v_fma_f32 v226, v226, s97, v12
    v_mfma_f32_16x16x32_bf16 v[156:159], v[48:51], a[12:15], 0
    buffer_load_dwordx4 v4, s[52:55], s99 offen offset:3072 lds
    v_fma_f32 v227, v227, s97, v12
    v_mfma_f32_16x16x32_bf16 v[156:159], v[52:55], a[28:31], v[156:159]
    s_waitcnt vmcnt(9) lgkmcnt(4)
    s_barrier
    v_fma_f32 v228, v228, s97, v12
    v_mfma_f32_16x16x32_bf16 v[160:163], v[32:35], a[0:3], 0
    ds_read_b64_tr_b16 v[48:49], v7 offset:16384
    s_add_u32 m0, s96, 0
    v_mfma_f32_16x16x32_bf16 v[160:163], v[36:39], a[16:19], v[160:163]
    ds_read_b64_tr_b16 v[50:51], v7 offset:16896
    s_add_u32 s99, s5, 4
    v_mfma_f32_16x16x32_bf16 v[164:167], v[32:35], a[4:7], 0
    s_and_b32 s99, s99, 7
    s_mul_i32 s99, s99, 229376
    buffer_load_dwordx4 v3, s[48:51], s99 offen offset:0 lds
    v_mfma_f32_16x16x32_bf16 v[164:167], v[36:39], a[20:23], v[164:167]
    ds_read_b64_tr_b16 v[52:53], v7 offset:24576
    v_fma_f32 v229, v229, s97, v12
    v_mfma_f32_16x16x32_bf16 v[168:171], v[32:35], a[8:11], 0
    buffer_load_dwordx4 v4, s[48:51], s99 offen offset:1024 lds
    v_fma_f32 v230, v230, s97, v12
    v_mfma_f32_16x16x32_bf16 v[168:171], v[36:39], a[24:27], v[168:171]
    ds_read_b64_tr_b16 v[54:55], v7 offset:25088
    v_fma_f32 v231, v231, s97, v12
    v_mfma_f32_16x16x32_bf16 v[172:175], v[32:35], a[12:15], 0
    buffer_load_dwordx4 v3, s[52:55], s99 offen offset:2048 lds
    v_fma_f32 v232, v232, s97, v12
    v_mfma_f32_16x16x32_bf16 v[172:175], v[36:39], a[28:31], v[172:175]
    s_waitcnt lgkmcnt(4)
    v_exp_f32 v225, v225
    v_mfma_f32_16x16x32_bf16 v[176:179], v[40:43], a[0:3], 0
    ds_read_b64_tr_b16 v[32:33], v8 offset:16384
    v_fma_f32 v233, v233, s97, v12
    v_mfma_f32_16x16x32_bf16 v[176:179], v[44:47], a[16:19], v[176:179]
    ds_read_b64_tr_b16 v[34:35], v8 offset:16896
    v_fma_f32 v234, v234, s97, v12
    v_mfma_f32_16x16x32_bf16 v[180:183], v[40:43], a[4:7], 0
    ds_read_b64_tr_b16 v[36:37], v8 offset:24576
    v_fma_f32 v235, v235, s97, v12
    v_mfma_f32_16x16x32_bf16 v[180:183], v[44:47], a[20:23], v[180:183]
    buffer_load_dwordx4 v4, s[52:55], s99 offen offset:3072 lds
    v_fma_f32 v236, v236, s97, v12
    v_mfma_f32_16x16x32_bf16 v[184:187], v[40:43], a[8:11], 0
    ds_read_b64_tr_b16 v[38:39], v8 offset:25088
    v_fma_f32 v237, v237, s97, v12
    v_mfma_f32_16x16x32_bf16 v[184:187], v[44:47], a[24:27], v[184:187]
    v_exp_f32 v226, v226
    v_mfma_f32_16x16x32_bf16 v[188:191], v[40:43], a[12:15], 0
    buffer_store_dwordx4 v[216:219], v16, s[72:75], s8 offen sc1
    v_fma_f32 v238, v238, s97, v12
    v_mfma_f32_16x16x32_bf16 v[188:191], v[44:47], a[28:31], v[188:191]
    s_waitcnt lgkmcnt(4)
    v_exp_f32 v227, v227
    v_mfma_f32_16x16x32_bf16 v[128:131], v[48:51], a[32:35], v[128:131]
    ds_read_b64_tr_b16 v[40:41], v7 offset:18432
    v_fma_f32 v239, v239, s97, v12
    v_mfma_f32_16x16x32_bf16 v[128:131], v[52:55], a[48:51], v[128:131]
    ds_read_b64_tr_b16 v[42:43], v7 offset:18944
    v_add_f32 v13, v224, v225
    v_mfma_f32_16x16x32_bf16 v[132:135], v[48:51], a[36:39], v[132:135]
    ds_read_b64_tr_b16 v[44:45], v7 offset:26624
    v_add_f32 v13, v13, v226
    v_mfma_f32_16x16x32_bf16 v[132:135], v[52:55], a[52:55], v[132:135]
    buffer_store_dwordx4 v[216:219], v17, s[72:75], s8 offen sc1
    v_add_f32 v13, v13, v227
    v_mfma_f32_16x16x32_bf16 v[136:139], v[48:51], a[40:43], v[136:139]
    ds_read_b64_tr_b16 v[46:47], v7 offset:27136
    v_permlane16_swap_b32 v81, v83
    v_mfma_f32_16x16x32_bf16 v[136:139], v[52:55], a[56:59], v[136:139]
    v_exp_f32 v228, v228
    v_mfma_f32_16x16x32_bf16 v[140:143], v[48:51], a[44:47], v[140:143]
    buffer_store_dwordx4 v[216:219], v16, s[72:75], s9 offen sc1
    v_add_f32 v13, v13, v228
    v_mfma_f32_16x16x32_bf16 v[140:143], v[52:55], a[60:63], v[140:143]
    s_waitcnt lgkmcnt(4)
    v_exp_f32 v229, v229
    v_mfma_f32_16x16x32_bf16 v[144:147], v[32:35], a[32:35], v[144:147]
    ds_read_b64_tr_b16 v[48:49], v8 offset:18432
    v_add_f32 v13, v13, v229
    v_mfma_f32_16x16x32_bf16 v[144:147], v[36:39], a[48:51], v[144:147]
    ds_read_b64_tr_b16 v[50:51], v8 offset:18944
    v_max3_f32 v12, v240, v241, v242
    v_mfma_f32_16x16x32_bf16 v[148:151], v[32:35], a[36:39], v[148:151]
    ds_read_b64_tr_b16 v[52:53], v8 offset:26624
    v_max3_f32 v12, v12, v243, v244
    v_mfma_f32_16x16x32_bf16 v[148:151], v[36:39], a[52:55], v[148:151]
    buffer_store_dwordx4 v[216:219], v17, s[72:75], s9 offen sc1
    v_max3_f32 v12, v12, v245, v246
    v_mfma_f32_16x16x32_bf16 v[152:155], v[32:35], a[40:43], v[152:155]
    ds_read_b64_tr_b16 v[54:55], v8 offset:27136
    v_max3_f32 v12, v12, v247, v248
    v_mfma_f32_16x16x32_bf16 v[152:155], v[36:39], a[56:59], v[152:155]
    v_exp_f32 v230, v230
    v_mfma_f32_16x16x32_bf16 v[156:159], v[32:35], a[44:47], v[156:159]
    buffer_store_dwordx2 v[216:217], v25, s[72:75], s13 offen sc1
    v_add_f32 v13, v13, v230
    v_mfma_f32_16x16x32_bf16 v[156:159], v[36:39], a[60:63], v[156:159]
    s_waitcnt vmcnt(14) lgkmcnt(4)
    s_barrier
    v_max3_f32 v12, v12, v249, v250
    v_mfma_f32_16x16x32_bf16 v[160:163], v[40:43], a[32:35], v[160:163]
    ds_read_b64_tr_b16 v[32:33], v7 offset:49152
    s_add_u32 m0, s96, 65536
    v_mfma_f32_16x16x32_bf16 v[160:163], v[44:47], a[48:51], v[160:163]
    ds_read_b64_tr_b16 v[34:35], v7 offset:49664
    s_add_u32 s99, s5, 5
    v_mfma_f32_16x16x32_bf16 v[164:167], v[40:43], a[36:39], v[164:167]
    ds_read_b64_tr_b16 v[36:37], v7 offset:57344
    s_and_b32 s99, s99, 7
    v_mfma_f32_16x16x32_bf16 v[164:167], v[44:47], a[52:55], v[164:167]
    s_mul_i32 s99, s99, 229376
    buffer_load_dwordx4 v3, s[48:51], s99 offen offset:0 lds
    v_mfma_f32_16x16x32_bf16 v[168:171], v[40:43], a[40:43], v[168:171]
    ds_read_b64_tr_b16 v[38:39], v7 offset:57856
    v_max3_f32 v12, v12, v251, v252
    v_mfma_f32_16x16x32_bf16 v[168:171], v[44:47], a[56:59], v[168:171]
    v_exp_f32 v231, v231
    v_mfma_f32_16x16x32_bf16 v[172:175], v[40:43], a[44:47], v[172:175]
    buffer_load_dwordx4 v4, s[48:51], s99 offen offset:1024 lds
    v_add_f32 v13, v13, v231
    v_mfma_f32_16x16x32_bf16 v[172:175], v[44:47], a[60:63], v[172:175]
    s_waitcnt lgkmcnt(4)
    v_exp_f32 v232, v232
    v_mfma_f32_16x16x32_bf16 v[176:179], v[48:51], a[32:35], v[176:179]
    ds_read_b64_tr_b16 v[40:41], v8 offset:49152
    v_add_f32 v13, v13, v232
    v_mfma_f32_16x16x32_bf16 v[176:179], v[52:55], a[48:51], v[176:179]
    ds_read_b64_tr_b16 v[42:43], v8 offset:49664
    v_max3_f32 v12, v12, v253, v254
    v_mfma_f32_16x16x32_bf16 v[180:183], v[48:51], a[36:39], v[180:183]
    ds_read_b64_tr_b16 v[44:45], v8 offset:57344
    v_max_f32 v12, v12, v255
    v_mfma_f32_16x16x32_bf16 v[180:183], v[52:55], a[52:55], v[180:183]
    buffer_load_dwordx4 v3, s[52:55], s99 offen offset:2048 lds
    v_mul_f32 v12, s98, v12
    v_mfma_f32_16x16x32_bf16 v[184:187], v[48:51], a[40:43], v[184:187]
    ds_read_b64_tr_b16 v[46:47], v8 offset:57856
    v_fma_f32 v240, v240, s97, v12
    v_mfma_f32_16x16x32_bf16 v[184:187], v[52:55], a[56:59], v[184:187]
    v_exp_f32 v233, v233
    v_mfma_f32_16x16x32_bf16 v[188:191], v[48:51], a[44:47], v[188:191]
    buffer_load_dwordx4 v4, s[52:55], s99 offen offset:3072 lds
    s_add_u32 m0, s96, 81920
    v_mfma_f32_16x16x32_bf16 v[188:191], v[52:55], a[60:63], v[188:191]
    s_waitcnt lgkmcnt(4)
    v_exp_f32 v234, v234
    v_mfma_f32_16x16x32_bf16 v[128:131], v[32:35], a[64:67], v[128:131]
    ds_read_b64_tr_b16 v[48:49], v7 offset:51200
    s_add_u32 s99, s5, 6
    v_mfma_f32_16x16x32_bf16 v[128:131], v[36:39], a[80:83], v[128:131]
    ds_read_b64_tr_b16 v[50:51], v7 offset:51712
    s_and_b32 s99, s99, 7
    v_mfma_f32_16x16x32_bf16 v[132:135], v[32:35], a[68:71], v[132:135]
    ds_read_b64_tr_b16 v[52:53], v7 offset:59392
    s_mul_i32 s99, s99, 229376
    v_mfma_f32_16x16x32_bf16 v[132:135], v[36:39], a[84:87], v[132:135]
    buffer_load_dwordx4 v3, s[48:51], s99 offen offset:0 lds
    v_add_f32 v13, v13, v233
    v_mfma_f32_16x16x32_bf16 v[136:139], v[32:35], a[72:75], v[136:139]
    ds_read_b64_tr_b16 v[54:55], v7 offset:59904
    v_add_f32 v13, v13, v234
    v_mfma_f32_16x16x32_bf16 v[136:139], v[36:39], a[88:91], v[136:139]
    v_exp_f32 v235, v235
    v_mfma_f32_16x16x32_bf16 v[140:143], v[32:35], a[76:79], v[140:143]
    buffer_load_dwordx4 v4, s[48:51], s99 offen offset:1024 lds
    v_add_f32 v13, v13, v235
    v_mfma_f32_16x16x32_bf16 v[140:143], v[36:39], a[92:95], v[140:143]
    s_waitcnt lgkmcnt(4)
    v_exp_f32 v236, v236
    v_mfma_f32_16x16x32_bf16 v[144:147], v[40:43], a[64:67], v[144:147]
    ds_read_b64_tr_b16 v[32:33], v8 offset:51200
    v_add_f32 v13, v13, v236
    v_mfma_f32_16x16x32_bf16 v[144:147], v[44:47], a[80:83], v[144:147]
    ds_read_b64_tr_b16 v[34:35], v8 offset:51712
    v_fma_f32 v241, v241, s97, v12
    v_mfma_f32_16x16x32_bf16 v[148:151], v[40:43], a[68:71], v[148:151]
    ds_read_b64_tr_b16 v[36:37], v8 offset:59392
    v_fma_f32 v242, v242, s97, v12
    v_mfma_f32_16x16x32_bf16 v[148:151], v[44:47], a[84:87], v[148:151]
    buffer_load_dwordx4 v3, s[52:55], s99 offen offset:2048 lds
    v_fma_f32 v243, v243, s97, v12
    v_mfma_f32_16x16x32_bf16 v[152:155], v[40:43], a[72:75], v[152:155]
    ds_read_b64_tr_b16 v[38:39], v8 offset:59904
    v_fma_f32 v244, v244, s97, v12
    v_mfma_f32_16x16x32_bf16 v[152:155], v[44:47], a[88:91], v[152:155]
    v_exp_f32 v237, v237
    v_mfma_f32_16x16x32_bf16 v[156:159], v[40:43], a[76:79], v[156:159]
    buffer_load_dwordx4 v4, s[52:55], s99 offen offset:3072 lds
    v_add_f32 v13, v13, v237
    v_mfma_f32_16x16x32_bf16 v[156:159], v[44:47], a[92:95], v[156:159]
    s_waitcnt vmcnt(17) lgkmcnt(4)
    s_barrier
    v_fma_f32 v245, v245, s97, v12
    v_and_b32 v23, 15, v0
    v_lshlrev_b32 v23, 2, v23
    v_mfma_f32_16x16x32_bf16 v[160:163], v[48:51], a[64:67], v[160:163]
    ds_read_b64_tr_b16 v[40:41], v7 offset:32768
    v_fma_f32 v246, v246, s97, v12
    v_mfma_f32_16x16x32_bf16 v[160:163], v[52:55], a[80:83], v[160:163]
    ds_read_b64_tr_b16 v[42:43], v7 offset:33280
    v_fma_f32 v247, v247, s97, v12
    v_mfma_f32_16x16x32_bf16 v[164:167], v[48:51], a[68:71], v[164:167]
    buffer_load_dword v21, v23, s[80:83], 0 offen offset:64 sc1
    s_add_u32 m0, s96, 16384
    v_mfma_f32_16x16x32_bf16 v[164:167], v[52:55], a[84:87], v[164:167]
    ds_read_b64_tr_b16 v[44:45], v7 offset:40960
    s_add_u32 s99, s5, 7
    v_mfma_f32_16x16x32_bf16 v[168:171], v[48:51], a[72:75], v[168:171]
    s_and_b32 s99, s99, 7
    s_mul_i32 s99, s99, 229376
    buffer_load_dwordx4 v3, s[48:51], s99 offen offset:0 lds
    v_mfma_f32_16x16x32_bf16 v[168:171], v[52:55], a[88:91], v[168:171]
    ds_read_b64_tr_b16 v[46:47], v7 offset:41472
    v_fma_f32 v248, v248, s97, v12
    v_mfma_f32_16x16x32_bf16 v[172:175], v[48:51], a[76:79], v[172:175]
    buffer_load_dwordx4 v4, s[48:51], s99 offen offset:1024 lds
    v_fma_f32 v249, v249, s97, v12
    v_mfma_f32_16x16x32_bf16 v[172:175], v[52:55], a[92:95], v[172:175]
    s_waitcnt lgkmcnt(4)
    v_exp_f32 v238, v238
    v_mfma_f32_16x16x32_bf16 v[176:179], v[32:35], a[64:67], v[176:179]
    ds_read_b64_tr_b16 v[48:49], v8 offset:32768
    v_add_f32 v13, v13, v238
    v_mfma_f32_16x16x32_bf16 v[176:179], v[36:39], a[80:83], v[176:179]
    ds_read_b64_tr_b16 v[50:51], v8 offset:33280
    v_fma_f32 v250, v250, s97, v12
    v_mfma_f32_16x16x32_bf16 v[180:183], v[32:35], a[68:71], v[180:183]
    ds_read_b64_tr_b16 v[52:53], v8 offset:40960
    v_fma_f32 v251, v251, s97, v12
    v_mfma_f32_16x16x32_bf16 v[180:183], v[36:39], a[84:87], v[180:183]
    buffer_load_dwordx4 v3, s[52:55], s99 offen offset:2048 lds
    v_fma_f32 v252, v252, s97, v12
    v_mfma_f32_16x16x32_bf16 v[184:187], v[32:35], a[72:75], v[184:187]
    ds_read_b64_tr_b16 v[54:55], v8 offset:41472
    v_fma_f32 v253, v253, s97, v12
    v_mfma_f32_16x16x32_bf16 v[184:187], v[36:39], a[88:91], v[184:187]
    v_exp_f32 v239, v239
    v_mfma_f32_16x16x32_bf16 v[188:191], v[32:35], a[76:79], v[188:191]
    buffer_load_dwordx4 v4, s[52:55], s99 offen offset:3072 lds
    s_add_u32 m0, s96, 98304
    v_mfma_f32_16x16x32_bf16 v[188:191], v[36:39], a[92:95], v[188:191]
    s_waitcnt lgkmcnt(4)
    v_exp_f32 v240, v240
    v_mfma_f32_16x16x32_bf16 v[128:131], v[40:43], a[96:99], v[128:131]
    ds_read_b64_tr_b16 v[32:33], v7 offset:34816
    s_add_u32 s99, s5, 0
    v_mfma_f32_16x16x32_bf16 v[128:131], v[44:47], a[112:115], v[128:131]
    ds_read_b64_tr_b16 v[34:35], v7 offset:35328
    s_and_b32 s99, s99, 7
    v_mfma_f32_16x16x32_bf16 v[132:135], v[40:43], a[100:103], v[132:135]
    ds_read_b64_tr_b16 v[36:37], v7 offset:43008
    s_mul_i32 s99, s99, 196608
    v_mfma_f32_16x16x32_bf16 v[132:135], v[44:47], a[116:119], v[132:135]
    buffer_load_dwordx4 v1, s[40:43], s99 offen offset:0 lds
    v_add_f32 v13, v13, v239
    v_mfma_f32_16x16x32_bf16 v[136:139], v[40:43], a[104:107], v[136:139]
    ds_read_b64_tr_b16 v[38:39], v7 offset:43520
    v_fma_f32 v254, v254, s97, v12
    v_mfma_f32_16x16x32_bf16 v[136:139], v[44:47], a[120:123], v[136:139]
    v_rcp_f32 v13, v13
    v_mfma_f32_16x16x32_bf16 v[140:143], v[40:43], a[108:111], v[140:143]
    buffer_load_dwordx4 v2, s[40:43], s99 offen offset:1024 lds
    v_mul_f32 v224, v224, v13
    v_mfma_f32_16x16x32_bf16 v[140:143], v[44:47], a[124:127], v[140:143]
    s_waitcnt lgkmcnt(4)
    v_exp_f32 v241, v241
    v_mfma_f32_16x16x32_bf16 v[144:147], v[48:51], a[96:99], v[144:147]
    ds_read_b64_tr_b16 v[40:41], v8 offset:34816
    v_mul_f32 v225, v225, v13
    v_mfma_f32_16x16x32_bf16 v[144:147], v[52:55], a[112:115], v[144:147]
    ds_read_b64_tr_b16 v[42:43], v8 offset:35328
    v_mul_f32 v226, v226, v13
    v_mfma_f32_16x16x32_bf16 v[148:151], v[48:51], a[100:103], v[148:151]
    ds_read_b64_tr_b16 v[44:45], v8 offset:43008
    v_mul_f32 v227, v227, v13
    v_mfma_f32_16x16x32_bf16 v[148:151], v[52:55], a[116:119], v[148:151]
    buffer_load_dwordx4 v1, s[44:47], s99 offen offset:2048 lds
    v_mul_f32 v228, v228, v13
    v_mfma_f32_16x16x32_bf16 v[152:155], v[48:51], a[104:107], v[152:155]
    ds_read_b64_tr_b16 v[46:47], v8 offset:43520
    v_mul_f32 v229, v229, v13
    v_mfma_f32_16x16x32_bf16 v[152:155], v[52:55], a[120:123], v[152:155]
    v_exp_f32 v242, v242
    v_mfma_f32_16x16x32_bf16 v[156:159], v[48:51], a[108:111], v[156:159]
    buffer_load_dwordx4 v2, s[44:47], s99 offen offset:3072 lds
    v_mul_f32 v230, v230, v13
    v_mfma_f32_16x16x32_bf16 v[156:159], v[52:55], a[124:127], v[156:159]
    s_waitcnt vmcnt(22) lgkmcnt(4)
    s_barrier
    v_mul_f32 v231, v231, v13
    v_mfma_f32_16x16x32_bf16 v[160:163], v[32:35], a[96:99], v[160:163]
    ds_read_b64_tr_b16 v[48:49], v7 offset:0
    s_mov_b32 s99, 0
    v_mfma_f32_16x16x32_bf16 v[160:163], v[36:39], a[112:115], v[160:163]
    ds_read_b64_tr_b16 v[50:51], v7 offset:512
    v_mul_f32 v232, v232, v13
    v_mfma_f32_16x16x32_bf16 v[164:167], v[32:35], a[100:103], v[164:167]
    ds_read_b64_tr_b16 v[52:53], v7 offset:8192
    v_mul_f32 v233, v233, v13
    v_mfma_f32_16x16x32_bf16 v[164:167], v[36:39], a[116:119], v[164:167]
    buffer_load_dword v18, v19, s[56:59], s99 offen offset:0
    s_mov_b32 s99, 917504
    v_mfma_f32_16x16x32_bf16 v[168:171], v[32:35], a[104:107], v[168:171]
    ds_read_b64_tr_b16 v[54:55], v7 offset:8704
    v_mul_f32 v234, v234, v13
    v_mfma_f32_16x16x32_bf16 v[168:171], v[36:39], a[120:123], v[168:171]
    v_exp_f32 v243, v243
    v_mfma_f32_16x16x32_bf16 v[172:175], v[32:35], a[108:111], v[172:175]
    buffer_load_dword v18, v19, s[56:59], s99 offen offset:0
    s_mov_b32 s99, 0
    v_mfma_f32_16x16x32_bf16 v[172:175], v[36:39], a[124:127], v[172:175]
    s_waitcnt lgkmcnt(4)
    v_exp_f32 v244, v244
    v_mfma_f32_16x16x32_bf16 v[176:179], v[40:43], a[96:99], v[176:179]
    ds_read_b64_tr_b16 v[32:33], v8 offset:0
    v_mul_f32 v235, v235, v13
    v_mfma_f32_16x16x32_bf16 v[176:179], v[44:47], a[112:115], v[176:179]
    ds_read_b64_tr_b16 v[34:35], v8 offset:512
    v_mul_f32 v236, v236, v13
    v_mfma_f32_16x16x32_bf16 v[180:183], v[40:43], a[100:103], v[180:183]
    ds_read_b64_tr_b16 v[36:37], v8 offset:8192
    v_mul_f32 v237, v237, v13
    v_mfma_f32_16x16x32_bf16 v[180:183], v[44:47], a[116:119], v[180:183]
    buffer_load_dword v18, v19, s[64:67], s99 offen offset:0
    s_add_u32 m0, s96, 49152
    v_mfma_f32_16x16x32_bf16 v[184:187], v[40:43], a[104:107], v[184:187]
    ds_read_b64_tr_b16 v[38:39], v8 offset:8704
    s_add_u32 s99, s5, 2
    v_mfma_f32_16x16x32_bf16 v[184:187], v[44:47], a[120:123], v[184:187]
    s_and_b32 s99, s99, 7
    v_exp_f32 v245, v245
    v_mfma_f32_16x16x32_bf16 v[188:191], v[40:43], a[108:111], v[188:191]
    s_mul_i32 s99, s99, 196608
    buffer_load_dwordx4 v1, s[40:43], s99 offen offset:0 lds
    v_mfma_f32_16x16x32_bf16 v[188:191], v[44:47], a[124:127], v[188:191]
    s_waitcnt lgkmcnt(4)
    v_exp_f32 v246, v246
    v_mfma_f32_16x16x32_bf16 v[128:131], v[48:51], a[128:131], v[128:131]
    ds_read_b64_tr_b16 v[40:41], v7 offset:2048
    v_lshrrev_b32 v3, 2, v0
    v_mfma_f32_16x16x32_bf16 v[128:131], v[52:55], a[144:147], v[128:131]
    ds_read_b64_tr_b16 v[42:43], v7 offset:2560
    v_lshrrev_b32 v4, 4, v0
    v_mfma_f32_16x16x32_bf16 v[132:135], v[48:51], a[132:135], v[132:135]
    ds_read_b64_tr_b16 v[44:45], v7 offset:10240
    v_and_b32 v4, 2, v4
    v_mfma_f32_16x16x32_bf16 v[132:135], v[52:55], a[148:151], v[132:135]
    buffer_load_dwordx4 v2, s[40:43], s99 offen offset:1024 lds
    v_xor_b32 v4, v4, v0
    v_mfma_f32_16x16x32_bf16 v[136:139], v[48:51], a[136:139], v[136:139]
    ds_read_b64_tr_b16 v[46:47], v7 offset:10752
    v_and_b32 v4, 3, v4
    v_mfma_f32_16x16x32_bf16 v[136:139], v[52:55], a[152:155], v[136:139]
    s_mul_i32 s34, s3, 192
    s_sub_u32 s34, 128, s34
    s_ashr_i32 s38, s34, 31
    v_mfma_f32_16x16x32_bf16 v[140:143], v[48:51], a[140:143], v[140:143]
    buffer_load_dwordx4 v1, s[44:47], s99 offen offset:2048 lds
    v_mul_f32 v238, v238, v13
    v_mfma_f32_16x16x32_bf16 v[140:143], v[52:55], a[156:159], v[140:143]
    s_waitcnt lgkmcnt(4)
    v_exp_f32 v247, v247
    v_mfma_f32_16x16x32_bf16 v[144:147], v[32:35], a[128:131], v[144:147]
    ds_read_b64_tr_b16 v[48:49], v8 offset:2048
    v_mul_f32 v239, v239, v13
    v_mfma_f32_16x16x32_bf16 v[144:147], v[36:39], a[144:147], v[144:147]
    ds_read_b64_tr_b16 v[50:51], v8 offset:2560
    v_cvt_pk_bf16_f32 v224, v224, v225
    v_mfma_f32_16x16x32_bf16 v[148:151], v[32:35], a[132:135], v[148:151]
    ds_read_b64_tr_b16 v[52:53], v8 offset:10240
    v_cvt_pk_bf16_f32 v225, v226, v227
    v_mfma_f32_16x16x32_bf16 v[148:151], v[36:39], a[148:151], v[148:151]
    ds_read_b64_tr_b16 v[54:55], v8 offset:10752
    v_cvt_pk_bf16_f32 v226, v228, v229
    v_mfma_f32_16x16x32_bf16 v[152:155], v[32:35], a[136:139], v[152:155]
    s_add_u32 s32, s48, s34
    s_addc_u32 s33, s49, s38
    v_cvt_pk_bf16_f32 v227, v230, v231
    v_mfma_f32_16x16x32_bf16 v[152:155], v[36:39], a[152:155], v[152:155]
    ds_write_b128 v14, v[224:227]
    v_cvt_pk_bf16_f32 v228, v232, v233
    v_mfma_f32_16x16x32_bf16 v[156:159], v[32:35], a[140:143], v[156:159]
    buffer_load_dwordx4 v2, s[44:47], s99 offen offset:3072 lds
    v_cvt_pk_bf16_f32 v229, v234, v235
    v_mfma_f32_16x16x32_bf16 v[156:159], v[36:39], a[156:159], v[156:159]
    s_waitcnt vmcnt(20) lgkmcnt(5)
    s_barrier
    v_cvt_pk_bf16_f32 v230, v236, v237
    v_mfma_f32_16x16x32_bf16 v[160:163], v[40:43], a[128:131], v[160:163]
    ds_read_b64_tr_b16 v[32:33], v9 offset:0
    s_add_u32 m0, s96, 32768
    v_mfma_f32_16x16x32_bf16 v[160:163], v[44:47], a[144:147], v[160:163]
    ds_read_b64_tr_b16 v[34:35], v9 offset:512
    s_add_u32 s99, s5, 4
    v_mfma_f32_16x16x32_bf16 v[164:167], v[40:43], a[132:135], v[164:167]
    ds_read_b64_tr_b16 v[36:37], v9 offset:8192
    s_and_b32 s99, s99, 7
    v_mfma_f32_16x16x32_bf16 v[164:167], v[44:47], a[148:151], v[164:167]
    ds_read_b64_tr_b16 v[38:39], v9 offset:8704
    s_mul_i32 s99, s99, 196608
    v_mfma_f32_16x16x32_bf16 v[168:171], v[40:43], a[136:139], v[168:171]
    s_add_u32 s36, s52, s34
    s_addc_u32 s37, s53, s38
    v_cvt_pk_bf16_f32 v231, v238, v239
    v_mfma_f32_16x16x32_bf16 v[168:171], v[44:47], a[152:155], v[168:171]
    ds_write_b128 v14, v[228:231] offset:16
    v_fma_f32 v255, v255, s97, v12
    v_mfma_f32_32x32x16_bf16 v[224:239], v[60:63], v[80:83], 0
    ds_read_b64_tr_b16 v[64:65], v15 offset:0
    v_exp_f32 v248, v248
    v_exp_f32 v249, v249
    v_add_f32 v13, v240, v241
    v_mfma_f32_16x16x32_bf16 v[172:175], v[40:43], a[140:143], v[172:175]
    buffer_load_dwordx4 v1, s[40:43], s99 offen offset:0 lds
    v_add_f32 v13, v13, v242
    v_mfma_f32_16x16x32_bf16 v[172:175], v[44:47], a[156:159], v[172:175]
    s_waitcnt lgkmcnt(7)
    v_exp_f32 v250, v250
    v_mfma_f32_16x16x32_bf16 v[176:179], v[48:51], a[128:131], v[176:179]
    ds_read_b64_tr_b16 v[40:41], v10 offset:0
    v_add_f32 v13, v13, v243
    v_mfma_f32_16x16x32_bf16 v[176:179], v[52:55], a[144:147], v[176:179]
    ds_read_b64_tr_b16 v[42:43], v10 offset:512
    v_add_f32 v13, v13, v244
    v_mfma_f32_16x16x32_bf16 v[180:183], v[48:51], a[132:135], v[180:183]
    ds_read_b64_tr_b16 v[44:45], v10 offset:8192
    v_add_f32 v13, v13, v245
    v_mfma_f32_16x16x32_bf16 v[180:183], v[52:55], a[148:151], v[180:183]
    ds_read_b64_tr_b16 v[46:47], v10 offset:8704
    v_add_f32 v13, v13, v246
    v_mfma_f32_16x16x32_bf16 v[184:187], v[48:51], a[136:139], v[184:187]
    ds_read_b64_tr_b16 v[66:67], v15 offset:512
    v_add_f32 v13, v13, v247
    v_mfma_f32_16x16x32_bf16 v[184:187], v[52:55], a[152:155], v[184:187]
    ds_read_b64_tr_b16 v[68:69], v15 offset:1024
    v_add_f32 v13, v13, v248
    v_mfma_f32_16x16x32_bf16 v[188:191], v[48:51], a[140:143], v[188:191]
    buffer_load_dwordx4 v2, s[40:43], s99 offen offset:1024 lds
    v_add_f32 v13, v13, v249
    v_mfma_f32_16x16x32_bf16 v[188:191], v[52:55], a[156:159], v[188:191]
    s_waitcnt lgkmcnt(8)
    v_exp_f32 v251, v251
    v_mfma_f32_16x16x32_bf16 v[128:131], v[32:35], a[160:163], v[128:131]
    ds_read_b64_tr_b16 v[48:49], v9 offset:2048
    v_add_f32 v13, v13, v250
    v_mfma_f32_16x16x32_bf16 v[128:131], v[36:39], a[176:179], v[128:131]
    ds_read_b64_tr_b16 v[50:51], v9 offset:2560
    v_add_f32 v13, v13, v251
    v_mfma_f32_16x16x32_bf16 v[132:135], v[32:35], a[164:167], v[132:135]
    ds_read_b64_tr_b16 v[52:53], v9 offset:10240
    v_cvt_pk_bf16_f32 v88, v88, v89
    v_mfma_f32_16x16x32_bf16 v[132:135], v[36:39], a[180:183], v[132:135]
    ds_read_b64_tr_b16 v[54:55], v9 offset:10752
    v_cvt_pk_bf16_f32 v89, v90, v91
    v_mfma_f32_16x16x32_bf16 v[136:139], v[32:35], a[168:171], v[136:139]
    ds_read_b64_tr_b16 v[70:71], v15 offset:1536
    v_cvt_pk_bf16_f32 v90, v92, v93
    s_waitcnt lgkmcnt(6)
    v_mfma_f32_16x16x32_bf16 v[200:203], v[64:67], v[28:31], 0
    s_add_u32 s36, s36, 1024
    s_addc_u32 s37, s37, 0
    v_cvt_pk_bf16_f32 v91, v94, v95
    v_mfma_f32_16x16x32_bf16 v[136:139], v[36:39], a[184:187], v[136:139]
    s_sub_u32 s34, s50, s34
    s_add_u32 s38, s34, 1024
    v_permlane16_swap_b32 v88, v90
    v_mfma_f32_16x16x32_bf16 v[140:143], v[32:35], a[172:175], v[140:143]
    buffer_load_dwordx4 v1, s[44:47], s99 offen offset:2048 lds
    v_permlane16_swap_b32 v89, v91
    v_mfma_f32_16x16x32_bf16 v[140:143], v[36:39], a[188:191], v[140:143]
    v_exp_f32 v252, v252
    s_lshl_b32 s100, s88, 4
    v_add_u32 v3, s100, v3
    v_mul_u32_u24 v3, 3584, v3
    v_lshl_add_u32 v3, v4, 4, v3
    v_add_u32 v4, 227328, v3
    v_mfma_f32_16x16x32_bf16 v[144:147], v[40:43], a[160:163], v[144:147]
    ds_read_b64_tr_b16 v[32:33], v10 offset:2048
    v_add_f32 v13, v13, v252
    v_mfma_f32_16x16x32_bf16 v[144:147], v[44:47], a[176:179], v[144:147]
    ds_read_b64_tr_b16 v[34:35], v10 offset:2560
    v_max3_f32 v12, v224, v225, v226
    v_mfma_f32_16x16x32_bf16 v[148:151], v[40:43], a[164:167], v[148:151]
    ds_read_b64_tr_b16 v[36:37], v10 offset:10240
    v_max3_f32 v12, v12, v227, v228
    s_waitcnt lgkmcnt(3)
    v_mfma_f32_16x16x32_bf16 v[204:207], v[68:71], v[28:31], 0
    v_exp_f32 v253, v253
    v_mfma_f32_16x16x32_bf16 v[148:151], v[44:47], a[180:183], v[148:151]
    ds_read_b64_tr_b16 v[38:39], v10 offset:10752
    v_add_f32 v13, v13, v253
    v_mfma_f32_16x16x32_bf16 v[152:155], v[40:43], a[168:171], v[152:155]
    v_exp_f32 v254, v254
    v_mfma_f32_16x16x32_bf16 v[152:155], v[44:47], a[184:187], v[152:155]
    v_exp_f32 v255, v255
    v_mfma_f32_16x16x32_bf16 v[156:159], v[40:43], a[172:175], v[156:159]
    buffer_load_dwordx4 v2, s[44:47], s99 offen offset:3072 lds
    v_add_f32 v13, v13, v254
    v_mfma_f32_16x16x32_bf16 v[156:159], v[44:47], a[188:191], v[156:159]
    s_waitcnt vmcnt(20)
    s_barrier
    v_add_f32 v13, v13, v255
    s_waitcnt vmcnt(19)
    v_cmp_gt_u32 vcc, 1, v21
    s_nop 0
    s_cbranch_vccnz L_slowA0
L_okA0:
    v_mfma_f32_16x16x32_bf16 v[160:163], v[48:51], a[160:163], v[160:163]
    ds_read_b64_tr_b16 v[40:41], v9 offset:16384
    s_add_u32 m0, s96, 0
    v_mfma_f32_16x16x32_bf16 v[160:163], v[52:55], a[176:179], v[160:163]
    ds_read_b64_tr_b16 v[42:43], v9 offset:16896
    s_add_u32 s99, s5, 6
    v_mfma_f32_16x16x32_bf16 v[164:167], v[48:51], a[164:167], v[164:167]
    s_and_b32 s99, s99, 7
    s_mul_i32 s99, s99, 196608
    buffer_load_dwordx4 v1, s[40:43], s99 offen offset:0 lds
    v_mfma_f32_16x16x32_bf16 v[164:167], v[52:55], a[180:183], v[164:167]
    ds_read_b64_tr_b16 v[44:45], v9 offset:24576
    v_max3_f32 v12, v12, v229, v230
    v_mfma_f32_16x16x32_bf16 v[168:171], v[48:51], a[168:171], v[168:171]
    buffer_load_dwordx4 v2, s[40:43], s99 offen offset:1024 lds
    v_max3_f32 v12, v12, v231, v232
    v_mfma_f32_16x16x32_bf16 v[168:171], v[52:55], a[184:187], v[168:171]
    ds_read_b64_tr_b16 v[46:47], v9 offset:25088
    v_max3_f32 v12, v12, v233, v234
    v_mfma_f32_16x16x32_bf16 v[172:175], v[48:51], a[172:175], v[172:175]
    buffer_load_dwordx4 v1, s[44:47], s99 offen offset:2048 lds
    v_max3_f32 v12, v12, v235, v236
    v_mfma_f32_16x16x32_bf16 v[172:175], v[52:55], a[188:191], v[172:175]
    s_waitcnt lgkmcnt(4)
    v_rcp_f32 v13, v13
    v_mfma_f32_16x16x32_bf16 v[176:179], v[32:35], a[160:163], v[176:179]
    ds_read_b64_tr_b16 v[48:49], v10 offset:16384
    v_mul_f32 v240, v240, v13
    v_mfma_f32_16x16x32_bf16 v[176:179], v[36:39], a[176:179], v[176:179]
    ds_read_b64_tr_b16 v[50:51], v10 offset:16896
    v_mul_f32 v241, v241, v13
    v_mfma_f32_16x16x32_bf16 v[180:183], v[32:35], a[164:167], v[180:183]
    buffer_load_dwordx4 v2, s[44:47], s99 offen offset:3072 lds
    s_add_u32 m0, s96, 114688
    v_mfma_f32_16x16x32_bf16 v[180:183], v[36:39], a[180:183], v[180:183]
    ds_read_b64_tr_b16 v[52:53], v10 offset:24576
    s_add_u32 s99, s5, 0
    v_mfma_f32_16x16x32_bf16 v[184:187], v[32:35], a[168:171], v[184:187]
    s_and_b32 s99, s99, 7
    s_mul_i32 s99, s99, 229376
    buffer_load_dwordx4 v3, s[32:35], s99 offen offset:0 lds
    v_mfma_f32_16x16x32_bf16 v[184:187], v[36:39], a[184:187], v[184:187]
    ds_read_b64_tr_b16 v[54:55], v10 offset:25088
    v_mul_f32 v242, v242, v13
    v_mfma_f32_16x16x32_bf16 v[188:191], v[32:35], a[172:175], v[188:191]
    buffer_load_dwordx4 v3, s[36:39], s99 offen offset:1024 lds
    v_mul_f32 v243, v243, v13
    v_mfma_f32_16x16x32_bf16 v[188:191], v[36:39], a[188:191], v[188:191]
    s_waitcnt lgkmcnt(4)
    v_mul_f32 v244, v244, v13
    v_mul_f32 v245, v245, v13
    v_mfma_f32_16x16x32_bf16 v[128:131], v[40:43], a[192:195], v[128:131]
    ds_read_b64_tr_b16 v[32:33], v9 offset:18432
    v_mul_f32 v246, v246, v13
    v_mfma_f32_16x16x32_bf16 v[128:131], v[44:47], a[208:211], v[128:131]
    ds_read_b64_tr_b16 v[34:35], v9 offset:18944
    v_mul_f32 v247, v247, v13
    v_mfma_f32_16x16x32_bf16 v[132:135], v[40:43], a[196:199], v[132:135]
    buffer_load_dwordx4 v4, s[32:35], s99 offen offset:2048 lds
    v_mul_f32 v248, v248, v13
    v_mfma_f32_16x16x32_bf16 v[132:135], v[44:47], a[212:215], v[132:135]
    ds_read_b64_tr_b16 v[36:37], v9 offset:26624
    v_mul_f32 v249, v249, v13
    v_mfma_f32_16x16x32_bf16 v[136:139], v[40:43], a[200:203], v[136:139]
    buffer_load_dwordx4 v4, s[36:39], s99 offen offset:3072 lds
    v_mul_f32 v250, v250, v13
    v_mfma_f32_16x16x32_bf16 v[136:139], v[44:47], a[216:219], v[136:139]
    ds_read_b64_tr_b16 v[38:39], v9 offset:27136
    v_mul_f32 v251, v251, v13
    v_mfma_f32_16x16x32_bf16 v[140:143], v[40:43], a[204:207], v[140:143]
    s_lshr_b32 s100, s56, 7
    s_sub_u32 s100, 3, s100
    s_add_u32 s100, s100, s95
    s_and_b32 s100, s100, 7
    s_sub_u32 s100, s100, s95
    s_lshl_b32 s100, s100, 7
    s_lshr_b32 s99, s2, 3
    s_sub_u32 s99, s99, s94
    s_mul_i32 s99, s99, 28672
    s_add_u32 s100, s100, s99
    v_add_u32 v27, s100, v19
    s_mov_b32 s99, 0
    buffer_load_dword v18, v27, s[56:59], s99 offen offset:0
    v_mfma_f32_16x16x32_bf16 v[140:143], v[44:47], a[220:223], v[140:143]
    s_waitcnt lgkmcnt(4)
    v_mul_f32 v252, v252, v13
    v_mul_f32 v253, v253, v13
    v_mfma_f32_16x16x32_bf16 v[144:147], v[48:51], a[192:195], v[144:147]
    ds_read_b64_tr_b16 v[40:41], v10 offset:18432
    v_mul_f32 v254, v254, v13
    v_mfma_f32_16x16x32_bf16 v[144:147], v[52:55], a[208:211], v[144:147]
    ds_read_b64_tr_b16 v[42:43], v10 offset:18944
    v_mul_f32 v255, v255, v13
    v_mfma_f32_16x16x32_bf16 v[148:151], v[48:51], a[196:199], v[148:151]
    s_lshr_b32 s100, s56, 7
    s_sub_u32 s100, 3, s100
    s_add_u32 s100, s100, s95
    s_and_b32 s100, s100, 7
    s_sub_u32 s100, s100, s95
    s_lshl_b32 s100, s100, 7
    s_lshr_b32 s99, s2, 3
    s_sub_u32 s99, s99, s94
    s_mul_i32 s99, s99, 28672
    s_add_u32 s100, s100, s99
    v_add_u32 v27, s100, v19
    s_mov_b32 s99, 917504
    buffer_load_dword v18, v27, s[56:59], s99 offen offset:0
    v_mfma_f32_16x16x32_bf16 v[148:151], v[52:55], a[212:215], v[148:151]
    ds_read_b64_tr_b16 v[44:45], v10 offset:26624
    v_cvt_pk_bf16_f32 v240, v240, v241
    v_mfma_f32_16x16x32_bf16 v[152:155], v[48:51], a[200:203], v[152:155]
    s_lshr_b32 s100, s64, 7
    s_sub_u32 s100, 3, s100
    s_add_u32 s100, s100, s95
    s_and_b32 s100, s100, 7
    s_sub_u32 s100, s100, s95
    s_lshl_b32 s100, s100, 7
    s_lshr_b32 s99, s2, 3
    s_sub_u32 s99, s99, s94
    s_mul_i32 s99, s99, 28672
    s_add_u32 s100, s100, s99
    v_add_u32 v27, s100, v19
    s_mov_b32 s99, 0
    buffer_load_dword v18, v27, s[64:67], s99 offen offset:0
    v_mfma_f32_16x16x32_bf16 v[152:155], v[52:55], a[216:219], v[152:155]
    ds_read_b64_tr_b16 v[46:47], v10 offset:27136
    v_cvt_pk_bf16_f32 v241, v242, v243
    v_mfma_f32_16x16x32_bf16 v[156:159], v[48:51], a[204:207], v[156:159]
    v_mov_b32 v27, 1
    buffer_store_dword v27, off, s[72:75], s14 sc1
    v_mfma_f32_16x16x32_bf16 v[156:159], v[52:55], a[220:223], v[156:159]
    s_waitcnt vmcnt(27) lgkmcnt(4)
    s_barrier
    v_cvt_pk_bf16_f32 v242, v244, v245
    v_mfma_f32_16x16x32_bf16 v[160:163], v[32:35], a[192:195], v[160:163]
    ds_read_b64_tr_b16 v[48:49], v7 offset:16384
    s_add_u32 m0, s96, 65536
    v_mfma_f32_16x16x32_bf16 v[160:163], v[36:39], a[208:211], v[160:163]
    ds_read_b64_tr_b16 v[50:51], v7 offset:16896
    s_add_u32 s99, s5, 2
    v_mfma_f32_16x16x32_bf16 v[164:167], v[32:35], a[196:199], v[164:167]
    ds_read_b64_tr_b16 v[52:53], v7 offset:24576
    s_and_b32 s99, s99, 7
    v_mfma_f32_16x16x32_bf16 v[164:167], v[36:39], a[212:215], v[164:167]
    ds_read_b64_tr_b16 v[54:55], v7 offset:25088
    s_mul_i32 s99, s99, 229376
    v_mfma_f32_16x16x32_bf16 v[168:171], v[32:35], a[200:203], v[168:171]
    v_cvt_pk_bf16_f32 v243, v246, v247
    v_cvt_pk_bf16_f32 v244, v248, v249
    v_mfma_f32_16x16x32_bf16 v[168:171], v[36:39], a[216:219], v[168:171]
    ds_write_b128 v14, v[240:243]
    v_cvt_pk_bf16_f32 v245, v250, v251
    v_mfma_f32_16x16x32_bf16 v[172:175], v[32:35], a[204:207], v[172:175]
    buffer_load_dwordx4 v3, s[32:35], s99 offen offset:0 lds
    v_cvt_pk_bf16_f32 v246, v252, v253
    v_mfma_f32_16x16x32_bf16 v[172:175], v[36:39], a[220:223], v[172:175]
    s_waitcnt lgkmcnt(5)
    v_cvt_pk_bf16_f32 v247, v254, v255
    v_max3_f32 v12, v12, v237, v238
    v_mfma_f32_16x16x32_bf16 v[176:179], v[40:43], a[192:195], v[176:179]
    ds_read_b64_tr_b16 v[32:33], v8 offset:16384
    v_max_f32 v12, v12, v239
    v_mfma_f32_16x16x32_bf16 v[176:179], v[44:47], a[208:211], v[176:179]
    ds_read_b64_tr_b16 v[34:35], v8 offset:16896
    v_mul_f32 v12, s98, v12
    v_mfma_f32_16x16x32_bf16 v[180:183], v[40:43], a[196:199], v[180:183]
    ds_read_b64_tr_b16 v[36:37], v8 offset:24576
    v_fma_f32 v224, v224, s97, v12
    v_mfma_f32_16x16x32_bf16 v[180:183], v[44:47], a[212:215], v[180:183]
    ds_read_b64_tr_b16 v[38:39], v8 offset:25088
    v_fma_f32 v225, v225, s97, v12
    v_mfma_f32_16x16x32_bf16 v[184:187], v[40:43], a[200:203], v[184:187]
    ds_write_b128 v14, v[244:247] offset:16
    v_fma_f32 v226, v226, s97, v12
    v_mfma_f32_32x32x16_bf16 v[240:255], v[60:63], v[88:91], 0
    ds_read_b64_tr_b16 v[72:73], v15 offset:0
    v_exp_f32 v224, v224
    v_exp_f32 v225, v225
    v_fma_f32 v227, v227, s97, v12
    v_mfma_f32_16x16x32_bf16 v[184:187], v[44:47], a[216:219], v[184:187]
    ds_read_b64_tr_b16 v[74:75], v15 offset:512
    v_fma_f32 v228, v228, s97, v12
    v_mfma_f32_16x16x32_bf16 v[188:191], v[40:43], a[204:207], v[188:191]
    buffer_load_dwordx4 v3, s[36:39], s99 offen offset:1024 lds
    v_fma_f32 v229, v229, s97, v12
    v_mfma_f32_16x16x32_bf16 v[188:191], v[44:47], a[220:223], v[188:191]
    s_waitcnt lgkmcnt(8)
    v_exp_f32 v226, v226
    v_mfma_f32_16x16x32_bf16 v[128:131], v[48:51], a[224:227], v[128:131]
    ds_read_b64_tr_b16 v[40:41], v7 offset:18432
    v_fma_f32 v230, v230, s97, v12
    v_mfma_f32_16x16x32_bf16 v[128:131], v[52:55], a[240:243], v[128:131]
    ds_read_b64_tr_b16 v[42:43], v7 offset:18944
    v_fma_f32 v231, v231, s97, v12
    v_mfma_f32_16x16x32_bf16 v[132:135], v[48:51], a[228:231], v[132:135]
    ds_read_b64_tr_b16 v[44:45], v7 offset:26624
    v_fma_f32 v232, v232, s97, v12
    v_mfma_f32_16x16x32_bf16 v[132:135], v[52:55], a[244:247], v[132:135]
    ds_read_b64_tr_b16 v[46:47], v7 offset:27136
    v_fma_f32 v233, v233, s97, v12
    v_mfma_f32_16x16x32_bf16 v[136:139], v[48:51], a[232:235], v[136:139]
    ds_read_b64_tr_b16 v[76:77], v15 offset:1024
    v_fma_f32 v234, v234, s97, v12
    v_mfma_f32_16x16x32_bf16 v[136:139], v[52:55], a[248:251], v[136:139]
    ds_read_b64_tr_b16 v[78:79], v15 offset:1536
    v_fma_f32 v235, v235, s97, v12
    s_waitcnt lgkmcnt(6)
    v_mfma_f32_16x16x32_bf16 v[200:203], v[72:75], v[28:31], v[200:203]
    v_exp_f32 v227, v227
    v_mfma_f32_16x16x32_bf16 v[140:143], v[48:51], a[236:239], v[140:143]
    buffer_load_dwordx4 v4, s[32:35], s99 offen offset:2048 lds
    v_fma_f32 v236, v236, s97, v12
    v_mfma_f32_16x16x32_bf16 v[140:143], v[52:55], a[252:255], v[140:143]
    v_exp_f32 v228, v228
    v_mfma_f32_16x16x32_bf16 v[144:147], v[32:35], a[224:227], v[144:147]
    ds_read_b64_tr_b16 v[48:49], v8 offset:18432
    v_fma_f32 v237, v237, s97, v12
    v_mfma_f32_16x16x32_bf16 v[144:147], v[36:39], a[240:243], v[144:147]
    ds_read_b64_tr_b16 v[50:51], v8 offset:18944
    v_fma_f32 v238, v238, s97, v12
    v_mfma_f32_16x16x32_bf16 v[148:151], v[32:35], a[228:231], v[148:151]
    ds_read_b64_tr_b16 v[52:53], v8 offset:26624
    v_fma_f32 v239, v239, s97, v12
    v_mfma_f32_16x16x32_bf16 v[148:151], v[36:39], a[244:247], v[148:151]
    ds_read_b64_tr_b16 v[54:55], v8 offset:27136
    v_add_f32 v13, v224, v225
    v_mfma_f32_16x16x32_bf16 v[152:155], v[32:35], a[232:235], v[152:155]
    v_exp_f32 v229, v229
    s_waitcnt lgkmcnt(4)
    v_mfma_f32_16x16x32_bf16 v[204:207], v[76:79], v[28:31], v[204:207]
    v_exp_f32 v230, v230
    v_mfma_f32_16x16x32_bf16 v[152:155], v[36:39], a[248:251], v[152:155]
    v_exp_f32 v231, v231
    v_mfma_f32_16x16x32_bf16 v[156:159], v[32:35], a[236:239], v[156:159]
    buffer_load_dwordx4 v4, s[36:39], s99 offen offset:3072 lds
    v_add_f32 v13, v13, v226
    v_mfma_f32_16x16x32_bf16 v[156:159], v[36:39], a[252:255], v[156:159]
    s_waitcnt vmcnt(27)
    s_barrier
    v_add_f32 v13, v13, v227
    v_xor_b32 v7, s6, v7
    v_xor_b32 v8, s6, v8
    v_xor_b32 v9, s6, v9
    v_xor_b32 v10, s6, v10
    v_mfma_f32_16x16x32_bf16 v[160:163], v[40:43], a[224:227], v[160:163]
    ds_read_b64_tr_b16 v[32:33], v9 offset:32768
    s_add_u32 m0, s96, 81920
    v_mfma_f32_16x16x32_bf16 v[160:163], v[44:47], a[240:243], v[160:163]
    ds_read_b64_tr_b16 v[34:35], v9 offset:33280
    s_add_u32 s99, s5, 4
    v_mfma_f32_16x16x32_bf16 v[164:167], v[40:43], a[228:231], v[164:167]
    ds_read_b64_tr_b16 v[36:37], v9 offset:40960
    s_and_b32 s99, s99, 7
    v_mfma_f32_16x16x32_bf16 v[164:167], v[44:47], a[244:247], v[164:167]
    ds_read_b64_tr_b16 v[38:39], v9 offset:41472
    s_mul_i32 s99, s99, 229376
    v_mfma_f32_16x16x32_bf16 v[168:171], v[40:43], a[232:235], v[168:171]
    v_exp_f32 v232, v232
    v_mfma_f32_16x16x32_bf16 v[168:171], v[44:47], a[248:251], v[168:171]
    v_exp_f32 v233, v233
    v_mfma_f32_16x16x32_bf16 v[172:175], v[40:43], a[236:239], v[172:175]
    buffer_load_dwordx4 v3, s[32:35], s99 offen offset:0 lds
    v_add_f32 v13, v13, v228
    v_mfma_f32_16x16x32_bf16 v[172:175], v[44:47], a[252:255], v[172:175]
    s_waitcnt lgkmcnt(4)
    v_exp_f32 v234, v234
    v_mfma_f32_16x16x32_bf16 v[176:179], v[48:51], a[224:227], v[176:179]
    ds_read_b64_tr_b16 v[40:41], v10 offset:32768
    v_add_f32 v13, v13, v229
    v_mfma_f32_16x16x32_bf16 v[176:179], v[52:55], a[240:243], v[176:179]
    ds_read_b64_tr_b16 v[42:43], v10 offset:33280
    v_add_f32 v13, v13, v230
    v_mfma_f32_16x16x32_bf16 v[180:183], v[48:51], a[228:231], v[180:183]
    ds_read_b64_tr_b16 v[44:45], v10 offset:40960
    v_add_f32 v13, v13, v231
    v_mfma_f32_16x16x32_bf16 v[180:183], v[52:55], a[244:247], v[180:183]
    ds_read_b64_tr_b16 v[46:47], v10 offset:41472
    v_add_f32 v13, v13, v232
    v_mfma_f32_16x16x32_bf16 v[184:187], v[48:51], a[232:235], v[184:187]
    v_exp_f32 v235, v235
    v_mfma_f32_16x16x32_bf16 v[184:187], v[52:55], a[248:251], v[184:187]
    v_exp_f32 v236, v236
    v_mfma_f32_16x16x32_bf16 v[188:191], v[48:51], a[236:239], v[188:191]
    buffer_load_dwordx4 v3, s[36:39], s99 offen offset:1024 lds
    v_add_f32 v13, v13, v233
    v_mfma_f32_16x16x32_bf16 v[188:191], v[52:55], a[252:255], v[188:191]
    s_waitcnt lgkmcnt(4)
    v_exp_f32 v237, v237
    v_mfma_f32_16x16x32_bf16 v[96:99], a[0:3], v[32:35], 0
    ds_read_b64_tr_b16 v[48:49], v9 offset:34816
    v_exp_f32 v238, v238
    v_mfma_f32_16x16x32_bf16 v[96:99], a[16:19], v[36:39], v[96:99]
    ds_read_b64_tr_b16 v[50:51], v9 offset:35328
    v_exp_f32 v239, v239
    v_mfma_f32_16x16x32_bf16 v[100:103], a[4:7], v[32:35], 0
    ds_read_b64_tr_b16 v[52:53], v9 offset:43008
    v_mul_f32 v128, s98, v128
    v_mul_f32 v129, s98, v129
    v_mfma_f32_16x16x32_bf16 v[100:103], a[20:23], v[36:39], v[100:103]
    ds_read_b64_tr_b16 v[54:55], v9 offset:43520
    v_exp_f32 v128, v128
    v_mfma_f32_16x16x32_bf16 v[104:107], a[8:11], v[32:35], 0
    v_exp_f32 v129, v129
    v_mul_f32 v130, s98, v130
    v_mfma_f32_16x16x32_bf16 v[104:107], a[24:27], v[36:39], v[104:107]
    v_exp_f32 v130, v130
    v_mul_f32 v131, s98, v131
    v_mfma_f32_16x16x32_bf16 v[108:111], a[12:15], v[32:35], 0
    buffer_load_dwordx4 v4, s[32:35], s99 offen offset:2048 lds
    v_exp_f32 v131, v131
    v_mfma_f32_16x16x32_bf16 v[108:111], a[28:31], v[36:39], v[108:111]
    s_waitcnt lgkmcnt(4)
    v_mul_f32 v144, s98, v144
    v_exp_f32 v144, v144
    v_mfma_f32_16x16x32_bf16 v[112:115], a[0:3], v[40:43], 0
    ds_read_b64_tr_b16 v[32:33], v10 offset:34816
    v_mul_f32 v145, s98, v145
    v_mul_f32 v146, s98, v146
    v_mfma_f32_16x16x32_bf16 v[112:115], a[16:19], v[44:47], v[112:115]
    ds_read_b64_tr_b16 v[34:35], v10 offset:35328
    v_exp_f32 v145, v145
    v_mfma_f32_16x16x32_bf16 v[116:119], a[4:7], v[40:43], 0
    ds_read_b64_tr_b16 v[36:37], v10 offset:43008
    v_exp_f32 v146, v146
    v_mfma_f32_16x16x32_bf16 v[116:119], a[20:23], v[44:47], v[116:119]
    ds_read_b64_tr_b16 v[38:39], v10 offset:43520
    v_mul_f32 v147, s98, v147
    v_add_f32 v128, 1.0, v128
    v_mfma_f32_16x16x32_bf16 v[120:123], a[8:11], v[40:43], 0
    v_exp_f32 v147, v147
    v_add_f32 v129, 1.0, v129
    v_mfma_f32_16x16x32_bf16 v[120:123], a[24:27], v[44:47], v[120:123]
    v_rcp_f32 v128, v128
    v_add_f32 v130, 1.0, v130
    v_mfma_f32_16x16x32_bf16 v[124:127], a[12:15], v[40:43], 0
    buffer_load_dwordx4 v4, s[36:39], s99 offen offset:3072 lds
    v_rcp_f32 v129, v129
    v_mfma_f32_16x16x32_bf16 v[124:127], a[28:31], v[44:47], v[124:127]
    s_waitcnt vmcnt(24) lgkmcnt(4)
    s_barrier
    v_rcp_f32 v130, v130
    v_mfma_f32_16x16x32_bf16 v[96:99], a[32:35], v[48:51], v[96:99]
    ds_read_b64_tr_b16 v[40:41], v7 offset:49152
    s_add_u32 m0, s96, 16384
    v_add_f32 v131, 1.0, v131
    v_mfma_f32_16x16x32_bf16 v[96:99], a[48:51], v[52:55], v[96:99]
    ds_read_b64_tr_b16 v[42:43], v7 offset:49664
    s_add_u32 s99, s5, 6
    v_add_f32 v144, 1.0, v144
    v_mfma_f32_16x16x32_bf16 v[100:103], a[36:39], v[48:51], v[100:103]
    ds_read_b64_tr_b16 v[44:45], v7 offset:57344
    s_and_b32 s99, s99, 7
    v_add_f32 v145, 1.0, v145
    v_mfma_f32_16x16x32_bf16 v[100:103], a[52:55], v[52:55], v[100:103]
    ds_read_b64_tr_b16 v[46:47], v7 offset:57856
    s_mul_i32 s99, s99, 229376
    v_add_f32 v146, 1.0, v146
    v_mfma_f32_16x16x32_bf16 v[104:107], a[40:43], v[48:51], v[104:107]
    v_rcp_f32 v131, v131
    v_add_f32 v147, 1.0, v147
    v_mfma_f32_16x16x32_bf16 v[104:107], a[56:59], v[52:55], v[104:107]
    v_rcp_f32 v144, v144
    v_mul_f32 v160, v160, v128
    v_mfma_f32_16x16x32_bf16 v[108:111], a[44:47], v[48:51], v[108:111]
    buffer_load_dwordx4 v3, s[32:35], s99 offen offset:0 lds
    v_rcp_f32 v145, v145
    v_mfma_f32_16x16x32_bf16 v[108:111], a[60:63], v[52:55], v[108:111]
    s_waitcnt lgkmcnt(4)
    v_rcp_f32 v146, v146
    v_mul_f32 v161, v161, v129
    v_mfma_f32_16x16x32_bf16 v[112:115], a[32:35], v[32:35], v[112:115]
    ds_read_b64_tr_b16 v[48:49], v8 offset:49152
    v_rcp_f32 v147, v147
    v_mfma_f32_16x16x32_bf16 v[112:115], a[48:51], v[36:39], v[112:115]
    ds_read_b64_tr_b16 v[50:51], v8 offset:49664
    v_mul_f32 v162, v162, v130
    v_mul_f32 v163, v163, v131
    v_mfma_f32_16x16x32_bf16 v[116:119], a[36:39], v[32:35], v[116:119]
    ds_read_b64_tr_b16 v[52:53], v8 offset:57344
    v_mul_f32 v176, v176, v144
    v_mul_f32 v177, v177, v145
    v_mfma_f32_16x16x32_bf16 v[116:119], a[52:55], v[36:39], v[116:119]
    ds_read_b64_tr_b16 v[54:55], v8 offset:57856
    v_mul_f32 v178, v178, v146
    v_mul_f32 v179, v179, v147
    v_mfma_f32_16x16x32_bf16 v[120:123], a[40:43], v[32:35], v[120:123]
    v_cvt_pk_bf16_f32 v128, v160, v161
    v_cvt_pk_bf16_f32 v129, v162, v163
    v_cvt_pk_bf16_f32 v130, v176, v177
    v_mfma_f32_16x16x32_bf16 v[120:123], a[56:59], v[36:39], v[120:123]
    v_cvt_pk_bf16_f32 v131, v178, v179
    v_mul_f32 v132, s98, v132
    v_mul_f32 v133, s98, v133
    v_mfma_f32_16x16x32_bf16 v[124:127], a[44:47], v[32:35], v[124:127]
    buffer_load_dwordx4 v3, s[36:39], s99 offen offset:1024 lds
    v_exp_f32 v132, v132
    v_mfma_f32_16x16x32_bf16 v[124:127], a[60:63], v[36:39], v[124:127]
    s_waitcnt lgkmcnt(4)
    v_exp_f32 v133, v133
    v_mul_f32 v134, s98, v134
    v_mfma_f32_16x16x32_bf16 v[96:99], a[64:67], v[40:43], v[96:99]
    ds_read_b64_tr_b16 v[32:33], v7 offset:51200
    v_exp_f32 v134, v134
    v_mfma_f32_16x16x32_bf16 v[96:99], a[80:83], v[44:47], v[96:99]
    ds_read_b64_tr_b16 v[34:35], v7 offset:51712
    v_lshrrev_b32 v23, 5, v0
    v_lshlrev_b32 v23, 12, v23
    v_mfma_f32_16x16x32_bf16 v[100:103], a[68:71], v[40:43], v[100:103]
    ds_read_b64_tr_b16 v[36:37], v7 offset:59392
    v_bfe_u32 v21, v0, 4, 1
    v_lshl_add_u32 v23, v21, 9, v23
    v_mfma_f32_16x16x32_bf16 v[100:103], a[84:87], v[44:47], v[100:103]
    ds_read_b64_tr_b16 v[38:39], v7 offset:59904
    v_xor_b32 v21, s90, v21
    v_lshl_add_u32 v23, v21, 5, v23
    v_mfma_f32_16x16x32_bf16 v[104:107], a[72:75], v[40:43], v[104:107]
    buffer_store_dwordx4 v[128:131], v11, s[72:75], s20 offen offset:0 sc1
    v_bfe_u32 v21, v0, 2, 2
    v_lshl_add_u32 v23, v21, 6, v23
    v_mfma_f32_16x16x32_bf16 v[104:107], a[88:91], v[44:47], v[104:107]
    v_and_b32 v21, 3, v0
    v_lshl_add_u32 v23, v21, 3, v23
    v_mul_f32 v135, s98, v135
    v_mfma_f32_16x16x32_bf16 v[108:111], a[76:79], v[40:43], v[108:111]
    buffer_load_dwordx4 v4, s[32:35], s99 offen offset:2048 lds
    v_exp_f32 v135, v135
    v_mfma_f32_16x16x32_bf16 v[108:111], a[92:95], v[44:47], v[108:111]
    s_waitcnt lgkmcnt(4)
    v_mul_f32 v148, s98, v148
    v_exp_f32 v148, v148
    v_mfma_f32_16x16x32_bf16 v[112:115], a[64:67], v[48:51], v[112:115]
    ds_read_b64_tr_b16 v[40:41], v8 offset:51200
    v_mul_f32 v149, s98, v149
    v_mul_f32 v150, s98, v150
    v_mfma_f32_16x16x32_bf16 v[112:115], a[80:83], v[52:55], v[112:115]
    ds_read_b64_tr_b16 v[42:43], v8 offset:51712
    v_exp_f32 v149, v149
    v_mfma_f32_16x16x32_bf16 v[116:119], a[68:71], v[48:51], v[116:119]
    ds_read_b64_tr_b16 v[44:45], v8 offset:59392
    v_exp_f32 v150, v150
    v_mfma_f32_16x16x32_bf16 v[116:119], a[84:87], v[52:55], v[116:119]
    ds_read_b64_tr_b16 v[46:47], v8 offset:59904
    v_mul_f32 v151, s98, v151
    v_add_f32 v132, 1.0, v132
    v_mfma_f32_16x16x32_bf16 v[120:123], a[72:75], v[48:51], v[120:123]
    v_exp_f32 v151, v151
    v_add_f32 v133, 1.0, v133
    v_mfma_f32_16x16x32_bf16 v[120:123], a[88:91], v[52:55], v[120:123]
    v_rcp_f32 v132, v132
    v_add_f32 v134, 1.0, v134
    v_mfma_f32_16x16x32_bf16 v[124:127], a[76:79], v[48:51], v[124:127]
    buffer_load_dwordx4 v4, s[36:39], s99 offen offset:3072 lds
    v_rcp_f32 v133, v133
    v_mfma_f32_16x16x32_bf16 v[124:127], a[92:95], v[52:55], v[124:127]
    s_waitcnt vmcnt(25) lgkmcnt(4)
    s_barrier
    v_rcp_f32 v134, v134
    v_mfma_f32_16x16x32_bf16 v[96:99], a[96:99], v[32:35], v[96:99]
    ds_read_b64_tr_b16 v[48:49], v7 offset:32768
    s_add_u32 m0, s96, 131072
    v_lshrrev_b32 v20, 2, v0
    v_mfma_f32_16x16x32_bf16 v[96:99], a[112:115], v[36:39], v[96:99]
    ds_read_b64_tr_b16 v[50:51], v7 offset:33280
    s_add_u32 s99, s17, 0
    v_and_b32 v22, 3, v0
    v_mfma_f32_16x16x32_bf16 v[100:103], a[100:103], v[32:35], v[100:103]
    ds_read_b64_tr_b16 v[52:53], v7 offset:40960
    v_lshlrev_b32 v22, 2, v22
    v_lshl_add_u32 v20, v20, 11, v22
    v_mfma_f32_16x16x32_bf16 v[100:103], a[116:119], v[36:39], v[100:103]
    ds_read_b64_tr_b16 v[54:55], v7 offset:41472
    v_add_f32 v135, 1.0, v135
    v_add_f32 v148, 1.0, v148
    v_mfma_f32_16x16x32_bf16 v[104:107], a[104:107], v[32:35], v[104:107]
    s_lshl_b32 s100, s93, 7
    s_add_u32 s100, s100, 10551296
    v_add_u32 v20, s100, v20
    v_add_f32 v149, 1.0, v149
    v_mfma_f32_16x16x32_bf16 v[104:107], a[120:123], v[36:39], v[104:107]
    v_rcp_f32 v135, v135
    v_add_f32 v150, 1.0, v150
    v_mfma_f32_16x16x32_bf16 v[108:111], a[108:111], v[32:35], v[108:111]
    buffer_load_dwordx4 v5, s[56:59], s99 offen lds
    v_rcp_f32 v148, v148
    v_mfma_f32_16x16x32_bf16 v[108:111], a[124:127], v[36:39], v[108:111]
    s_waitcnt lgkmcnt(4)
    v_rcp_f32 v149, v149
    v_add_f32 v151, 1.0, v151
    v_mfma_f32_16x16x32_bf16 v[112:115], a[96:99], v[40:43], v[112:115]
    ds_read_b64_tr_b16 v[32:33], v8 offset:32768
    v_rcp_f32 v150, v150
    v_mfma_f32_16x16x32_bf16 v[112:115], a[112:115], v[44:47], v[112:115]
    ds_read_b64_tr_b16 v[34:35], v8 offset:33280
    v_rcp_f32 v151, v151
    v_mfma_f32_16x16x32_bf16 v[116:119], a[100:103], v[40:43], v[116:119]
    ds_read_b64_tr_b16 v[36:37], v8 offset:40960
    v_mul_f32 v164, v164, v132
    v_mul_f32 v165, v165, v133
    v_mfma_f32_16x16x32_bf16 v[116:119], a[116:119], v[44:47], v[116:119]
    ds_read_b64_tr_b16 v[38:39], v8 offset:41472
    v_mul_f32 v166, v166, v134
    v_mul_f32 v167, v167, v135
    v_mfma_f32_16x16x32_bf16 v[120:123], a[104:107], v[40:43], v[120:123]
    v_mul_f32 v180, v180, v148
    v_mul_f32 v181, v181, v149
    v_mul_f32 v182, v182, v150
    v_mfma_f32_16x16x32_bf16 v[120:123], a[120:123], v[44:47], v[120:123]
    v_mul_f32 v183, v183, v151
    v_cvt_pk_bf16_f32 v132, v164, v165
    v_cvt_pk_bf16_f32 v133, v166, v167
    v_mfma_f32_16x16x32_bf16 v[124:127], a[108:111], v[40:43], v[124:127]
    buffer_load_dwordx4 v6, s[56:59], s99 offen offset:1024 lds
    v_cvt_pk_bf16_f32 v134, v180, v181
    v_cvt_pk_bf16_f32 v135, v182, v183
    v_mfma_f32_16x16x32_bf16 v[124:127], a[124:127], v[44:47], v[124:127]
    s_waitcnt lgkmcnt(4)
    v_mul_f32 v136, s98, v136
    v_exp_f32 v136, v136
    v_mfma_f32_16x16x32_bf16 v[96:99], a[128:131], v[48:51], v[96:99]
    ds_read_b64_tr_b16 v[40:41], v7 offset:34816
    v_mul_f32 v137, s98, v137
    v_mul_f32 v138, s98, v138
    v_mfma_f32_16x16x32_bf16 v[96:99], a[144:147], v[52:55], v[96:99]
    ds_read_b64_tr_b16 v[42:43], v7 offset:35328
    v_exp_f32 v137, v137
    v_mfma_f32_16x16x32_bf16 v[100:103], a[132:135], v[48:51], v[100:103]
    ds_read_b64_tr_b16 v[44:45], v7 offset:43008
    v_exp_f32 v138, v138
    v_mfma_f32_16x16x32_bf16 v[100:103], a[148:151], v[52:55], v[100:103]
    ds_read_b64_tr_b16 v[46:47], v7 offset:43520
    v_mul_f32 v139, s98, v139
    v_mul_f32 v152, s98, v152
    v_mfma_f32_16x16x32_bf16 v[104:107], a[136:139], v[48:51], v[104:107]
    buffer_store_dwordx4 v[132:135], v11, s[72:75], s20 offen offset:1024 sc1
    v_exp_f32 v139, v139
    v_mfma_f32_16x16x32_bf16 v[104:107], a[152:155], v[52:55], v[104:107]
    v_exp_f32 v152, v152
    v_mul_f32 v153, s98, v153
    v_mfma_f32_16x16x32_bf16 v[108:111], a[140:143], v[48:51], v[108:111]
    buffer_load_dwordx4 v5, s[60:63], s99 offen offset:2048 lds
    v_exp_f32 v153, v153
    v_mfma_f32_16x16x32_bf16 v[108:111], a[156:159], v[52:55], v[108:111]
    s_waitcnt lgkmcnt(4)
    v_mul_f32 v154, s98, v154
    v_exp_f32 v154, v154
    v_mfma_f32_16x16x32_bf16 v[112:115], a[128:131], v[32:35], v[112:115]
    ds_read_b64_tr_b16 v[48:49], v8 offset:34816
    v_mul_f32 v155, s98, v155
    v_add_f32 v136, 1.0, v136
    v_mfma_f32_16x16x32_bf16 v[112:115], a[144:147], v[36:39], v[112:115]
    ds_read_b64_tr_b16 v[50:51], v8 offset:35328
    v_exp_f32 v155, v155
    v_mfma_f32_16x16x32_bf16 v[116:119], a[132:135], v[32:35], v[116:119]
    ds_read_b64_tr_b16 v[52:53], v8 offset:43008
    v_rcp_f32 v136, v136
    v_mfma_f32_16x16x32_bf16 v[116:119], a[148:151], v[36:39], v[116:119]
    ds_read_b64_tr_b16 v[54:55], v8 offset:43520
    v_add_f32 v137, 1.0, v137
    v_add_f32 v138, 1.0, v138
    v_mfma_f32_16x16x32_bf16 v[120:123], a[136:139], v[32:35], v[120:123]
    v_rcp_f32 v137, v137
    v_add_f32 v139, 1.0, v139
    v_mfma_f32_16x16x32_bf16 v[120:123], a[152:155], v[36:39], v[120:123]
    v_rcp_f32 v138, v138
    v_add_f32 v152, 1.0, v152
    v_mfma_f32_16x16x32_bf16 v[124:127], a[140:143], v[32:35], v[124:127]
    buffer_load_dwordx4 v6, s[60:63], s99 offen offset:3072 lds
    v_rcp_f32 v139, v139
    v_mfma_f32_16x16x32_bf16 v[124:127], a[156:159], v[36:39], v[124:127]
    s_waitcnt vmcnt(26) lgkmcnt(4)
    s_barrier
    v_rcp_f32 v152, v152
    v_mfma_f32_16x16x32_bf16 v[96:99], a[160:163], v[40:43], v[96:99]
    ds_read_b64_tr_b16 v[32:33], v7 offset:0
    v_add_f32 v153, 1.0, v153
    v_add_f32 v154, 1.0, v154
    v_mfma_f32_16x16x32_bf16 v[96:99], a[176:179], v[44:47], v[96:99]
    ds_read_b64_tr_b16 v[34:35], v7 offset:512
    v_rcp_f32 v153, v153
    v_mfma_f32_16x16x32_bf16 v[100:103], a[164:167], v[40:43], v[100:103]
    ds_read_b64_tr_b16 v[36:37], v7 offset:8192
    v_rcp_f32 v154, v154
    v_mfma_f32_16x16x32_bf16 v[100:103], a[180:183], v[44:47], v[100:103]
    ds_read_b64_tr_b16 v[38:39], v7 offset:8704
    v_add_f32 v155, 1.0, v155
    v_mul_f32 v168, v168, v136
    v_mfma_f32_16x16x32_bf16 v[104:107], a[168:171], v[40:43], v[104:107]
    v_rcp_f32 v155, v155
    v_mul_f32 v169, v169, v137
    v_mfma_f32_16x16x32_bf16 v[104:107], a[184:187], v[44:47], v[104:107]
    v_mul_f32 v170, v170, v138
    v_mul_f32 v171, v171, v139
    v_mul_f32 v184, v184, v152
    v_mfma_f32_16x16x32_bf16 v[108:111], a[172:175], v[40:43], v[108:111]
    buffer_load_dword v22, v20, s[72:75], 0 offen sc1
    v_mul_f32 v185, v185, v153
    v_mul_f32 v186, v186, v154
    v_mfma_f32_16x16x32_bf16 v[108:111], a[188:191], v[44:47], v[108:111]
    s_waitcnt lgkmcnt(4)
    v_mul_f32 v187, v187, v155
    v_cvt_pk_bf16_f32 v136, v168, v169
    v_cvt_pk_bf16_f32 v137, v170, v171
    v_mfma_f32_16x16x32_bf16 v[112:115], a[160:163], v[48:51], v[112:115]
    ds_read_b64_tr_b16 v[40:41], v8 offset:0
    v_cvt_pk_bf16_f32 v138, v184, v185
    v_cvt_pk_bf16_f32 v139, v186, v187
    v_mfma_f32_16x16x32_bf16 v[112:115], a[176:179], v[52:55], v[112:115]
    ds_read_b64_tr_b16 v[42:43], v8 offset:512
    v_mul_f32 v140, s98, v140
    v_mul_f32 v141, s98, v141
    v_mfma_f32_16x16x32_bf16 v[116:119], a[164:167], v[48:51], v[116:119]
    ds_read_b64_tr_b16 v[44:45], v8 offset:8192
    v_exp_f32 v140, v140
    v_mfma_f32_16x16x32_bf16 v[116:119], a[180:183], v[52:55], v[116:119]
    ds_read_b64_tr_b16 v[46:47], v8 offset:8704
    v_exp_f32 v141, v141
    v_mfma_f32_16x16x32_bf16 v[120:123], a[168:171], v[48:51], v[120:123]
    buffer_store_dwordx4 v[136:139], v11, s[72:75], s20 offen offset:2048 sc1
    v_mul_f32 v142, s98, v142
    v_mul_f32 v143, s98, v143
    v_mfma_f32_16x16x32_bf16 v[120:123], a[184:187], v[52:55], v[120:123]
    v_exp_f32 v142, v142
    v_mul_f32 v156, s98, v156
    v_mfma_f32_16x16x32_bf16 v[124:127], a[172:175], v[48:51], v[124:127]
    v_exp_f32 v143, v143
    v_mul_f32 v157, s98, v157
    v_mfma_f32_16x16x32_bf16 v[124:127], a[188:191], v[52:55], v[124:127]
    s_waitcnt lgkmcnt(4)
    v_exp_f32 v156, v156
    v_mul_f32 v158, s98, v158
    v_mfma_f32_16x16x32_bf16 v[96:99], a[192:195], v[32:35], v[96:99]
    ds_read_b64_tr_b16 v[48:49], v7 offset:2048
    v_exp_f32 v157, v157
    v_mfma_f32_16x16x32_bf16 v[96:99], a[208:211], v[36:39], v[96:99]
    ds_read_b64_tr_b16 v[50:51], v7 offset:2560
    v_exp_f32 v158, v158
    v_mfma_f32_16x16x32_bf16 v[100:103], a[196:199], v[32:35], v[100:103]
    ds_read_b64_tr_b16 v[52:53], v7 offset:10240
    v_mul_f32 v159, s98, v159
    v_add_f32 v140, 1.0, v140
    v_mfma_f32_16x16x32_bf16 v[100:103], a[212:215], v[36:39], v[100:103]
    ds_read_b64_tr_b16 v[54:55], v7 offset:10752
    v_exp_f32 v159, v159
    v_mfma_f32_16x16x32_bf16 v[104:107], a[200:203], v[32:35], v[104:107]
    v_rcp_f32 v140, v140
    v_add_f32 v141, 1.0, v141
    v_mfma_f32_16x16x32_bf16 v[104:107], a[216:219], v[36:39], v[104:107]
    v_rcp_f32 v141, v141
    v_add_f32 v142, 1.0, v142
    v_mfma_f32_16x16x32_bf16 v[108:111], a[204:207], v[32:35], v[108:111]
    v_rcp_f32 v142, v142
    v_mfma_f32_16x16x32_bf16 v[108:111], a[220:223], v[36:39], v[108:111]
    s_waitcnt lgkmcnt(4)
    v_add_f32 v143, 1.0, v143
    v_add_f32 v156, 1.0, v156
    v_mfma_f32_16x16x32_bf16 v[112:115], a[192:195], v[40:43], v[112:115]
    ds_read_b64_tr_b16 v[32:33], v8 offset:2048
    v_add_f32 v157, 1.0, v157
    v_mfma_f32_16x16x32_bf16 v[112:115], a[208:211], v[44:47], v[112:115]
    ds_read_b64_tr_b16 v[34:35], v8 offset:2560
    v_add_f32 v158, 1.0, v158
    v_mfma_f32_16x16x32_bf16 v[116:119], a[196:199], v[40:43], v[116:119]
    ds_read_b64_tr_b16 v[36:37], v8 offset:10240
    v_add_f32 v159, 1.0, v159
    v_mfma_f32_16x16x32_bf16 v[116:119], a[212:215], v[44:47], v[116:119]
    ds_read_b64_tr_b16 v[38:39], v8 offset:10752
    v_mul_f32 v172, v172, v140
    v_mfma_f32_16x16x32_bf16 v[120:123], a[200:203], v[40:43], v[120:123]
    v_rcp_f32 v143, v143
    v_mfma_f32_16x16x32_bf16 v[120:123], a[216:219], v[44:47], v[120:123]
    v_rcp_f32 v156, v156
    v_mfma_f32_16x16x32_bf16 v[124:127], a[204:207], v[40:43], v[124:127]
    v_rcp_f32 v157, v157
    v_mfma_f32_16x16x32_bf16 v[124:127], a[220:223], v[44:47], v[124:127]
    s_waitcnt vmcnt(24) lgkmcnt(4)
    s_barrier
    v_mul_f32 v173, v173, v141
    v_mov_b32 v7, v23
    v_add_u32 v9, 0x10000, v23
    v_mfma_f32_16x16x32_bf16 v[96:99], a[224:227], v[48:51], v[96:99]
    ds_read_b64_tr_b16 v[40:41], v9 offset:49152
    s_add_u32 m0, s96, 98304
    v_mfma_f32_16x16x32_bf16 v[96:99], a[240:243], v[52:55], v[96:99]
    ds_read_b64_tr_b16 v[42:43], v9 offset:49408
    s_add_u32 s99, s17, 32768
    v_mfma_f32_16x16x32_bf16 v[100:103], a[228:231], v[48:51], v[100:103]
    ds_read_b64_tr_b16 v[44:45], v9 offset:57344
    v_mul_f32 v174, v174, v142
    v_mfma_f32_16x16x32_bf16 v[100:103], a[244:247], v[52:55], v[100:103]
    ds_read_b64_tr_b16 v[46:47], v9 offset:57600
    v_mul_f32 v175, v175, v143
    v_mfma_f32_16x16x32_bf16 v[104:107], a[232:235], v[48:51], v[104:107]
    v_rcp_f32 v158, v158
    v_mfma_f32_16x16x32_bf16 v[104:107], a[248:251], v[52:55], v[104:107]
    v_rcp_f32 v159, v159
    v_mfma_f32_16x16x32_bf16 v[108:111], a[236:239], v[48:51], v[108:111]
    buffer_load_dwordx4 v5, s[56:59], s99 offen lds
    v_mul_f32 v188, v188, v156
    v_mfma_f32_16x16x32_bf16 v[108:111], a[252:255], v[52:55], v[108:111]
    s_waitcnt lgkmcnt(4)
    v_mul_f32 v189, v189, v157
    v_mul_f32 v190, v190, v158
    v_mfma_f32_16x16x32_bf16 v[112:115], a[224:227], v[32:35], v[112:115]
    ds_read_b64_tr_b16 v[48:49], v9 offset:50176
    v_mul_f32 v191, v191, v159
    v_mfma_f32_16x16x32_bf16 v[112:115], a[240:243], v[36:39], v[112:115]
    ds_read_b64_tr_b16 v[50:51], v9 offset:50432
    v_cvt_pk_bf16_f32 v140, v172, v173
    v_mfma_f32_16x16x32_bf16 v[116:119], a[228:231], v[32:35], v[116:119]
    ds_read_b64_tr_b16 v[52:53], v9 offset:58368
    v_cvt_pk_bf16_f32 v141, v174, v175
    v_mfma_f32_16x16x32_bf16 v[116:119], a[244:247], v[36:39], v[116:119]
    ds_read_b64_tr_b16 v[54:55], v9 offset:58624
    v_cvt_pk_bf16_f32 v142, v188, v189
    v_mfma_f32_16x16x32_bf16 v[120:123], a[232:235], v[32:35], v[120:123]
    v_cvt_pk_bf16_f32 v143, v190, v191
    v_add_f32 v13, v13, v234
    v_mfma_f32_16x16x32_bf16 v[120:123], a[248:251], v[36:39], v[120:123]
    buffer_store_dwordx4 v[140:143], v11, s[72:75], s20 offen offset:3072 sc1
    v_add_f32 v13, v13, v235
    v_mfma_f32_16x16x32_bf16 v[124:127], a[236:239], v[32:35], v[124:127]
    buffer_load_dwordx4 v6, s[56:59], s99 offen offset:1024 lds
    v_add_f32 v13, v13, v236
    v_mfma_f32_16x16x32_bf16 v[124:127], a[252:255], v[36:39], v[124:127]
    s_waitcnt lgkmcnt(4)
    v_add_f32 v13, v13, v237
    v_add_f32 v13, v13, v238
    v_mfma_f32_16x16x32_bf16 v[128:131], v[40:43], a[0:3], 0
    ds_read_b64_tr_b16 v[32:33], v9 offset:51200
    v_add_f32 v13, v13, v239
    v_rcp_f32 v13, v13
    v_mfma_f32_16x16x32_bf16 v[128:131], v[44:47], a[16:19], v[128:131]
    ds_read_b64_tr_b16 v[34:35], v9 offset:51456
    v_mul_f32 v224, v224, v13
    v_mul_f32 v225, v225, v13
    v_mul_f32 v226, v226, v13
    v_mfma_f32_16x16x32_bf16 v[132:135], v[40:43], a[4:7], 0
    ds_read_b64_tr_b16 v[36:37], v9 offset:59392
    v_mul_f32 v227, v227, v13
    v_mul_f32 v228, v228, v13
    v_mul_f32 v229, v229, v13
    v_mfma_f32_16x16x32_bf16 v[132:135], v[44:47], a[20:23], v[132:135]
    ds_read_b64_tr_b16 v[38:39], v9 offset:59648
    v_mul_f32 v230, v230, v13
    v_mul_f32 v231, v231, v13
    v_mul_f32 v232, v232, v13
    v_mfma_f32_16x16x32_bf16 v[144:147], v[40:43], a[8:11], 0
    v_mul_f32 v233, v233, v13
    v_mul_f32 v234, v234, v13
    v_mul_f32 v235, v235, v13
    v_mul_f32 v236, v236, v13
    v_mfma_f32_16x16x32_bf16 v[144:147], v[44:47], a[24:27], v[144:147]
    v_mul_f32 v237, v237, v13
    v_mul_f32 v238, v238, v13
    v_mul_f32 v239, v239, v13
    v_cvt_pk_bf16_f32 v224, v224, v225
    v_mfma_f32_16x16x32_bf16 v[148:151], v[40:43], a[12:15], 0
    buffer_load_dwordx4 v5, s[60:63], s99 offen offset:2048 lds
    v_cvt_pk_bf16_f32 v225, v226, v227
    v_cvt_pk_bf16_f32 v226, v228, v229
    v_cvt_pk_bf16_f32 v227, v230, v231
    v_mfma_f32_16x16x32_bf16 v[148:151], v[44:47], a[28:31], v[148:151]
    s_waitcnt lgkmcnt(4)
    v_cvt_pk_bf16_f32 v228, v232, v233
    v_cvt_pk_bf16_f32 v229, v234, v235
    v_cvt_pk_bf16_f32 v230, v236, v237
    v_cvt_pk_bf16_f32 v231, v238, v239
    v_mfma_f32_16x16x32_bf16 v[160:163], v[48:51], a[0:3], 0
    ds_read_b64_tr_b16 v[40:41], v9 offset:52224
    v_cvt_pk_bf16_f32 v96, v96, v97
    v_cvt_pk_bf16_f32 v97, v98, v99
    v_cvt_pk_bf16_f32 v98, v100, v101
    v_mfma_f32_16x16x32_bf16 v[160:163], v[52:55], a[16:19], v[160:163]
    ds_read_b64_tr_b16 v[42:43], v9 offset:52480
    v_cvt_pk_bf16_f32 v99, v102, v103
    v_cvt_pk_bf16_f32 v104, v104, v105
    v_cvt_pk_bf16_f32 v105, v106, v107
    v_mfma_f32_16x16x32_bf16 v[192:195], v[64:67], v[96:99], 0
    ds_write_b128 v14, v[224:227]
    v_cvt_pk_bf16_f32 v106, v108, v109
    v_cvt_pk_bf16_f32 v107, v110, v111
    v_cvt_pk_bf16_f32 v112, v112, v113
    v_mfma_f32_16x16x32_bf16 v[196:199], v[68:71], v[96:99], 0
    ds_write_b128 v14, v[228:231] offset:16
    v_cvt_pk_bf16_f32 v113, v114, v115
    v_cvt_pk_bf16_f32 v114, v116, v117
    v_cvt_pk_bf16_f32 v115, v118, v119
    v_mfma_f32_16x16x32_bf16 v[192:195], v[72:75], v[104:107], v[192:195]
    ds_read_b64_tr_b16 v[80:81], v15 offset:0
    v_max3_f32 v12, v240, v241, v242
    v_max3_f32 v12, v12, v243, v244
    v_max3_f32 v12, v12, v245, v246
    v_mfma_f32_16x16x32_bf16 v[196:199], v[76:79], v[104:107], v[196:199]
    ds_read_b64_tr_b16 v[82:83], v15 offset:512
    v_max3_f32 v12, v12, v247, v248
    v_max3_f32 v12, v12, v249, v250
    v_max3_f32 v12, v12, v251, v252
    v_mfma_f32_16x16x32_bf16 v[164:167], v[48:51], a[4:7], 0
    ds_read_b64_tr_b16 v[44:45], v9 offset:60416
    v_max3_f32 v12, v12, v253, v254
    v_max_f32 v12, v12, v255
    v_mul_f32 v12, s98, v12
    v_mfma_f32_16x16x32_bf16 v[164:167], v[52:55], a[20:23], v[164:167]
    ds_read_b64_tr_b16 v[46:47], v9 offset:60672
    v_fma_f32 v240, v240, s97, v12
    v_exp_f32 v240, v240
    v_mfma_f32_16x16x32_bf16 v[176:179], v[48:51], a[8:11], 0
    ds_read_b64_tr_b16 v[84:85], v15 offset:1024
    v_fma_f32 v241, v241, s97, v12
    v_exp_f32 v241, v241
    v_mfma_f32_16x16x32_bf16 v[176:179], v[52:55], a[24:27], v[176:179]
    ds_read_b64_tr_b16 v[86:87], v15 offset:1536
    v_fma_f32 v242, v242, s97, v12
    v_exp_f32 v242, v242
    v_mfma_f32_16x16x32_bf16 v[180:183], v[48:51], a[12:15], 0
    buffer_load_dwordx4 v6, s[60:63], s99 offen offset:3072 lds
    v_fma_f32 v243, v243, s97, v12
    v_exp_f32 v243, v243
    v_mfma_f32_16x16x32_bf16 v[180:183], v[52:55], a[28:31], v[180:183]
    s_waitcnt vmcnt(21) lgkmcnt(10)
    s_barrier
    v_fma_f32 v244, v244, s97, v12
    v_exp_f32 v244, v244
    s_waitcnt lgkmcnt(4)
    v_mfma_f32_16x16x32_bf16 v[208:211], v[80:83], v[112:115], 0
    v_fma_f32 v245, v245, s97, v12
    v_exp_f32 v245, v245
    v_fma_f32 v246, v246, s97, v12
    v_mfma_f32_16x16x32_bf16 v[216:219], v[80:83], v[28:31], 0
    v_exp_f32 v246, v246
    v_fma_f32 v247, v247, s97, v12
    v_fma_f32 v248, v248, s97, v12
    v_mfma_f32_16x16x32_bf16 v[128:131], v[32:35], a[32:35], v[128:131]
    ds_read_b64_tr_b16 v[48:49], v9 offset:0
    s_add_u32 m0, s96, 49152
    v_exp_f32 v247, v247
    v_mfma_f32_16x16x32_bf16 v[128:131], v[36:39], a[48:51], v[128:131]
    s_add_u32 s99, s17, 327680
    buffer_load_dwordx4 v5, s[56:59], s99 offen lds
    s_waitcnt lgkmcnt(1)
    v_mfma_f32_16x16x32_bf16 v[212:215], v[84:87], v[112:115], 0
    v_exp_f32 v248, v248
    v_bfe_u32 v19, v0, 2, 3
    v_and_b32 v21, 3, v0
    v_mfma_f32_16x16x32_bf16 v[220:223], v[84:87], v[28:31], 0
    v_lshlrev_b32 v21, 2, v21
    v_lshl_add_u32 v19, v19, 7, v21
    v_and_b32 v18, 1, v0
    v_lshlrev_b32 v18, 7, v18
    v_mfma_f32_16x16x32_bf16 v[132:135], v[32:35], a[36:39], v[132:135]
    ds_read_b64_tr_b16 v[50:51], v9 offset:256
    v_bfe_u32 v21, v0, 1, 1
    v_lshl_add_u32 v18, v21, 2, v18
    v_fma_f32 v249, v249, s97, v12
    v_mfma_f32_16x16x32_bf16 v[132:135], v[36:39], a[52:55], v[132:135]
    buffer_load_dwordx4 v6, s[56:59], s99 offen offset:1024 lds
    v_exp_f32 v249, v249
    v_fma_f32 v250, v250, s97, v12
    v_mfma_f32_16x16x32_bf16 v[144:147], v[32:35], a[40:43], v[144:147]
    ds_read_b64_tr_b16 v[52:53], v9 offset:8192
    v_exp_f32 v250, v250
    v_fma_f32 v251, v251, s97, v12
    v_mfma_f32_16x16x32_bf16 v[144:147], v[36:39], a[56:59], v[144:147]
    buffer_load_dwordx4 v5, s[60:63], s99 offen offset:2048 lds
    v_exp_f32 v251, v251
    v_fma_f32 v252, v252, s97, v12
    v_mfma_f32_16x16x32_bf16 v[148:151], v[32:35], a[44:47], v[148:151]
    buffer_load_dwordx4 v6, s[60:63], s99 offen offset:3072 lds
    s_add_u32 m0, s96, 32768
    v_exp_f32 v252, v252
    v_mfma_f32_16x16x32_bf16 v[148:151], v[36:39], a[60:63], v[148:151]
    ds_read_b64_tr_b16 v[54:55], v9 offset:8448
    v_fma_f32 v253, v253, s97, v12
    v_fma_f32 v254, v254, s97, v12
    v_mfma_f32_16x16x32_bf16 v[160:163], v[40:43], a[32:35], v[160:163]
    ds_read_b64_tr_b16 v[32:33], v9 offset:1024
    s_add_u32 s99, s17, 360448
    v_exp_f32 v253, v253
    v_mfma_f32_16x16x32_bf16 v[160:163], v[44:47], a[48:51], v[160:163]
    ds_read_b64_tr_b16 v[34:35], v9 offset:1280
    v_exp_f32 v254, v254
    v_fma_f32 v255, v255, s97, v12
    v_mfma_f32_16x16x32_bf16 v[164:167], v[40:43], a[36:39], v[164:167]
    buffer_load_dwordx4 v5, s[56:59], s99 offen lds
    v_exp_f32 v255, v255
    v_add_f32 v13, v240, v241
    v_mfma_f32_16x16x32_bf16 v[164:167], v[44:47], a[52:55], v[164:167]
    ds_read_b64_tr_b16 v[36:37], v9 offset:9216
    v_add_f32 v13, v13, v242
    v_add_f32 v13, v13, v243
    v_add_f32 v13, v13, v244
    v_mfma_f32_16x16x32_bf16 v[176:179], v[40:43], a[40:43], v[176:179]
    buffer_load_dwordx4 v6, s[56:59], s99 offen offset:1024 lds
    v_add_f32 v13, v13, v245
    v_add_f32 v13, v13, v246
    v_add_f32 v13, v13, v247
    v_mfma_f32_16x16x32_bf16 v[176:179], v[44:47], a[56:59], v[176:179]
    ds_read_b64_tr_b16 v[38:39], v9 offset:9472
    v_add_f32 v13, v13, v248
    v_add_f32 v13, v13, v249
    v_add_f32 v13, v13, v250
    v_mfma_f32_16x16x32_bf16 v[180:183], v[40:43], a[44:47], v[180:183]
    buffer_load_dwordx4 v5, s[60:63], s99 offen offset:2048 lds
    v_add_f32 v13, v13, v251
    v_add_f32 v13, v13, v252
    v_add_f32 v13, v13, v253
    v_mfma_f32_16x16x32_bf16 v[180:183], v[44:47], a[60:63], v[180:183]
    s_waitcnt lgkmcnt(4)
    v_add_f32 v13, v13, v254
    v_add_f32 v13, v13, v255
    v_rcp_f32 v13, v13
    v_mfma_f32_16x16x32_bf16 v[128:131], v[48:51], a[64:67], v[128:131]
    ds_read_b64_tr_b16 v[40:41], v9 offset:2048
    v_mul_f32 v240, v240, v13
    v_mul_f32 v241, v241, v13
    v_mul_f32 v242, v242, v13
    v_mfma_f32_16x16x32_bf16 v[128:131], v[52:55], a[80:83], v[128:131]
    ds_read_b64_tr_b16 v[42:43], v9 offset:2304
    v_mul_f32 v243, v243, v13
    v_mul_f32 v244, v244, v13
    v_mul_f32 v245, v245, v13
    v_mfma_f32_16x16x32_bf16 v[132:135], v[48:51], a[68:71], v[132:135]
    buffer_load_dwordx4 v6, s[60:63], s99 offen offset:3072 lds
    s_add_u32 m0, s96, 0
    v_mul_f32 v246, v246, v13
    v_mul_f32 v247, v247, v13
    v_mfma_f32_16x16x32_bf16 v[132:135], v[52:55], a[84:87], v[132:135]
    ds_read_b64_tr_b16 v[44:45], v9 offset:10240
    s_add_u32 s99, s17, 131072
    v_mul_f32 v248, v248, v13
    v_mul_f32 v249, v249, v13
    v_mfma_f32_16x16x32_bf16 v[144:147], v[48:51], a[72:75], v[144:147]
    buffer_load_dwordx4 v5, s[56:59], s99 offen lds
    v_mul_f32 v250, v250, v13
    v_mul_f32 v251, v251, v13
    v_mul_f32 v252, v252, v13
    v_mfma_f32_16x16x32_bf16 v[144:147], v[52:55], a[88:91], v[144:147]
    ds_read_b64_tr_b16 v[46:47], v9 offset:10496
    v_mul_f32 v253, v253, v13
    v_mul_f32 v254, v254, v13
    v_mul_f32 v255, v255, v13
    v_mfma_f32_16x16x32_bf16 v[148:151], v[48:51], a[76:79], v[148:151]
    buffer_load_dwordx4 v6, s[56:59], s99 offen offset:1024 lds
    v_cvt_pk_bf16_f32 v240, v240, v241
    v_cvt_pk_bf16_f32 v241, v242, v243
    v_cvt_pk_bf16_f32 v242, v244, v245
    v_mfma_f32_16x16x32_bf16 v[148:151], v[52:55], a[92:95], v[148:151]
    s_waitcnt lgkmcnt(4)
    v_cvt_pk_bf16_f32 v243, v246, v247
    v_cvt_pk_bf16_f32 v244, v248, v249
    v_cvt_pk_bf16_f32 v245, v250, v251
    v_cvt_pk_bf16_f32 v246, v252, v253
    v_mfma_f32_16x16x32_bf16 v[160:163], v[32:35], a[64:67], v[160:163]
    ds_read_b64_tr_b16 v[48:49], v9 offset:3072
    v_cvt_pk_bf16_f32 v247, v254, v255
    v_mfma_f32_16x16x32_bf16 v[160:163], v[36:39], a[80:83], v[160:163]
    buffer_load_dwordx4 v5, s[60:63], s99 offen offset:2048 lds
    v_cvt_pk_bf16_f32 v120, v120, v121
    v_mfma_f32_16x16x32_bf16 v[164:167], v[32:35], a[68:71], v[164:167]
    ds_read_b64_tr_b16 v[50:51], v9 offset:3328
    v_cvt_pk_bf16_f32 v121, v122, v123
    v_mfma_f32_16x16x32_bf16 v[164:167], v[36:39], a[84:87], v[164:167]
    ds_read_b64_tr_b16 v[52:53], v9 offset:11264
    v_cvt_pk_bf16_f32 v122, v124, v125
    v_mfma_f32_16x16x32_bf16 v[176:179], v[32:35], a[72:75], v[176:179]
    buffer_load_dwordx4 v6, s[60:63], s99 offen offset:3072 lds
    v_cvt_pk_bf16_f32 v123, v126, v127
    v_mfma_f32_16x16x32_bf16 v[176:179], v[36:39], a[88:91], v[176:179]
    s_waitcnt vmcnt(15)
    v_mov_b32 v27, 2
    buffer_store_dword v27, off, s[72:75], s14 sc1
    v_mfma_f32_16x16x32_bf16 v[180:183], v[32:35], a[76:79], v[180:183]
    ds_read_b64_tr_b16 v[54:55], v9 offset:11520
    s_lshl_b32 s100, s94, 10
    s_add_u32 s100, s100, 10551296
    v_add_u32 v19, s100, v19
    ds_write_b128 v14, v[240:243]
    ds_write_b128 v14, v[244:247] offset:16
    ds_read_b64_tr_b16 v[88:89], v15 offset:0
    ds_read_b64_tr_b16 v[90:91], v15 offset:512
    ds_read_b64_tr_b16 v[92:93], v15 offset:1024
    ds_read_b64_tr_b16 v[94:95], v15 offset:1536
    v_add_u32 v240, s0, v11
    ds_write_b128 v240, v[192:195] offset:0
    ds_write_b128 v240, v[196:199] offset:1024
    ds_write_b128 v240, v[200:203] offset:2048
    ds_write_b128 v240, v[204:207] offset:3072
    v_xor_b32 v241, 8192, v240
    s_waitcnt lgkmcnt(6)
    v_mfma_f32_16x16x32_bf16 v[208:211], v[88:91], v[120:123], v[208:211]
    v_mfma_f32_16x16x32_bf16 v[216:219], v[88:91], v[28:31], v[216:219]
    s_waitcnt lgkmcnt(4)
    v_mfma_f32_16x16x32_bf16 v[212:215], v[92:95], v[120:123], v[212:215]
    v_mfma_f32_16x16x32_bf16 v[220:223], v[92:95], v[28:31], v[220:223]
    v_mfma_f32_16x16x32_bf16 v[180:183], v[36:39], a[92:95], v[180:183]
    s_waitcnt lgkmcnt(0)
    s_barrier
    s_lshr_b32 s100, s94, 1
    s_lshl_b32 s100, s100, 3
    s_add_u32 s100, s100, s88
    s_lshl_b32 s100, s100, 8
    v_add_u32 v18, s100, v18
    s_and_b32 s100, s94, 1
    s_lshl_b32 s100, s100, 3
    s_add_u32 s100, s100, 10551296
    v_add_u32 v18, s100, v18
    v_mfma_f32_16x16x32_bf16 v[128:131], v[40:43], a[96:99], v[128:131]
    ds_read_b64_tr_b16 v[32:33], v9 offset:16384
    v_lshrrev_b32 v110, 2, v0
    v_lshlrev_b32 v110, 7, v110
    v_mfma_f32_16x16x32_bf16 v[128:131], v[44:47], a[112:115], v[128:131]
    ds_read_b64_tr_b16 v[34:35], v9 offset:16640
    v_and_b32 v111, 3, v0
    v_lshl_add_u32 v110, v111, 3, v110
    v_mfma_f32_16x16x32_bf16 v[132:135], v[40:43], a[100:103], v[132:135]
    ds_read_b64_tr_b16 v[36:37], v9 offset:24576
    v_add_u32 v110, s96, v110
    v_bfe_u32 v111, v0, 3, 2
    v_mfma_f32_16x16x32_bf16 v[132:135], v[44:47], a[116:119], v[132:135]
    buffer_load_dword v21, v18, s[72:75], 0 offen offset:1024 sc1
    v_lshl_add_u32 v96, v111, 5, v110
    v_xor_b32 v97, 32, v96
    v_mfma_f32_16x16x32_bf16 v[144:147], v[40:43], a[104:107], v[144:147]
    ds_read_b64_tr_b16 v[38:39], v9 offset:24832
    v_xor_b32 v98, 64, v96
    v_xor_b32 v99, 96, v96
    v_mfma_f32_16x16x32_bf16 v[144:147], v[44:47], a[120:123], v[144:147]
    ds_read_b128 v[224:227], v241 offset:0
    v_add_u32 v100, 0x10000, v96
    v_add_u32 v101, 0x10000, v97
    v_mfma_f32_16x16x32_bf16 v[148:151], v[40:43], a[108:111], v[148:151]
    buffer_load_dword v23, v19, s[72:75], 0 offen sc1
    s_add_u32 m0, s96, 114688
    v_add_u32 v102, 0x10000, v98
    v_mfma_f32_16x16x32_bf16 v[148:151], v[44:47], a[124:127], v[148:151]
    v_add_u32 v103, 0x10000, v99
    v_add_u32 v104, 0x20000, v96
    v_add_u32 v105, 0x20000, v97
    v_mfma_f32_16x16x32_bf16 v[160:163], v[48:51], a[96:99], v[160:163]
    ds_read_b64_tr_b16 v[40:41], v9 offset:17408
    s_add_u32 s99, s17, 163840
    v_add_u32 v106, 0x20000, v98
    v_mfma_f32_16x16x32_bf16 v[160:163], v[52:55], a[112:115], v[160:163]
    ds_read_b64_tr_b16 v[42:43], v9 offset:17664
    v_add_u32 v107, 0x20000, v99
    v_lshrrev_b32 v110, 5, v0
    v_mfma_f32_16x16x32_bf16 v[164:167], v[48:51], a[100:103], v[164:167]
    ds_read_b64_tr_b16 v[44:45], v9 offset:25600
    v_bfe_u32 v111, v0, 3, 2
    v_lshl_add_u32 v110, v110, 4, v111
    v_mfma_f32_16x16x32_bf16 v[164:167], v[52:55], a[116:119], v[164:167]
    buffer_load_dwordx4 v5, s[56:59], s99 offen lds
    v_and_b32 v111, 0x70, v5
    v_lshl_add_u32 v14, v110, 10, v111
    v_add_u32 v15, 7168, v14
    v_mfma_f32_16x16x32_bf16 v[176:179], v[48:51], a[104:107], v[176:179]
    ds_read_b64_tr_b16 v[46:47], v9 offset:25856
    s_waitcnt lgkmcnt(4)
    v_add_f32 v208, v208, v224
    v_add_f32 v209, v209, v225
    v_add_f32 v210, v210, v226
    v_mfma_f32_16x16x32_bf16 v[176:179], v[52:55], a[120:123], v[176:179]
    ds_read_b128 v[228:231], v241 offset:1024
    v_add_f32 v211, v211, v227
    s_lshl_b32 s100, s7, 10
    v_add_u32 v108, s100, v11
    v_mfma_f32_16x16x32_bf16 v[180:183], v[48:51], a[108:111], v[180:183]
    buffer_load_dwordx4 v6, s[56:59], s99 offen offset:1024 lds
    v_xor_b32 v109, 1024, v108
    v_xor_b32 v110, 2048, v108
    v_xor_b32 v111, 3072, v108
    v_mfma_f32_16x16x32_bf16 v[180:183], v[52:55], a[124:127], v[180:183]
    v_mfma_f32_16x16x32_bf16 v[128:131], v[32:35], a[128:131], v[128:131]
    ds_read_b64_tr_b16 v[48:49], v9 offset:18432
    v_mfma_f32_16x16x32_bf16 v[128:131], v[36:39], a[144:147], v[128:131]
    ds_read_b64_tr_b16 v[50:51], v9 offset:18688
    v_mfma_f32_16x16x32_bf16 v[132:135], v[32:35], a[132:135], v[132:135]
    ds_read_b64_tr_b16 v[52:53], v9 offset:26624
    v_mfma_f32_16x16x32_bf16 v[132:135], v[36:39], a[148:151], v[132:135]
    ds_read_b64_tr_b16 v[54:55], v9 offset:26880
    v_mfma_f32_16x16x32_bf16 v[144:147], v[32:35], a[136:139], v[144:147]
    ds_read_b128 v[232:235], v241 offset:2048
    s_waitcnt lgkmcnt(5)
    v_add_f32 v212, v212, v228
    v_add_f32 v213, v213, v229
    v_add_f32 v214, v214, v230
    v_mfma_f32_16x16x32_bf16 v[144:147], v[36:39], a[152:155], v[144:147]
    ds_read_b128 v[236:239], v241 offset:3072
    v_add_f32 v215, v215, v231
    v_mfma_f32_16x16x32_bf16 v[148:151], v[32:35], a[140:143], v[148:151]
    buffer_load_dwordx4 v5, s[60:63], s99 offen offset:2048 lds
    v_mfma_f32_16x16x32_bf16 v[148:151], v[36:39], a[156:159], v[148:151]
    buffer_store_dwordx4 v[208:211], v16, s[72:75], s8 offen sc1
    buffer_store_dwordx4 v[212:215], v16, s[72:75], s9 offen sc1
    s_waitcnt lgkmcnt(1)
    v_add_f32 v216, v216, v232
    v_add_f32 v217, v217, v233
    v_add_f32 v218, v218, v234
    v_add_f32 v219, v219, v235
    buffer_store_dwordx4 v[216:219], v17, s[72:75], s8 offen sc1
    s_waitcnt lgkmcnt(0)
    v_add_f32 v220, v220, v236
    v_add_f32 v221, v221, v237
    v_add_f32 v222, v222, v238
    v_add_f32 v223, v223, v239
    buffer_store_dwordx4 v[220:223], v17, s[72:75], s9 offen sc1
    v_mfma_f32_16x16x32_bf16 v[160:163], v[40:43], a[128:131], v[160:163]
    ds_read_b64_tr_b16 v[32:33], v9 offset:19456
    v_mfma_f32_16x16x32_bf16 v[160:163], v[44:47], a[144:147], v[160:163]
    ds_read_b64_tr_b16 v[34:35], v9 offset:19712
    v_mfma_f32_16x16x32_bf16 v[164:167], v[40:43], a[132:135], v[164:167]
    ds_read_b64_tr_b16 v[36:37], v9 offset:27648
    v_mfma_f32_16x16x32_bf16 v[164:167], v[44:47], a[148:151], v[164:167]
    ds_read_b64_tr_b16 v[38:39], v9 offset:27904
    v_mfma_f32_16x16x32_bf16 v[176:179], v[40:43], a[136:139], v[176:179]
    v_mfma_f32_16x16x32_bf16 v[176:179], v[44:47], a[152:155], v[176:179]
    v_mfma_f32_16x16x32_bf16 v[180:183], v[40:43], a[140:143], v[180:183]
    buffer_load_dwordx4 v6, s[60:63], s99 offen offset:3072 lds
    v_mfma_f32_16x16x32_bf16 v[180:183], v[44:47], a[156:159], v[180:183]
    s_barrier
    s_waitcnt vmcnt(9)
    v_cmp_gt_u32 vcc, 2, v21
    s_nop 0
    s_cbranch_vccnz L_slowA1
L_okA1:
    v_mfma_f32_16x16x32_bf16 v[128:131], v[48:51], a[160:163], v[128:131]
    ds_read_b64_tr_b16 v[40:41], v7 offset:16384
    s_add_u32 m0, s96, 65536
    v_mfma_f32_16x16x32_bf16 v[128:131], v[52:55], a[176:179], v[128:131]
    ds_read_b64_tr_b16 v[42:43], v7 offset:16640
    s_add_u32 s99, s17, 262144
    v_mfma_f32_16x16x32_bf16 v[132:135], v[48:51], a[164:167], v[132:135]
    buffer_load_dwordx4 v5, s[56:59], s99 offen lds
    v_mfma_f32_16x16x32_bf16 v[132:135], v[52:55], a[180:183], v[132:135]
    ds_read_b64_tr_b16 v[44:45], v7 offset:24576
    v_mfma_f32_16x16x32_bf16 v[144:147], v[48:51], a[168:171], v[144:147]
    buffer_load_dwordx4 v6, s[56:59], s99 offen offset:1024 lds
    v_mfma_f32_16x16x32_bf16 v[144:147], v[52:55], a[184:187], v[144:147]
    ds_read_b64_tr_b16 v[46:47], v7 offset:24832
    v_mfma_f32_16x16x32_bf16 v[148:151], v[48:51], a[172:175], v[148:151]
    buffer_load_dwordx4 v5, s[60:63], s99 offen offset:2048 lds
    v_mfma_f32_16x16x32_bf16 v[148:151], v[52:55], a[188:191], v[148:151]
    s_waitcnt lgkmcnt(4)
    v_mfma_f32_16x16x32_bf16 v[160:163], v[32:35], a[160:163], v[160:163]
    ds_read_b64_tr_b16 v[48:49], v7 offset:17408
    v_mfma_f32_16x16x32_bf16 v[160:163], v[36:39], a[176:179], v[160:163]
    ds_read_b64_tr_b16 v[50:51], v7 offset:17664
    v_mfma_f32_16x16x32_bf16 v[164:167], v[32:35], a[164:167], v[164:167]
    buffer_load_dwordx4 v6, s[60:63], s99 offen offset:3072 lds
    s_add_u32 s25, s15, 0
    v_mfma_f32_16x16x32_bf16 v[164:167], v[36:39], a[180:183], v[164:167]
    ds_read_b64_tr_b16 v[52:53], v7 offset:25600
    v_mfma_f32_16x16x32_bf16 v[176:179], v[32:35], a[168:171], v[176:179]
    buffer_load_dwordx4 a[0:3], v108, s[72:75], s25 offen sc1
    v_mfma_f32_16x16x32_bf16 v[176:179], v[36:39], a[184:187], v[176:179]
    ds_read_b64_tr_b16 v[54:55], v7 offset:25856
    v_mfma_f32_16x16x32_bf16 v[180:183], v[32:35], a[172:175], v[180:183]
    buffer_load_dwordx4 a[4:7], v109, s[72:75], s25 offen sc1
    v_mfma_f32_16x16x32_bf16 v[180:183], v[36:39], a[188:191], v[180:183]
    s_waitcnt lgkmcnt(4)
    v_mfma_f32_16x16x32_bf16 v[128:131], v[40:43], a[192:195], v[128:131]
    ds_read_b64_tr_b16 v[32:33], v7 offset:18432
    v_mfma_f32_16x16x32_bf16 v[128:131], v[44:47], a[208:211], v[128:131]
    ds_read_b64_tr_b16 v[34:35], v7 offset:18688
    v_mfma_f32_16x16x32_bf16 v[132:135], v[40:43], a[196:199], v[132:135]
    buffer_load_dwordx4 a[8:11], v110, s[72:75], s25 offen sc1
    v_mfma_f32_16x16x32_bf16 v[132:135], v[44:47], a[212:215], v[132:135]
    ds_read_b64_tr_b16 v[36:37], v7 offset:26624
    v_mfma_f32_16x16x32_bf16 v[144:147], v[40:43], a[200:203], v[144:147]
    buffer_load_dwordx4 a[12:15], v111, s[72:75], s25 offen sc1
    s_add_u32 s25, s15, 4096
    v_mfma_f32_16x16x32_bf16 v[144:147], v[44:47], a[216:219], v[144:147]
    ds_read_b64_tr_b16 v[38:39], v7 offset:26880
    v_mfma_f32_16x16x32_bf16 v[148:151], v[40:43], a[204:207], v[148:151]
    buffer_load_dwordx4 a[16:19], v108, s[72:75], s25 offen sc1
    v_mfma_f32_16x16x32_bf16 v[148:151], v[44:47], a[220:223], v[148:151]
    s_waitcnt lgkmcnt(4)
    v_mfma_f32_16x16x32_bf16 v[160:163], v[48:51], a[192:195], v[160:163]
    ds_read_b64_tr_b16 v[40:41], v7 offset:19456
    v_mfma_f32_16x16x32_bf16 v[160:163], v[52:55], a[208:211], v[160:163]
    ds_read_b64_tr_b16 v[42:43], v7 offset:19712
    v_mfma_f32_16x16x32_bf16 v[164:167], v[48:51], a[196:199], v[164:167]
    buffer_load_dwordx4 a[20:23], v109, s[72:75], s25 offen sc1
    v_mfma_f32_16x16x32_bf16 v[164:167], v[52:55], a[212:215], v[164:167]
    ds_read_b64_tr_b16 v[44:45], v7 offset:27648
    v_mfma_f32_16x16x32_bf16 v[176:179], v[48:51], a[200:203], v[176:179]
    buffer_load_dwordx4 a[24:27], v110, s[72:75], s25 offen sc1
    v_mfma_f32_16x16x32_bf16 v[176:179], v[52:55], a[216:219], v[176:179]
    ds_read_b64_tr_b16 v[46:47], v7 offset:27904
    v_mfma_f32_16x16x32_bf16 v[180:183], v[48:51], a[204:207], v[180:183]
    buffer_load_dwordx4 a[28:31], v111, s[72:75], s25 offen sc1
    v_mfma_f32_16x16x32_bf16 v[180:183], v[52:55], a[220:223], v[180:183]
    s_waitcnt lgkmcnt(4)
    s_barrier
    v_mfma_f32_16x16x32_bf16 v[128:131], v[32:35], a[224:227], v[128:131]
    v_mfma_f32_16x16x32_bf16 v[128:131], v[36:39], a[240:243], v[128:131]
    buffer_load_dword v21, v18, s[72:75], 0 offen sc1
    s_add_u32 m0, s96, 147456
    v_mfma_f32_16x16x32_bf16 v[132:135], v[32:35], a[228:231], v[132:135]
    s_add_u32 s99, s17, 294912
    buffer_load_dwordx4 v5, s[56:59], s99 offen lds
    v_mfma_f32_16x16x32_bf16 v[132:135], v[36:39], a[244:247], v[132:135]
    v_mfma_f32_16x16x32_bf16 v[144:147], v[32:35], a[232:235], v[144:147]
    buffer_load_dwordx4 v6, s[56:59], s99 offen offset:1024 lds
    v_mfma_f32_16x16x32_bf16 v[144:147], v[36:39], a[248:251], v[144:147]
    buffer_load_dwordx4 v5, s[60:63], s99 offen offset:2048 lds
    v_mfma_f32_16x16x32_bf16 v[148:151], v[32:35], a[236:239], v[148:151]
    buffer_load_dwordx4 v6, s[60:63], s99 offen offset:3072 lds
    s_add_u32 m0, s96, 81920
    v_mfma_f32_16x16x32_bf16 v[148:151], v[36:39], a[252:255], v[148:151]
    s_waitcnt lgkmcnt(0)
    v_mfma_f32_16x16x32_bf16 v[160:163], v[40:43], a[224:227], v[160:163]
    s_add_u32 s99, s17, 65536
    v_mfma_f32_16x16x32_bf16 v[160:163], v[44:47], a[240:243], v[160:163]
    buffer_load_dwordx4 v5, s[56:59], s99 offen lds
    v_mfma_f32_16x16x32_bf16 v[164:167], v[40:43], a[228:231], v[164:167]
    v_mfma_f32_16x16x32_bf16 v[164:167], v[44:47], a[244:247], v[164:167]
    buffer_load_dwordx4 v6, s[56:59], s99 offen offset:1024 lds
    v_mfma_f32_16x16x32_bf16 v[176:179], v[40:43], a[232:235], v[176:179]
    v_mfma_f32_16x16x32_bf16 v[176:179], v[44:47], a[248:251], v[176:179]
    buffer_load_dwordx4 v5, s[60:63], s99 offen offset:2048 lds
    v_mfma_f32_16x16x32_bf16 v[180:183], v[40:43], a[236:239], v[180:183]
    buffer_load_dwordx4 v6, s[60:63], s99 offen offset:3072 lds
    s_add_u32 s25, s15, 40960
    v_mfma_f32_16x16x32_bf16 v[180:183], v[44:47], a[252:255], v[180:183]
    buffer_load_dwordx4 a[32:35], v108, s[72:75], s25 offen sc1
    buffer_load_dwordx4 a[36:39], v109, s[72:75], s25 offen sc1
    buffer_load_dwordx4 a[40:43], v110, s[72:75], s25 offen sc1
    buffer_load_dwordx4 a[44:47], v111, s[72:75], s25 offen sc1
    s_add_u32 s25, s15, 45056
    buffer_load_dwordx4 a[48:51], v108, s[72:75], s25 offen sc1
    buffer_load_dwordx4 a[52:55], v109, s[72:75], s25 offen sc1
    buffer_load_dwordx4 a[56:59], v110, s[72:75], s25 offen sc1
    buffer_load_dwordx4 a[60:63], v111, s[72:75], s25 offen sc1
    s_barrier
    s_cmp_lg_u32 s88, 0
    s_cbranch_scc1 L_nored1
    v_cmp_gt_u32 vcc, 1, v22
    s_nop 0
    s_cbranch_vccnz L_slowA2
L_okA2:
    buffer_load_dwordx4 v[192:195], v24, s[72:75], s10 offen offset:0 sc1
    buffer_load_dwordx4 v[196:199], v24, s[72:75], s10 offen offset:640 sc1
    buffer_load_dwordx4 v[200:203], v24, s[72:75], s10 offen offset:1280 sc1
    buffer_load_dwordx4 v[204:207], v24, s[72:75], s10 offen offset:1920 sc1
    buffer_load_dwordx4 v[208:211], v24, s[72:75], s10 offen offset:2560 sc1
    buffer_load_dwordx4 v[212:215], v24, s[72:75], s10 offen offset:3200 sc1
    buffer_load_dwordx4 v[216:219], v24, s[72:75], s11 offen offset:0 sc1
    buffer_load_dwordx4 v[220:223], v24, s[72:75], s11 offen offset:640 sc1
    buffer_load_dwordx4 v[224:227], v24, s[72:75], s11 offen offset:1280 sc1
    buffer_load_dwordx4 v[228:231], v24, s[72:75], s11 offen offset:1920 sc1
    buffer_load_dwordx4 v[232:235], v24, s[72:75], s11 offen offset:2560 sc1
    buffer_load_dwordx4 v[236:239], v24, s[72:75], s11 offen offset:3200 sc1
    buffer_load_dwordx4 v[240:243], v24, s[72:75], s12 offen offset:0 sc1
    buffer_load_dwordx4 v[244:247], v24, s[72:75], s12 offen offset:640 sc1
    buffer_load_dwordx4 v[248:251], v24, s[72:75], s12 offen offset:1280 sc1
    buffer_load_dwordx4 v[252:255], v24, s[72:75], s12 offen offset:1920 sc1
L_nored1:
    s_waitcnt vmcnt(16)
    v_cmp_gt_u32 vcc, 2, v21
    s_nop 0
    s_cbranch_vccnz L_slowA3
L_okA3:
    s_add_u32 s25, s15, 16384
    buffer_load_dwordx4 a[64:67], v108, s[72:75], s25 offen sc1
    v_lshlrev_b32 v1, 3, v0
    v_mul_f32 v128, s98, v128
    v_mul_f32 v129, s98, v129
    v_mul_f32 v130, s98, v130
    v_mul_f32 v131, s98, v131
    v_mul_f32 v132, s98, v132
    v_mul_f32 v133, s98, v133
    v_mul_f32 v134, s98, v134
    v_mul_f32 v135, s98, v135
    v_exp_f32 v128, v128
    buffer_load_dwordx4 a[68:71], v109, s[72:75], s25 offen sc1
    v_exp_f32 v129, v129
    v_exp_f32 v130, v130
    v_exp_f32 v131, v131
    v_exp_f32 v132, v132
    v_exp_f32 v133, v133
    buffer_load_dwordx4 a[72:75], v110, s[72:75], s25 offen sc1
    v_exp_f32 v134, v134
    v_exp_f32 v135, v135
    v_add_f32 v128, 1.0, v128
    v_add_f32 v129, 1.0, v129
    v_add_f32 v130, 1.0, v130
    v_add_f32 v131, 1.0, v131
    v_add_f32 v132, 1.0, v132
    v_add_f32 v133, 1.0, v133
    buffer_load_dwordx4 a[76:79], v111, s[72:75], s25 offen sc1
    v_add_f32 v134, 1.0, v134
    v_add_f32 v135, 1.0, v135
    v_rcp_f32 v128, v128
    v_rcp_f32 v129, v129
    v_rcp_f32 v130, v130
    v_rcp_f32 v131, v131
    s_add_u32 s25, s15, 20480
    buffer_load_dwordx4 a[80:83], v108, s[72:75], s25 offen sc1
    v_rcp_f32 v132, v132
    v_rcp_f32 v133, v133
    v_rcp_f32 v134, v134
    v_rcp_f32 v135, v135
    v_mul_f32 v160, v160, v128
    v_mul_f32 v161, v161, v129
    s_cmp_lg_u32 s88, 0
    s_cbranch_scc1 L_nored2
    s_waitcnt vmcnt(5)
    v_pk_add_f32 v[192:193], v[192:193], v[196:197]
    v_pk_add_f32 v[194:195], v[194:195], v[198:199]
    v_pk_add_f32 v[192:193], v[192:193], v[200:201]
    v_pk_add_f32 v[194:195], v[194:195], v[202:203]
    v_pk_add_f32 v[192:193], v[192:193], v[204:205]
    v_pk_add_f32 v[194:195], v[194:195], v[206:207]
    v_pk_add_f32 v[192:193], v[192:193], v[208:209]
    v_pk_add_f32 v[194:195], v[194:195], v[210:211]
    v_pk_add_f32 v[192:193], v[192:193], v[212:213]
    v_pk_add_f32 v[194:195], v[194:195], v[214:215]
    v_pk_add_f32 v[192:193], v[192:193], v[216:217]
    v_pk_add_f32 v[194:195], v[194:195], v[218:219]
    v_pk_add_f32 v[192:193], v[192:193], v[220:221]
    v_pk_add_f32 v[194:195], v[194:195], v[222:223]
    v_pk_add_f32 v[192:193], v[192:193], v[224:225]
    v_pk_add_f32 v[194:195], v[194:195], v[226:227]
    v_pk_add_f32 v[192:193], v[192:193], v[228:229]
    v_pk_add_f32 v[194:195], v[194:195], v[230:231]
    v_pk_add_f32 v[192:193], v[192:193], v[232:233]
    v_pk_add_f32 v[194:195], v[194:195], v[234:235]
    v_pk_add_f32 v[192:193], v[192:193], v[236:237]
    v_pk_add_f32 v[194:195], v[194:195], v[238:239]
    v_pk_add_f32 v[192:193], v[192:193], v[240:241]
    v_pk_add_f32 v[194:195], v[194:195], v[242:243]
    v_pk_add_f32 v[192:193], v[192:193], v[244:245]
    v_pk_add_f32 v[194:195], v[194:195], v[246:247]
    v_pk_add_f32 v[192:193], v[192:193], v[248:249]
    v_pk_add_f32 v[194:195], v[194:195], v[250:251]
    v_pk_add_f32 v[192:193], v[192:193], v[252:253]
    v_pk_add_f32 v[194:195], v[194:195], v[254:255]
    v_add_f32 v12, v192, v193
    v_add_f32 v13, v194, v195
    v_cmp_u_f32 vcc, v12, v13
    s_nop 0
    s_cbranch_vccnz L_slowred
L_okred:
    v_cvt_pk_bf16_f32 v196, v192, v193
    v_cvt_pk_bf16_f32 v197, v194, v195
    buffer_store_dwordx2 v[196:197], v25, s[72:75], s13 offen sc1
L_nored2:
    buffer_load_dwordx4 a[84:87], v109, s[72:75], s25 offen sc1
    v_mul_f32 v162, v162, v130
    v_mul_f32 v163, v163, v131
    v_mul_f32 v164, v164, v132
    v_mul_f32 v165, v165, v133
    v_mul_f32 v166, v166, v134
    v_mul_f32 v167, v167, v135
    v_cvt_pk_bf16_f32 v128, v160, v161
    v_cvt_pk_bf16_f32 v129, v162, v163
    buffer_store_dwordx2 v[128:129], v1, s[72:75], s21 offen offset:0 sc1
    buffer_load_dwordx4 a[88:91], v110, s[72:75], s25 offen sc1
    v_cvt_pk_bf16_f32 v132, v164, v165
    v_cvt_pk_bf16_f32 v133, v166, v167
    buffer_store_dwordx2 v[132:133], v1, s[72:75], s21 offen offset:1024 sc1
    v_mul_f32 v144, s98, v144
    v_mul_f32 v145, s98, v145
    v_mul_f32 v146, s98, v146
    v_mul_f32 v147, s98, v147
    v_mul_f32 v148, s98, v148
    v_mul_f32 v149, s98, v149
    buffer_load_dwordx4 a[92:95], v111, s[72:75], s25 offen sc1
    v_mul_f32 v150, s98, v150
    v_mul_f32 v151, s98, v151
    v_exp_f32 v144, v144
    v_exp_f32 v145, v145
    v_exp_f32 v146, v146
    v_exp_f32 v147, v147
    s_add_u32 s25, s15, 32768
    buffer_load_dwordx4 a[96:99], v108, s[72:75], s25 offen sc1
    v_exp_f32 v148, v148
    v_exp_f32 v149, v149
    v_exp_f32 v150, v150
    v_exp_f32 v151, v151
    v_add_f32 v144, 1.0, v144
    v_add_f32 v145, 1.0, v145
    buffer_load_dwordx4 a[100:103], v109, s[72:75], s25 offen sc1
    v_add_f32 v146, 1.0, v146
    v_add_f32 v147, 1.0, v147
    v_add_f32 v148, 1.0, v148
    v_add_f32 v149, 1.0, v149
    v_add_f32 v150, 1.0, v150
    v_add_f32 v151, 1.0, v151
    v_rcp_f32 v144, v144
    v_rcp_f32 v145, v145
    buffer_load_dwordx4 a[104:107], v110, s[72:75], s25 offen sc1
    v_rcp_f32 v146, v146
    v_rcp_f32 v147, v147
    v_rcp_f32 v148, v148
    v_rcp_f32 v149, v149
    v_rcp_f32 v150, v150
    buffer_load_dwordx4 a[108:111], v111, s[72:75], s25 offen sc1
    v_rcp_f32 v151, v151
    v_mul_f32 v176, v176, v144
    v_mul_f32 v177, v177, v145
    v_mul_f32 v178, v178, v146
    v_mul_f32 v179, v179, v147
    v_mul_f32 v180, v180, v148
    v_mul_f32 v181, v181, v149
    v_mul_f32 v182, v182, v150
    v_mul_f32 v183, v183, v151
    s_add_u32 s25, s15, 36864
    buffer_load_dwordx4 a[112:115], v108, s[72:75], s25 offen sc1
    v_cvt_pk_bf16_f32 v144, v176, v177
    v_cvt_pk_bf16_f32 v145, v178, v179
    buffer_store_dwordx2 v[144:145], v1, s[72:75], s21 offen offset:2048 sc1
    v_cvt_pk_bf16_f32 v148, v180, v181
    v_cvt_pk_bf16_f32 v149, v182, v183
    buffer_store_dwordx2 v[148:149], v1, s[72:75], s21 offen offset:3072 sc1
    buffer_load_dwordx4 a[116:119], v109, s[72:75], s25 offen sc1
    buffer_load_dwordx4 a[120:123], v110, s[72:75], s25 offen sc1
    buffer_load_dwordx4 a[124:127], v111, s[72:75], s25 offen sc1
    s_waitcnt vmcnt(3)
    v_mov_b32 v27, 3
    buffer_store_dword v27, off, s[72:75], s14 sc1
    ds_read_b64_tr_b16 v[32:33], v104 offset:0
    ds_read_b64_tr_b16 v[34:35], v104 offset:2048
    ds_read_b64_tr_b16 v[36:37], v100 offset:32768
    ds_read_b64_tr_b16 v[38:39], v100 offset:34816
    ds_read_b64_tr_b16 v[40:41], v105 offset:0
    ds_read_b64_tr_b16 v[42:43], v105 offset:2048
    ds_read_b64_tr_b16 v[44:45], v101 offset:32768
    ds_read_b64_tr_b16 v[46:47], v101 offset:34816
    s_waitcnt lgkmcnt(4)
    v_mfma_f32_16x16x32_bf16 v[64:67], v[32:35], a[0:3], 0
    ds_read_b64_tr_b16 v[48:49], v106 offset:0
    s_add_u32 m0, s96, 16384
    v_mfma_f32_16x16x32_bf16 v[64:67], v[36:39], a[16:19], v[64:67]
    ds_read_b64_tr_b16 v[50:51], v106 offset:2048
    s_add_u32 s99, s17, 98304
    v_mfma_f32_16x16x32_bf16 v[68:71], v[32:35], a[4:7], 0
    ds_read_b64_tr_b16 v[52:53], v102 offset:32768
    v_mfma_f32_16x16x32_bf16 v[68:71], v[36:39], a[20:23], v[68:71]
    buffer_load_dwordx4 v5, s[56:59], s99 offen lds
    v_mfma_f32_16x16x32_bf16 v[72:75], v[32:35], a[8:11], 0
    ds_read_b64_tr_b16 v[54:55], v102 offset:34816
    v_mfma_f32_16x16x32_bf16 v[72:75], v[36:39], a[24:27], v[72:75]
    v_mfma_f32_16x16x32_bf16 v[76:79], v[32:35], a[12:15], 0
    buffer_load_dwordx4 v6, s[56:59], s99 offen offset:1024 lds
    v_mfma_f32_16x16x32_bf16 v[76:79], v[36:39], a[28:31], v[76:79]
    s_waitcnt lgkmcnt(4)
    v_mfma_f32_16x16x32_bf16 v[80:83], v[40:43], a[0:3], 0
    ds_read_b64_tr_b16 v[32:33], v107 offset:0
    v_mfma_f32_16x16x32_bf16 v[80:83], v[44:47], a[16:19], v[80:83]
    ds_read_b64_tr_b16 v[34:35], v107 offset:2048
    v_mfma_f32_16x16x32_bf16 v[84:87], v[40:43], a[4:7], 0
    ds_read_b64_tr_b16 v[36:37], v103 offset:32768
    v_mfma_f32_16x16x32_bf16 v[84:87], v[44:47], a[20:23], v[84:87]
    ds_read_b64_tr_b16 v[38:39], v103 offset:34816
    v_mfma_f32_16x16x32_bf16 v[88:91], v[40:43], a[8:11], 0
    v_mfma_f32_16x16x32_bf16 v[88:91], v[44:47], a[24:27], v[88:91]
    v_mfma_f32_16x16x32_bf16 v[92:95], v[40:43], a[12:15], 0
    buffer_load_dwordx4 v5, s[60:63], s99 offen offset:2048 lds
    v_mfma_f32_16x16x32_bf16 v[92:95], v[44:47], a[28:31], v[92:95]
    s_waitcnt lgkmcnt(4)
    v_mfma_f32_16x16x32_bf16 v[136:139], v[48:51], a[0:3], 0
    ds_read_b64_tr_b16 v[40:41], v96 offset:49152
    v_mfma_f32_16x16x32_bf16 v[136:139], v[52:55], a[16:19], v[136:139]
    ds_read_b64_tr_b16 v[42:43], v96 offset:51200
    v_mfma_f32_16x16x32_bf16 v[140:143], v[48:51], a[4:7], 0
    ds_read_b64_tr_b16 v[44:45], v96 offset:32768
    v_mfma_f32_16x16x32_bf16 v[140:143], v[52:55], a[20:23], v[140:143]
    ds_read_b64_tr_b16 v[46:47], v96 offset:34816
    v_mfma_f32_16x16x32_bf16 v[152:155], v[48:51], a[8:11], 0
    v_mfma_f32_16x16x32_bf16 v[152:155], v[52:55], a[24:27], v[152:155]
    v_mfma_f32_16x16x32_bf16 v[156:159], v[48:51], a[12:15], 0
    buffer_load_dwordx4 v6, s[60:63], s99 offen offset:3072 lds
    v_mfma_f32_16x16x32_bf16 v[156:159], v[52:55], a[28:31], v[156:159]
    s_waitcnt lgkmcnt(4)
    v_mfma_f32_16x16x32_bf16 v[168:171], v[32:35], a[0:3], 0
    ds_read_b64_tr_b16 v[48:49], v97 offset:49152
    v_mfma_f32_16x16x32_bf16 v[168:171], v[36:39], a[16:19], v[168:171]
    ds_read_b64_tr_b16 v[50:51], v97 offset:51200
    v_mfma_f32_16x16x32_bf16 v[172:175], v[32:35], a[4:7], 0
    ds_read_b64_tr_b16 v[52:53], v97 offset:32768
    v_mfma_f32_16x16x32_bf16 v[172:175], v[36:39], a[20:23], v[172:175]
    ds_read_b64_tr_b16 v[54:55], v97 offset:34816
    v_mfma_f32_16x16x32_bf16 v[184:187], v[32:35], a[8:11], 0
    v_mfma_f32_16x16x32_bf16 v[184:187], v[36:39], a[24:27], v[184:187]
    v_mfma_f32_16x16x32_bf16 v[188:191], v[32:35], a[12:15], 0
    buffer_load_dword v21, v18, s[72:75], 0 offen offset:1024 sc1
    v_mfma_f32_16x16x32_bf16 v[188:191], v[36:39], a[28:31], v[188:191]
    s_waitcnt lgkmcnt(4)
    v_mfma_f32_16x16x32_bf16 v[64:67], v[40:43], a[32:35], v[64:67]
    ds_read_b64_tr_b16 v[32:33], v98 offset:49152
    s_add_u32 m0, s96, 131072
    v_mfma_f32_16x16x32_bf16 v[64:67], v[44:47], a[48:51], v[64:67]
    ds_read_b64_tr_b16 v[34:35], v98 offset:51200
    s_add_u32 s99, s17, 393216
    v_mfma_f32_16x16x32_bf16 v[68:71], v[40:43], a[36:39], v[68:71]
    buffer_load_dwordx4 v5, s[56:59], s99 offen lds
    v_mfma_f32_16x16x32_bf16 v[68:71], v[44:47], a[52:55], v[68:71]
    ds_read_b64_tr_b16 v[36:37], v98 offset:32768
    v_mfma_f32_16x16x32_bf16 v[72:75], v[40:43], a[40:43], v[72:75]
    buffer_load_dwordx4 v6, s[56:59], s99 offen offset:1024 lds
    v_mfma_f32_16x16x32_bf16 v[72:75], v[44:47], a[56:59], v[72:75]
    ds_read_b64_tr_b16 v[38:39], v98 offset:34816
    v_mfma_f32_16x16x32_bf16 v[76:79], v[40:43], a[44:47], v[76:79]
    buffer_load_dwordx4 v5, s[60:63], s99 offen offset:2048 lds
    v_mfma_f32_16x16x32_bf16 v[76:79], v[44:47], a[60:63], v[76:79]
    s_waitcnt lgkmcnt(4)
    v_mfma_f32_16x16x32_bf16 v[80:83], v[48:51], a[32:35], v[80:83]
    ds_read_b64_tr_b16 v[40:41], v99 offset:49152
    v_mfma_f32_16x16x32_bf16 v[80:83], v[52:55], a[48:51], v[80:83]
    ds_read_b64_tr_b16 v[42:43], v99 offset:51200
    v_mfma_f32_16x16x32_bf16 v[84:87], v[48:51], a[36:39], v[84:87]
    buffer_load_dwordx4 v6, s[60:63], s99 offen offset:3072 lds
    s_add_u32 m0, s96, 98304
    v_mfma_f32_16x16x32_bf16 v[84:87], v[52:55], a[52:55], v[84:87]
    ds_read_b64_tr_b16 v[44:45], v99 offset:32768
    s_add_u32 s99, s17, 425984
    v_mfma_f32_16x16x32_bf16 v[88:91], v[48:51], a[40:43], v[88:91]
    buffer_load_dwordx4 v5, s[56:59], s99 offen lds
    v_mfma_f32_16x16x32_bf16 v[88:91], v[52:55], a[56:59], v[88:91]
    ds_read_b64_tr_b16 v[46:47], v99 offset:34816
    v_mfma_f32_16x16x32_bf16 v[92:95], v[48:51], a[44:47], v[92:95]
    buffer_load_dwordx4 v6, s[56:59], s99 offen offset:1024 lds
    v_mfma_f32_16x16x32_bf16 v[92:95], v[52:55], a[60:63], v[92:95]
    s_waitcnt lgkmcnt(4)
    v_mfma_f32_16x16x32_bf16 v[136:139], v[32:35], a[32:35], v[136:139]
    ds_read_b64_tr_b16 v[48:49], v96 offset:0
    v_mfma_f32_16x16x32_bf16 v[136:139], v[36:39], a[48:51], v[136:139]
    ds_read_b64_tr_b16 v[50:51], v96 offset:2048
    v_mfma_f32_16x16x32_bf16 v[140:143], v[32:35], a[36:39], v[140:143]
    buffer_load_dwordx4 v5, s[60:63], s99 offen offset:2048 lds
    v_mfma_f32_16x16x32_bf16 v[140:143], v[36:39], a[52:55], v[140:143]
    ds_read_b64_tr_b16 v[52:53], v100 offset:49152
    v_mfma_f32_16x16x32_bf16 v[152:155], v[32:35], a[40:43], v[152:155]
    buffer_load_dwordx4 v6, s[60:63], s99 offen offset:3072 lds
    s_waitcnt vmcnt(8)
    v_cmp_gt_u32 vcc, 3, v21
    s_nop 0
    s_cbranch_vccnz L_slowA4
L_okA4:
    v_mfma_f32_16x16x32_bf16 v[152:155], v[36:39], a[56:59], v[152:155]
    ds_read_b64_tr_b16 v[54:55], v100 offset:51200
    s_add_u32 s25, s15, 8192
    v_mfma_f32_16x16x32_bf16 v[156:159], v[32:35], a[44:47], v[156:159]
    buffer_load_dwordx4 a[128:131], v108, s[72:75], s25 offen sc1
    v_mfma_f32_16x16x32_bf16 v[156:159], v[36:39], a[60:63], v[156:159]
    s_waitcnt lgkmcnt(4)
    v_mfma_f32_16x16x32_bf16 v[168:171], v[40:43], a[32:35], v[168:171]
    ds_read_b64_tr_b16 v[32:33], v97 offset:0
    v_mfma_f32_16x16x32_bf16 v[168:171], v[44:47], a[48:51], v[168:171]
    ds_read_b64_tr_b16 v[34:35], v97 offset:2048
    v_mfma_f32_16x16x32_bf16 v[172:175], v[40:43], a[36:39], v[172:175]
    buffer_load_dwordx4 a[132:135], v109, s[72:75], s25 offen sc1
    v_mfma_f32_16x16x32_bf16 v[172:175], v[44:47], a[52:55], v[172:175]
    ds_read_b64_tr_b16 v[36:37], v101 offset:49152
    v_mfma_f32_16x16x32_bf16 v[184:187], v[40:43], a[40:43], v[184:187]
    buffer_load_dwordx4 a[136:139], v110, s[72:75], s25 offen sc1
    v_mfma_f32_16x16x32_bf16 v[184:187], v[44:47], a[56:59], v[184:187]
    ds_read_b64_tr_b16 v[38:39], v101 offset:51200
    v_mfma_f32_16x16x32_bf16 v[188:191], v[40:43], a[44:47], v[188:191]
    buffer_load_dwordx4 a[140:143], v111, s[72:75], s25 offen sc1
    v_mfma_f32_16x16x32_bf16 v[188:191], v[44:47], a[60:63], v[188:191]
    s_waitcnt lgkmcnt(4)
    v_lshlrev_b32 v1, 3, v0
    v_sub_u32 v192, v108, v1
    v_sub_u32 v193, v109, v1
    v_sub_u32 v194, v110, v1
    v_sub_u32 v195, v111, v1
    v_mfma_f32_16x16x32_bf16 v[64:67], v[48:51], a[64:67], v[64:67]
    ds_read_b64_tr_b16 v[40:41], v98 offset:0
    s_add_u32 s25, s15, 12288
    v_mfma_f32_16x16x32_bf16 v[64:67], v[52:55], a[80:83], v[64:67]
    ds_read_b64_tr_b16 v[42:43], v98 offset:2048
    v_mfma_f32_16x16x32_bf16 v[68:71], v[48:51], a[68:71], v[68:71]
    buffer_load_dwordx4 a[144:147], v108, s[72:75], s25 offen sc1
    v_mfma_f32_16x16x32_bf16 v[68:71], v[52:55], a[84:87], v[68:71]
    ds_read_b64_tr_b16 v[44:45], v102 offset:49152
    v_mfma_f32_16x16x32_bf16 v[72:75], v[48:51], a[72:75], v[72:75]
    buffer_load_dwordx4 a[148:151], v109, s[72:75], s25 offen sc1
    v_mfma_f32_16x16x32_bf16 v[72:75], v[52:55], a[88:91], v[72:75]
    ds_read_b64_tr_b16 v[46:47], v102 offset:51200
    v_mfma_f32_16x16x32_bf16 v[76:79], v[48:51], a[76:79], v[76:79]
    buffer_load_dwordx4 a[152:155], v110, s[72:75], s25 offen sc1
    v_mfma_f32_16x16x32_bf16 v[76:79], v[52:55], a[92:95], v[76:79]
    s_waitcnt lgkmcnt(4)
    v_mfma_f32_16x16x32_bf16 v[80:83], v[32:35], a[64:67], v[80:83]
    ds_read_b64_tr_b16 v[48:49], v99 offset:0
    v_mfma_f32_16x16x32_bf16 v[80:83], v[36:39], a[80:83], v[80:83]
    ds_read_b64_tr_b16 v[50:51], v99 offset:2048
    v_mfma_f32_16x16x32_bf16 v[84:87], v[32:35], a[68:71], v[84:87]
    ds_read_b64_tr_b16 v[52:53], v103 offset:49152
    v_mfma_f32_16x16x32_bf16 v[84:87], v[36:39], a[84:87], v[84:87]
    buffer_load_dwordx4 a[156:159], v111, s[72:75], s25 offen sc1
    s_add_u32 m0, s96, 49152
    v_mfma_f32_16x16x32_bf16 v[88:91], v[32:35], a[72:75], v[88:91]
    ds_read_b64_tr_b16 v[54:55], v103 offset:51200
    s_add_u32 s99, s17, 196608
    v_mfma_f32_16x16x32_bf16 v[88:91], v[36:39], a[88:91], v[88:91]
    v_mfma_f32_16x16x32_bf16 v[92:95], v[32:35], a[76:79], v[92:95]
    buffer_load_dwordx4 v5, s[56:59], s99 offen lds
    v_mfma_f32_16x16x32_bf16 v[92:95], v[36:39], a[92:95], v[92:95]
    s_waitcnt lgkmcnt(4)
    v_mfma_f32_16x16x32_bf16 v[136:139], v[40:43], a[64:67], v[136:139]
    ds_read_b64_tr_b16 v[32:33], v100 offset:0
    v_mfma_f32_16x16x32_bf16 v[136:139], v[44:47], a[80:83], v[136:139]
    ds_read_b64_tr_b16 v[34:35], v100 offset:2048
    v_mfma_f32_16x16x32_bf16 v[140:143], v[40:43], a[68:71], v[140:143]
    ds_read_b64_tr_b16 v[36:37], v104 offset:16384
    v_mfma_f32_16x16x32_bf16 v[140:143], v[44:47], a[84:87], v[140:143]
    buffer_load_dwordx4 v6, s[56:59], s99 offen offset:1024 lds
    v_mfma_f32_16x16x32_bf16 v[152:155], v[40:43], a[72:75], v[152:155]
    ds_read_b64_tr_b16 v[38:39], v104 offset:18432
    v_mfma_f32_16x16x32_bf16 v[152:155], v[44:47], a[88:91], v[152:155]
    v_mfma_f32_16x16x32_bf16 v[156:159], v[40:43], a[76:79], v[156:159]
    buffer_load_dwordx4 v5, s[60:63], s99 offen offset:2048 lds
    v_mfma_f32_16x16x32_bf16 v[156:159], v[44:47], a[92:95], v[156:159]
    s_waitcnt lgkmcnt(4)
    v_mfma_f32_16x16x32_bf16 v[168:171], v[48:51], a[64:67], v[168:171]
    ds_read_b64_tr_b16 v[40:41], v101 offset:0
    v_mfma_f32_16x16x32_bf16 v[168:171], v[52:55], a[80:83], v[168:171]
    ds_read_b64_tr_b16 v[42:43], v101 offset:2048
    v_mfma_f32_16x16x32_bf16 v[172:175], v[48:51], a[68:71], v[172:175]
    ds_read_b64_tr_b16 v[44:45], v105 offset:16384
    v_mfma_f32_16x16x32_bf16 v[172:175], v[52:55], a[84:87], v[172:175]
    buffer_load_dwordx4 v6, s[60:63], s99 offen offset:3072 lds
    v_mfma_f32_16x16x32_bf16 v[184:187], v[48:51], a[72:75], v[184:187]
    ds_read_b64_tr_b16 v[46:47], v105 offset:18432
    v_mfma_f32_16x16x32_bf16 v[184:187], v[52:55], a[88:91], v[184:187]
    v_mfma_f32_16x16x32_bf16 v[188:191], v[48:51], a[76:79], v[188:191]
    buffer_load_dword v22, v18, s[72:75], 0 offen sc1
    v_mfma_f32_16x16x32_bf16 v[188:191], v[52:55], a[92:95], v[188:191]
    s_waitcnt lgkmcnt(4)
    v_mfma_f32_16x16x32_bf16 v[64:67], v[32:35], a[96:99], v[64:67]
    ds_read_b64_tr_b16 v[48:49], v102 offset:0
    s_add_u32 s25, s15, 49152
    buffer_load_dwordx4 a[160:163], v108, s[72:75], s25 offen sc1
    v_mfma_f32_16x16x32_bf16 v[64:67], v[36:39], a[112:115], v[64:67]
    ds_read_b64_tr_b16 v[50:51], v102 offset:2048
    buffer_load_dwordx4 a[164:167], v109, s[72:75], s25 offen sc1
    v_mfma_f32_16x16x32_bf16 v[68:71], v[32:35], a[100:103], v[68:71]
    ds_read_b64_tr_b16 v[52:53], v106 offset:16384
    buffer_load_dwordx4 a[168:171], v110, s[72:75], s25 offen sc1
    v_mfma_f32_16x16x32_bf16 v[68:71], v[36:39], a[116:119], v[68:71]
    buffer_load_dwordx4 a[172:175], v111, s[72:75], s25 offen sc1
    s_add_u32 s25, s15, 53248
    v_mfma_f32_16x16x32_bf16 v[72:75], v[32:35], a[104:107], v[72:75]
    buffer_load_dwordx4 a[176:179], v108, s[72:75], s25 offen sc1
    v_mfma_f32_16x16x32_bf16 v[72:75], v[36:39], a[120:123], v[72:75]
    buffer_load_dwordx4 a[180:183], v109, s[72:75], s25 offen sc1
    v_mfma_f32_16x16x32_bf16 v[76:79], v[32:35], a[108:111], v[76:79]
    buffer_load_dwordx4 a[184:187], v110, s[72:75], s25 offen sc1
    v_mfma_f32_16x16x32_bf16 v[76:79], v[36:39], a[124:127], v[76:79]
    ds_read_b64_tr_b16 v[54:55], v106 offset:18432
    s_waitcnt lgkmcnt(4)
    v_mfma_f32_16x16x32_bf16 v[80:83], v[40:43], a[96:99], v[80:83]
    ds_read_b64_tr_b16 v[32:33], v103 offset:0
    buffer_load_dwordx4 a[188:191], v111, s[72:75], s25 offen sc1
    v_mfma_f32_16x16x32_bf16 v[80:83], v[44:47], a[112:115], v[80:83]
    ds_read_b64_tr_b16 v[34:35], v103 offset:2048
    s_add_u32 m0, s96, 32768
    s_add_u32 s99, s17, 229376
    buffer_load_dwordx4 v5, s[56:59], s99 offen lds
    v_mfma_f32_16x16x32_bf16 v[84:87], v[40:43], a[100:103], v[84:87]
    ds_read_b64_tr_b16 v[36:37], v107 offset:16384
    buffer_load_dwordx4 v6, s[56:59], s99 offen offset:1024 lds
    v_mfma_f32_16x16x32_bf16 v[84:87], v[44:47], a[116:119], v[84:87]
    buffer_load_dwordx4 v5, s[60:63], s99 offen offset:2048 lds
    v_mfma_f32_16x16x32_bf16 v[88:91], v[40:43], a[104:107], v[88:91]
    buffer_load_dwordx4 v6, s[60:63], s99 offen offset:3072 lds
    s_add_u32 m0, s96, 0
    v_mfma_f32_16x16x32_bf16 v[88:91], v[44:47], a[120:123], v[88:91]
    s_add_u32 s99, s18, 0
    buffer_load_dwordx4 v14, s[64:67], s99 offen lds
    v_mfma_f32_16x16x32_bf16 v[92:95], v[40:43], a[108:111], v[92:95]
    buffer_load_dwordx4 v15, s[64:67], s99 offen offset:1024 lds
    v_mfma_f32_16x16x32_bf16 v[92:95], v[44:47], a[124:127], v[92:95]
    ds_read_b64_tr_b16 v[38:39], v107 offset:18432
    s_waitcnt lgkmcnt(4)
    v_mfma_f32_16x16x32_bf16 v[136:139], v[48:51], a[96:99], v[136:139]
    ds_read_b64_tr_b16 v[40:41], v100 offset:16384
    buffer_load_dwordx4 v14, s[68:71], s99 offen offset:2048 lds
    v_mfma_f32_16x16x32_bf16 v[136:139], v[52:55], a[112:115], v[136:139]
    ds_read_b64_tr_b16 v[42:43], v100 offset:18432
    buffer_load_dwordx4 v15, s[68:71], s99 offen offset:3072 lds
    v_cmp_gt_u32 vcc, 1, v23
    s_nop 0
    s_cbranch_vccnz L_slowA5
L_okA5:
    v_mfma_f32_16x16x32_bf16 v[140:143], v[48:51], a[100:103], v[140:143]
    ds_read_b64_tr_b16 v[44:45], v96 offset:16384
    v_and_b32 v1, 15, v0
    v_mfma_f32_16x16x32_bf16 v[140:143], v[52:55], a[116:119], v[140:143]
    v_lshlrev_b32 v1, 2, v1
    s_lshl_b32 s100, s7, 6
    v_mfma_f32_16x16x32_bf16 v[152:155], v[48:51], a[104:107], v[152:155]
    v_add_u32 v1, s100, v1
    s_lshl_b32 s100, s94, 8
    v_mfma_f32_16x16x32_bf16 v[152:155], v[52:55], a[120:123], v[152:155]
    s_add_u32 s100, s100, 10485760
    v_xor_b32 v2, 0, v1
    v_mfma_f32_16x16x32_bf16 v[156:159], v[48:51], a[108:111], v[156:159]
    buffer_load_dword v28, v2, s[72:75], s100 offen sc1
    v_mfma_f32_16x16x32_bf16 v[156:159], v[52:55], a[124:127], v[156:159]
    ds_read_b64_tr_b16 v[46:47], v96 offset:18432
    s_waitcnt lgkmcnt(4)
    v_mfma_f32_16x16x32_bf16 v[168:171], v[32:35], a[96:99], v[168:171]
    ds_read_b64_tr_b16 v[48:49], v101 offset:16384
    v_mfma_f32_16x16x32_bf16 v[168:171], v[36:39], a[112:115], v[168:171]
    ds_read_b64_tr_b16 v[50:51], v101 offset:18432
    v_xor_b32 v2, 64, v1
    v_mfma_f32_16x16x32_bf16 v[172:175], v[32:35], a[100:103], v[172:175]
    ds_read_b64_tr_b16 v[52:53], v97 offset:16384
    buffer_load_dword v29, v2, s[72:75], s100 offen sc1
    v_mfma_f32_16x16x32_bf16 v[172:175], v[36:39], a[116:119], v[172:175]
    v_xor_b32 v2, 128, v1
    v_mfma_f32_16x16x32_bf16 v[184:187], v[32:35], a[104:107], v[184:187]
    buffer_load_dword v30, v2, s[72:75], s100 offen sc1
    v_mfma_f32_16x16x32_bf16 v[184:187], v[36:39], a[120:123], v[184:187]
    v_xor_b32 v2, 192, v1
    v_mfma_f32_16x16x32_bf16 v[188:191], v[32:35], a[108:111], v[188:191]
    buffer_load_dword v31, v2, s[72:75], s100 offen sc1
    v_mfma_f32_16x16x32_bf16 v[188:191], v[36:39], a[124:127], v[188:191]
    ds_read_b64_tr_b16 v[54:55], v97 offset:18432
    s_waitcnt lgkmcnt(4)
    s_waitcnt vmcnt(20)
    v_cmp_gt_u32 vcc, 3, v22
    s_nop 0
    s_cbranch_vccnz L_slowA6
L_okA6:
    v_mfma_f32_16x16x32_bf16 v[64:67], v[40:43], a[128:131], v[64:67]
    ds_read_b64_tr_b16 v[32:33], v102 offset:16384
    s_add_u32 s25, s15, 24576
    v_mfma_f32_16x16x32_bf16 v[64:67], v[44:47], a[144:147], v[64:67]
    ds_read_b64_tr_b16 v[34:35], v102 offset:18432
    buffer_load_dwordx2 a[192:193], v192, s[72:75], s25 offen sc1
    v_mfma_f32_16x16x32_bf16 v[68:71], v[40:43], a[132:135], v[68:71]
    buffer_load_dwordx2 a[194:195], v192, s[72:75], s25 offen offset:512 sc1
    v_mfma_f32_16x16x32_bf16 v[68:71], v[44:47], a[148:151], v[68:71]
    ds_read_b64_tr_b16 v[36:37], v98 offset:16384
    v_mfma_f32_16x16x32_bf16 v[72:75], v[40:43], a[136:139], v[72:75]
    buffer_load_dwordx2 a[196:197], v193, s[72:75], s25 offen sc1
    v_mfma_f32_16x16x32_bf16 v[72:75], v[44:47], a[152:155], v[72:75]
    buffer_load_dwordx2 a[198:199], v193, s[72:75], s25 offen offset:512 sc1
    v_mfma_f32_16x16x32_bf16 v[76:79], v[40:43], a[140:143], v[76:79]
    buffer_load_dwordx2 a[200:201], v194, s[72:75], s25 offen sc1
    v_mfma_f32_16x16x32_bf16 v[76:79], v[44:47], a[156:159], v[76:79]
    ds_read_b64_tr_b16 v[38:39], v98 offset:18432
    s_waitcnt lgkmcnt(4)
    v_mfma_f32_16x16x32_bf16 v[80:83], v[48:51], a[128:131], v[80:83]
    ds_read_b64_tr_b16 v[40:41], v103 offset:16384
    v_mfma_f32_16x16x32_bf16 v[80:83], v[52:55], a[144:147], v[80:83]
    ds_read_b64_tr_b16 v[42:43], v103 offset:18432
    buffer_load_dwordx2 a[202:203], v194, s[72:75], s25 offen offset:512 sc1
    v_mfma_f32_16x16x32_bf16 v[84:87], v[48:51], a[132:135], v[84:87]
    buffer_load_dwordx2 a[204:205], v195, s[72:75], s25 offen sc1
    v_mfma_f32_16x16x32_bf16 v[84:87], v[52:55], a[148:151], v[84:87]
    ds_read_b64_tr_b16 v[44:45], v99 offset:16384
    v_mfma_f32_16x16x32_bf16 v[88:91], v[48:51], a[136:139], v[88:91]
    buffer_load_dwordx2 a[206:207], v195, s[72:75], s25 offen offset:512 sc1
    s_add_u32 s25, s15, 28672
    v_mfma_f32_16x16x32_bf16 v[88:91], v[52:55], a[152:155], v[88:91]
    buffer_load_dwordx2 a[208:209], v192, s[72:75], s25 offen sc1
    v_mfma_f32_16x16x32_bf16 v[92:95], v[48:51], a[140:143], v[92:95]
    buffer_load_dwordx2 a[210:211], v192, s[72:75], s25 offen offset:512 sc1
    v_mfma_f32_16x16x32_bf16 v[92:95], v[52:55], a[156:159], v[92:95]
    ds_read_b64_tr_b16 v[46:47], v99 offset:18432
    s_waitcnt lgkmcnt(4)
    v_mfma_f32_16x16x32_bf16 v[136:139], v[32:35], a[128:131], v[136:139]
    ds_read_b64_tr_b16 v[48:49], v104 offset:0
    v_mfma_f32_16x16x32_bf16 v[136:139], v[36:39], a[144:147], v[136:139]
    ds_read_b64_tr_b16 v[50:51], v104 offset:2048
    buffer_load_dwordx2 a[212:213], v193, s[72:75], s25 offen sc1
    v_mfma_f32_16x16x32_bf16 v[140:143], v[32:35], a[132:135], v[140:143]
    buffer_load_dwordx2 a[214:215], v193, s[72:75], s25 offen offset:512 sc1
    v_mfma_f32_16x16x32_bf16 v[140:143], v[36:39], a[148:151], v[140:143]
    ds_read_b64_tr_b16 v[52:53], v100 offset:32768
    v_mfma_f32_16x16x32_bf16 v[152:155], v[32:35], a[136:139], v[152:155]
    buffer_load_dwordx2 a[216:217], v194, s[72:75], s25 offen sc1
    v_mfma_f32_16x16x32_bf16 v[152:155], v[36:39], a[152:155], v[152:155]
    buffer_load_dwordx2 a[218:219], v194, s[72:75], s25 offen offset:512 sc1
    v_mfma_f32_16x16x32_bf16 v[156:159], v[32:35], a[140:143], v[156:159]
    buffer_load_dwordx2 a[220:221], v195, s[72:75], s25 offen sc1
    v_mfma_f32_16x16x32_bf16 v[156:159], v[36:39], a[156:159], v[156:159]
    ds_read_b64_tr_b16 v[54:55], v100 offset:34816
    s_waitcnt lgkmcnt(4)
    v_mfma_f32_16x16x32_bf16 v[168:171], v[40:43], a[128:131], v[168:171]
    ds_read_b64_tr_b16 v[32:33], v105 offset:0
    v_mfma_f32_16x16x32_bf16 v[168:171], v[44:47], a[144:147], v[168:171]
    ds_read_b64_tr_b16 v[34:35], v105 offset:2048
    buffer_load_dwordx2 a[222:223], v195, s[72:75], s25 offen offset:512 sc1
    v_mfma_f32_16x16x32_bf16 v[172:175], v[40:43], a[132:135], v[172:175]
    s_add_u32 m0, s96, 114688
    s_add_u32 s99, s18, 32768
    buffer_load_dwordx4 v14, s[64:67], s99 offen lds
    v_mfma_f32_16x16x32_bf16 v[172:175], v[44:47], a[148:151], v[172:175]
    ds_read_b64_tr_b16 v[36:37], v101 offset:32768
    v_mfma_f32_16x16x32_bf16 v[184:187], v[40:43], a[136:139], v[184:187]
    buffer_load_dwordx4 v15, s[64:67], s99 offen offset:1024 lds
    v_mfma_f32_16x16x32_bf16 v[184:187], v[44:47], a[152:155], v[184:187]
    buffer_load_dwordx4 v14, s[68:71], s99 offen offset:2048 lds
    v_mfma_f32_16x16x32_bf16 v[188:191], v[40:43], a[140:143], v[188:191]
    buffer_load_dwordx4 v15, s[68:71], s99 offen offset:3072 lds
    v_mfma_f32_16x16x32_bf16 v[188:191], v[44:47], a[156:159], v[188:191]
    ds_read_b64_tr_b16 v[38:39], v101 offset:34816
    s_waitcnt lgkmcnt(4)
    s_waitcnt vmcnt(39)
    v_mfma_f32_16x16x32_bf16 v[64:67], v[48:51], a[160:163], v[64:67]
    ds_read_b64_tr_b16 v[40:41], v106 offset:0
    s_add_u32 s25, s16, 0
    s_waitcnt vmcnt(35)
    v_mfma_f32_16x16x32_bf16 v[64:67], v[52:55], a[176:179], v[64:67]
    ds_read_b64_tr_b16 v[42:43], v106 offset:2048
    v_mfma_f32_16x16x32_bf16 v[68:71], v[48:51], a[164:167], v[68:71]
    buffer_load_dwordx4 a[224:227], v108, s[72:75], s25 offen sc1
    s_waitcnt vmcnt(35)
    v_mfma_f32_16x16x32_bf16 v[68:71], v[52:55], a[180:183], v[68:71]
    ds_read_b64_tr_b16 v[44:45], v102 offset:32768
    v_mfma_f32_16x16x32_bf16 v[72:75], v[48:51], a[168:171], v[72:75]
    buffer_load_dwordx4 a[228:231], v109, s[72:75], s25 offen sc1
    s_waitcnt vmcnt(35)
    v_mfma_f32_16x16x32_bf16 v[72:75], v[52:55], a[184:187], v[72:75]
    ds_read_b64_tr_b16 v[46:47], v102 offset:34816
    v_mfma_f32_16x16x32_bf16 v[76:79], v[48:51], a[172:175], v[76:79]
    buffer_load_dwordx4 a[232:235], v110, s[72:75], s25 offen sc1
    s_waitcnt vmcnt(35)
    v_mfma_f32_16x16x32_bf16 v[76:79], v[52:55], a[188:191], v[76:79]
    s_waitcnt lgkmcnt(4)
    v_mfma_f32_16x16x32_bf16 v[80:83], v[32:35], a[160:163], v[80:83]
    ds_read_b64_tr_b16 v[48:49], v107 offset:0
    v_mfma_f32_16x16x32_bf16 v[80:83], v[36:39], a[176:179], v[80:83]
    ds_read_b64_tr_b16 v[50:51], v107 offset:2048
    v_mfma_f32_16x16x32_bf16 v[84:87], v[32:35], a[164:167], v[84:87]
    buffer_load_dwordx4 a[236:239], v111, s[72:75], s25 offen sc1
    s_add_u32 s25, s16, 4096
    v_mfma_f32_16x16x32_bf16 v[84:87], v[36:39], a[180:183], v[84:87]
    ds_read_b64_tr_b16 v[52:53], v103 offset:32768
    v_mfma_f32_16x16x32_bf16 v[88:91], v[32:35], a[168:171], v[88:91]
    buffer_load_dwordx4 a[240:243], v108, s[72:75], s25 offen sc1
    v_mfma_f32_16x16x32_bf16 v[88:91], v[36:39], a[184:187], v[88:91]
    ds_read_b64_tr_b16 v[54:55], v103 offset:34816
    v_mfma_f32_16x16x32_bf16 v[92:95], v[32:35], a[172:175], v[92:95]
    buffer_load_dwordx4 a[244:247], v109, s[72:75], s25 offen sc1
    v_mfma_f32_16x16x32_bf16 v[92:95], v[36:39], a[188:191], v[92:95]
    s_waitcnt lgkmcnt(4)
    v_mfma_f32_16x16x32_bf16 v[136:139], v[40:43], a[160:163], v[136:139]
    ds_read_b64_tr_b16 v[32:33], v96 offset:49152
    v_mfma_f32_16x16x32_bf16 v[136:139], v[44:47], a[176:179], v[136:139]
    ds_read_b64_tr_b16 v[34:35], v96 offset:51200
    v_mfma_f32_16x16x32_bf16 v[140:143], v[40:43], a[164:167], v[140:143]
    buffer_load_dwordx4 a[248:251], v110, s[72:75], s25 offen sc1
    v_mfma_f32_16x16x32_bf16 v[140:143], v[44:47], a[180:183], v[140:143]
    s_waitcnt vmcnt(35)
    ds_read_b64_tr_b16 v[36:37], v96 offset:32768
    v_mfma_f32_16x16x32_bf16 v[152:155], v[40:43], a[168:171], v[152:155]
    buffer_load_dwordx4 a[252:255], v111, s[72:75], s25 offen sc1
    s_add_u32 m0, s96, 65536
    v_mfma_f32_16x16x32_bf16 v[152:155], v[44:47], a[184:187], v[152:155]
    ds_read_b64_tr_b16 v[38:39], v96 offset:34816
    s_add_u32 s99, s18, 65536
    v_mfma_f32_16x16x32_bf16 v[156:159], v[40:43], a[172:175], v[156:159]
    buffer_load_dwordx4 v14, s[64:67], s99 offen lds
    v_mfma_f32_16x16x32_bf16 v[156:159], v[44:47], a[188:191], v[156:159]
    s_waitcnt lgkmcnt(4)
    v_mfma_f32_16x16x32_bf16 v[168:171], v[48:51], a[160:163], v[168:171]
    ds_read_b64_tr_b16 v[40:41], v97 offset:49152
    v_mfma_f32_16x16x32_bf16 v[168:171], v[52:55], a[176:179], v[168:171]
    ds_read_b64_tr_b16 v[42:43], v97 offset:51200
    v_mfma_f32_16x16x32_bf16 v[172:175], v[48:51], a[164:167], v[172:175]
    buffer_load_dwordx4 v15, s[64:67], s99 offen offset:1024 lds
    v_mfma_f32_16x16x32_bf16 v[172:175], v[52:55], a[180:183], v[172:175]
    ds_read_b64_tr_b16 v[44:45], v97 offset:32768
    v_mfma_f32_16x16x32_bf16 v[184:187], v[48:51], a[168:171], v[184:187]
    buffer_load_dwordx4 v14, s[68:71], s99 offen offset:2048 lds
    v_mfma_f32_16x16x32_bf16 v[184:187], v[52:55], a[184:187], v[184:187]
    ds_read_b64_tr_b16 v[46:47], v97 offset:34816
    v_mfma_f32_16x16x32_bf16 v[188:191], v[48:51], a[172:175], v[188:191]
    buffer_load_dwordx4 v15, s[68:71], s99 offen offset:3072 lds
    v_mfma_f32_16x16x32_bf16 v[188:191], v[52:55], a[188:191], v[188:191]
    s_waitcnt lgkmcnt(4)
    s_waitcnt vmcnt(35)
    v_sub_f32 v28, 1.0, v28
    s_waitcnt vmcnt(34)
    v_sub_f32 v29, 1.0, v29
    s_waitcnt vmcnt(33)
    v_sub_f32 v30, 1.0, v30
    s_waitcnt vmcnt(32)
    v_sub_f32 v31, 1.0, v31
    s_waitcnt vmcnt(30)
    v_mfma_f32_16x16x32_bf16 v[64:67], v[32:35], a[192:195], v[64:67]
    ds_read_b64_tr_b16 v[48:49], v98 offset:49152
    s_add_u32 m0, s96, 147456
    s_waitcnt vmcnt(22)
    v_mfma_f32_16x16x32_bf16 v[64:67], v[36:39], a[208:211], v[64:67]
    ds_read_b64_tr_b16 v[50:51], v98 offset:51200
    s_add_u32 s99, s18, 98304
    v_mfma_f32_16x16x32_bf16 v[68:71], v[32:35], a[196:199], v[68:71]
    buffer_load_dwordx4 v14, s[64:67], s99 offen lds
    s_waitcnt vmcnt(21)
    v_mfma_f32_16x16x32_bf16 v[68:71], v[36:39], a[212:215], v[68:71]
    ds_read_b64_tr_b16 v[52:53], v98 offset:32768
    v_mfma_f32_16x16x32_bf16 v[72:75], v[32:35], a[200:203], v[72:75]
    buffer_load_dwordx4 v15, s[64:67], s99 offen offset:1024 lds
    s_waitcnt vmcnt(20)
    v_mfma_f32_16x16x32_bf16 v[72:75], v[36:39], a[216:219], v[72:75]
    ds_read_b64_tr_b16 v[54:55], v98 offset:34816
    v_mfma_f32_16x16x32_bf16 v[76:79], v[32:35], a[204:207], v[76:79]
    buffer_load_dwordx4 v14, s[68:71], s99 offen offset:2048 lds
    s_waitcnt vmcnt(19)
    v_mfma_f32_16x16x32_bf16 v[76:79], v[36:39], a[220:223], v[76:79]
    s_waitcnt lgkmcnt(4)
    v_mfma_f32_16x16x32_bf16 v[80:83], v[40:43], a[192:195], v[80:83]
    ds_read_b64_tr_b16 v[32:33], v99 offset:49152
    v_mul_f32 v64, v28, v64
    v_mfma_f32_16x16x32_bf16 v[80:83], v[44:47], a[208:211], v[80:83]
    ds_read_b64_tr_b16 v[34:35], v99 offset:51200
    v_mul_f32 v65, v28, v65
    v_mfma_f32_16x16x32_bf16 v[84:87], v[40:43], a[196:199], v[84:87]
    buffer_load_dwordx4 v15, s[68:71], s99 offen offset:3072 lds
    s_add_u32 s25, s16, 8192
    v_mfma_f32_16x16x32_bf16 v[84:87], v[44:47], a[212:215], v[84:87]
    ds_read_b64_tr_b16 v[36:37], v99 offset:32768
    v_mul_f32 v66, v28, v66
    v_mfma_f32_16x16x32_bf16 v[88:91], v[40:43], a[200:203], v[88:91]
    buffer_load_dwordx4 a[0:3], v108, s[72:75], s25 offen sc1
    v_mul_f32 v67, v28, v67
    v_mfma_f32_16x16x32_bf16 v[88:91], v[44:47], a[216:219], v[88:91]
    ds_read_b64_tr_b16 v[38:39], v99 offset:34816
    v_mul_f32 v68, v29, v68
    v_mfma_f32_16x16x32_bf16 v[92:95], v[40:43], a[204:207], v[92:95]
    buffer_load_dwordx4 a[4:7], v109, s[72:75], s25 offen sc1
    v_mul_f32 v69, v29, v69
    v_mfma_f32_16x16x32_bf16 v[92:95], v[44:47], a[220:223], v[92:95]
    s_waitcnt lgkmcnt(4)
    v_mul_f32 v70, v29, v70
    v_mul_f32 v71, v29, v71
    v_mfma_f32_16x16x32_bf16 v[136:139], v[48:51], a[192:195], v[136:139]
    ds_read_b64_tr_b16 v[40:41], v96 offset:0
    v_mul_f32 v80, v28, v80
    v_mfma_f32_16x16x32_bf16 v[136:139], v[52:55], a[208:211], v[136:139]
    ds_read_b64_tr_b16 v[42:43], v96 offset:2048
    v_mul_f32 v81, v28, v81
    v_mfma_f32_16x16x32_bf16 v[140:143], v[48:51], a[196:199], v[140:143]
    buffer_load_dwordx4 a[8:11], v110, s[72:75], s25 offen sc1
    v_mul_f32 v82, v28, v82
    v_mfma_f32_16x16x32_bf16 v[140:143], v[52:55], a[212:215], v[140:143]
    s_waitcnt vmcnt(19)
    ds_read_b64_tr_b16 v[44:45], v100 offset:49152
    v_mul_f32 v83, v28, v83
    v_mfma_f32_16x16x32_bf16 v[152:155], v[48:51], a[200:203], v[152:155]
    buffer_load_dwordx4 a[12:15], v111, s[72:75], s25 offen sc1
    s_add_u32 s25, s16, 12288
    v_mfma_f32_16x16x32_bf16 v[152:155], v[52:55], a[216:219], v[152:155]
    ds_read_b64_tr_b16 v[46:47], v100 offset:51200
    v_mul_f32 v84, v29, v84
    v_mfma_f32_16x16x32_bf16 v[156:159], v[48:51], a[204:207], v[156:159]
    buffer_load_dwordx4 a[16:19], v108, s[72:75], s25 offen sc1
    v_mul_f32 v85, v29, v85
    v_mfma_f32_16x16x32_bf16 v[156:159], v[52:55], a[220:223], v[156:159]
    s_waitcnt lgkmcnt(4)
    v_mul_f32 v86, v29, v86
    v_mul_f32 v87, v29, v87
    v_mfma_f32_16x16x32_bf16 v[168:171], v[32:35], a[192:195], v[168:171]
    ds_read_b64_tr_b16 v[48:49], v97 offset:0
    v_mul_f32 v136, v28, v136
    v_mfma_f32_16x16x32_bf16 v[168:171], v[36:39], a[208:211], v[168:171]
    ds_read_b64_tr_b16 v[50:51], v97 offset:2048
    v_mul_f32 v137, v28, v137
    v_mfma_f32_16x16x32_bf16 v[172:175], v[32:35], a[196:199], v[172:175]
    buffer_load_dwordx4 a[20:23], v109, s[72:75], s25 offen sc1
    v_mul_f32 v138, v28, v138
    v_mfma_f32_16x16x32_bf16 v[172:175], v[36:39], a[212:215], v[172:175]
    ds_read_b64_tr_b16 v[52:53], v101 offset:49152
    v_mul_f32 v139, v28, v139
    v_mfma_f32_16x16x32_bf16 v[184:187], v[32:35], a[200:203], v[184:187]
    buffer_load_dwordx4 a[24:27], v110, s[72:75], s25 offen sc1
    v_mul_f32 v140, v29, v140
    v_mfma_f32_16x16x32_bf16 v[184:187], v[36:39], a[216:219], v[184:187]
    ds_read_b64_tr_b16 v[54:55], v101 offset:51200
    v_mul_f32 v141, v29, v141
    v_mfma_f32_16x16x32_bf16 v[188:191], v[32:35], a[204:207], v[188:191]
    buffer_load_dwordx4 a[28:31], v111, s[72:75], s25 offen sc1
    v_mul_f32 v142, v29, v142
    v_mfma_f32_16x16x32_bf16 v[188:191], v[36:39], a[220:223], v[188:191]
    s_waitcnt lgkmcnt(4)
    v_mul_f32 v143, v29, v143
    v_mul_f32 v152, v30, v152
    s_waitcnt vmcnt(16)
    v_accvgpr_read_b32 v3, a224
    v_accvgpr_read_b32 v4, a228
    v_max_u32 v7, v3, v4
    v_accvgpr_read_b32 v3, a232
    v_accvgpr_read_b32 v4, a236
    v_max3_u32 v7, v7, v3, v4
    v_accvgpr_read_b32 v3, a240
    v_accvgpr_read_b32 v4, a244
    v_max3_u32 v7, v7, v3, v4
    v_accvgpr_read_b32 v3, a248
    v_accvgpr_read_b32 v4, a252
    v_max3_u32 v7, v7, v3, v4
    v_cmp_eq_u32 vcc, -1, v7
    s_nop 0
    s_cbranch_vccnz L_slowfcA7
L_okfcA7:
    v_mul_f32 v72, v30, v72
    v_mul_f32 v73, v30, v73
    v_mul_f32 v74, v30, v74
    v_mul_f32 v75, v30, v75
    v_mul_f32 v76, v31, v76
    v_mul_f32 v77, v31, v77
    v_mul_f32 v78, v31, v78
    v_mul_f32 v79, v31, v79
    v_mfma_f32_16x16x32_bf16 v[64:67], v[40:43], a[224:227], v[64:67]
    ds_read_b64_tr_b16 v[32:33], v98 offset:0
    v_mul_f32 v168, v28, v168
    v_mfma_f32_16x16x32_bf16 v[64:67], v[44:47], a[240:243], v[64:67]
    ds_read_b64_tr_b16 v[34:35], v98 offset:2048
    v_mul_f32 v169, v28, v169
    v_mfma_f32_16x16x32_bf16 v[68:71], v[40:43], a[228:231], v[68:71]
    ds_read_b64_tr_b16 v[36:37], v102 offset:49152
    v_mul_f32 v170, v28, v170
    v_mfma_f32_16x16x32_bf16 v[68:71], v[44:47], a[244:247], v[68:71]
    ds_read_b64_tr_b16 v[38:39], v102 offset:51200
    v_mul_f32 v171, v28, v171
    v_mfma_f32_16x16x32_bf16 v[72:75], v[40:43], a[232:235], v[72:75]
    v_mul_f32 v172, v29, v172
    v_mul_f32 v173, v29, v173
    v_mfma_f32_16x16x32_bf16 v[72:75], v[44:47], a[248:251], v[72:75]
    v_mul_f32 v174, v29, v174
    v_mul_f32 v175, v29, v175
    v_mfma_f32_16x16x32_bf16 v[76:79], v[40:43], a[236:239], v[76:79]
    v_mul_f32 v184, v30, v184
    v_mul_f32 v185, v30, v185
    v_mfma_f32_16x16x32_bf16 v[76:79], v[44:47], a[252:255], v[76:79]
    s_waitcnt lgkmcnt(4)
    v_mul_f32 v186, v30, v186
    v_mul_f32 v187, v30, v187
    v_mul_f32 v88, v30, v88
    v_mul_f32 v89, v30, v89
    v_mul_f32 v90, v30, v90
    v_mul_f32 v91, v30, v91
    v_mul_f32 v92, v31, v92
    v_mul_f32 v93, v31, v93
    v_mul_f32 v94, v31, v94
    v_mul_f32 v95, v31, v95
    v_mfma_f32_16x16x32_bf16 v[80:83], v[48:51], a[224:227], v[80:83]
    ds_read_b64_tr_b16 v[40:41], v99 offset:0
    v_mul_f32 v188, v31, v188
    v_mfma_f32_16x16x32_bf16 v[80:83], v[52:55], a[240:243], v[80:83]
    ds_read_b64_tr_b16 v[42:43], v99 offset:2048
    v_mul_f32 v189, v31, v189
    v_mfma_f32_16x16x32_bf16 v[84:87], v[48:51], a[228:231], v[84:87]
    ds_read_b64_tr_b16 v[44:45], v103 offset:49152
    v_mul_f32 v190, v31, v190
    v_mfma_f32_16x16x32_bf16 v[84:87], v[52:55], a[244:247], v[84:87]
    ds_read_b64_tr_b16 v[46:47], v103 offset:51200
    v_mul_f32 v191, v31, v191
    v_mfma_f32_16x16x32_bf16 v[88:91], v[48:51], a[232:235], v[88:91]
    s_lshl_b32 s100, s7, 14
    v_mul_f32 v153, v30, v153
    v_mul_f32 v154, v30, v154
    v_mfma_f32_16x16x32_bf16 v[88:91], v[52:55], a[248:251], v[88:91]
    v_mul_f32 v155, v30, v155
    v_mul_f32 v156, v31, v156
    v_mfma_f32_16x16x32_bf16 v[92:95], v[48:51], a[236:239], v[92:95]
    v_mul_f32 v157, v31, v157
    v_mul_f32 v158, v31, v158
    v_mfma_f32_16x16x32_bf16 v[92:95], v[52:55], a[252:255], v[92:95]
    s_waitcnt lgkmcnt(4)
    v_mul_f32 v159, v31, v159
    v_add_u32 v224, s96, v11
    v_mfma_f32_16x16x32_bf16 v[136:139], v[32:35], a[224:227], v[136:139]
    s_waitcnt vmcnt(12)
    ds_read_b64_tr_b16 v[48:49], v100 offset:0
    v_xor_b32 v225, 4096, v224
    v_mfma_f32_16x16x32_bf16 v[136:139], v[36:39], a[240:243], v[136:139]
    ds_read_b64_tr_b16 v[50:51], v100 offset:2048
    v_xor_b32 v226, 8192, v224
    v_mfma_f32_16x16x32_bf16 v[140:143], v[32:35], a[228:231], v[140:143]
    s_waitcnt vmcnt(8)
    ds_read_b64_tr_b16 v[52:53], v104 offset:16384
    v_xor_b32 v227, 12288, v224
    v_mfma_f32_16x16x32_bf16 v[140:143], v[36:39], a[244:247], v[140:143]
    ds_read_b64_tr_b16 v[54:55], v104 offset:18432
    v_and_b32 v228, 15, v0
    v_mfma_f32_16x16x32_bf16 v[152:155], v[32:35], a[232:235], v[152:155]
    v_lshlrev_b32 v228, 10, v228
    v_bfe_u32 v229, v0, 4, 1
    v_mfma_f32_16x16x32_bf16 v[152:155], v[36:39], a[248:251], v[152:155]
    v_lshl_add_u32 v228, v229, 5, v228
    v_lshrrev_b32 v229, 5, v0
    v_mfma_f32_16x16x32_bf16 v[156:159], v[32:35], a[236:239], v[156:159]
    v_lshl_add_u32 v228, v229, 4, v228
    v_mfma_f32_16x16x32_bf16 v[156:159], v[36:39], a[252:255], v[156:159]
    s_waitcnt lgkmcnt(4)
    v_mfma_f32_16x16x32_bf16 v[168:171], v[40:43], a[224:227], v[168:171]
    ds_read_b64_tr_b16 v[32:33], v101 offset:0
    v_mfma_f32_16x16x32_bf16 v[168:171], v[44:47], a[240:243], v[168:171]
    ds_read_b64_tr_b16 v[34:35], v101 offset:2048
    v_mfma_f32_16x16x32_bf16 v[172:175], v[40:43], a[228:231], v[172:175]
    ds_read_b64_tr_b16 v[36:37], v105 offset:16384
    v_mfma_f32_16x16x32_bf16 v[172:175], v[44:47], a[244:247], v[172:175]
    ds_read_b64_tr_b16 v[38:39], v105 offset:18432
    v_mfma_f32_16x16x32_bf16 v[184:187], v[40:43], a[232:235], v[184:187]
    v_mfma_f32_16x16x32_bf16 v[184:187], v[44:47], a[248:251], v[184:187]
    v_mfma_f32_16x16x32_bf16 v[188:191], v[40:43], a[236:239], v[188:191]
    v_mfma_f32_16x16x32_bf16 v[188:191], v[44:47], a[252:255], v[188:191]
    s_waitcnt lgkmcnt(4)
    s_waitcnt vmcnt(0)
    v_accvgpr_read_b32 v3, a0
    v_accvgpr_read_b32 v4, a4
    v_max_u32 v7, v3, v4
    v_accvgpr_read_b32 v3, a8
    v_accvgpr_read_b32 v4, a12
    v_max3_u32 v7, v7, v3, v4
    v_accvgpr_read_b32 v3, a16
    v_accvgpr_read_b32 v4, a20
    v_max3_u32 v7, v7, v3, v4
    v_accvgpr_read_b32 v3, a24
    v_accvgpr_read_b32 v4, a28
    v_max3_u32 v7, v7, v3, v4
    v_cmp_eq_u32 vcc, -1, v7
    s_nop 0
    s_cbranch_vccnz L_slowfcA8
L_okfcA8:
    v_mfma_f32_16x16x32_bf16 v[64:67], v[48:51], a[0:3], v[64:67]
    ds_read_b64_tr_b16 v[40:41], v102 offset:0
    v_mfma_f32_16x16x32_bf16 v[64:67], v[52:55], a[16:19], v[64:67]
    ds_read_b64_tr_b16 v[42:43], v102 offset:2048
    v_mfma_f32_16x16x32_bf16 v[68:71], v[48:51], a[4:7], v[68:71]
    ds_read_b64_tr_b16 v[44:45], v106 offset:16384
    v_mfma_f32_16x16x32_bf16 v[68:71], v[52:55], a[20:23], v[68:71]
    ds_read_b64_tr_b16 v[46:47], v106 offset:18432
    v_mfma_f32_16x16x32_bf16 v[72:75], v[48:51], a[8:11], v[72:75]
    v_mfma_f32_16x16x32_bf16 v[72:75], v[52:55], a[24:27], v[72:75]
    v_mfma_f32_16x16x32_bf16 v[76:79], v[48:51], a[12:15], v[76:79]
    v_mfma_f32_16x16x32_bf16 v[76:79], v[52:55], a[28:31], v[76:79]
    s_waitcnt lgkmcnt(4)
    v_mfma_f32_16x16x32_bf16 v[80:83], v[32:35], a[0:3], v[80:83]
    ds_read_b64_tr_b16 v[48:49], v103 offset:0
    v_mfma_f32_16x16x32_bf16 v[80:83], v[36:39], a[16:19], v[80:83]
    ds_read_b64_tr_b16 v[50:51], v103 offset:2048
    v_mfma_f32_16x16x32_bf16 v[84:87], v[32:35], a[4:7], v[84:87]
    ds_read_b64_tr_b16 v[52:53], v107 offset:16384
    v_mfma_f32_16x16x32_bf16 v[84:87], v[36:39], a[20:23], v[84:87]
    ds_read_b64_tr_b16 v[54:55], v107 offset:18432
    v_mfma_f32_16x16x32_bf16 v[88:91], v[32:35], a[8:11], v[88:91]
    ds_write_b128 v224, v[68:71] offset:0
    v_mfma_f32_16x16x32_bf16 v[88:91], v[36:39], a[24:27], v[88:91]
    ds_write_b128 v224, v[72:75] offset:16384
    v_mfma_f32_16x16x32_bf16 v[92:95], v[32:35], a[12:15], v[92:95]
    ds_write_b128 v224, v[76:79] offset:32768
    v_mfma_f32_16x16x32_bf16 v[92:95], v[36:39], a[28:31], v[92:95]
    s_waitcnt lgkmcnt(7)
    v_mfma_f32_16x16x32_bf16 v[136:139], v[40:43], a[0:3], v[136:139]
    ds_write_b128 v224, v[84:87] offset:1024
    v_mfma_f32_16x16x32_bf16 v[136:139], v[44:47], a[16:19], v[136:139]
    v_mfma_f32_16x16x32_bf16 v[140:143], v[40:43], a[4:7], v[140:143]
    ds_write_b128 v224, v[88:91] offset:17408
    v_mfma_f32_16x16x32_bf16 v[140:143], v[44:47], a[20:23], v[140:143]
    v_mfma_f32_16x16x32_bf16 v[152:155], v[40:43], a[8:11], v[152:155]
    v_mfma_f32_16x16x32_bf16 v[152:155], v[44:47], a[24:27], v[152:155]
    ds_write_b128 v224, v[92:95] offset:33792
    v_mfma_f32_16x16x32_bf16 v[156:159], v[40:43], a[12:15], v[156:159]
    v_mfma_f32_16x16x32_bf16 v[156:159], v[44:47], a[28:31], v[156:159]
    s_waitcnt lgkmcnt(6)
    v_mfma_f32_16x16x32_bf16 v[168:171], v[48:51], a[0:3], v[168:171]
    v_mfma_f32_16x16x32_bf16 v[168:171], v[52:55], a[16:19], v[168:171]
    v_mfma_f32_16x16x32_bf16 v[172:175], v[48:51], a[4:7], v[172:175]
    ds_write_b128 v224, v[140:143] offset:2048
    v_mfma_f32_16x16x32_bf16 v[172:175], v[52:55], a[20:23], v[172:175]
    ds_write_b128 v224, v[152:155] offset:18432
    v_mfma_f32_16x16x32_bf16 v[184:187], v[48:51], a[8:11], v[184:187]
    v_mfma_f32_16x16x32_bf16 v[184:187], v[52:55], a[24:27], v[184:187]
    ds_write_b128 v224, v[156:159] offset:34816
    v_mfma_f32_16x16x32_bf16 v[188:191], v[48:51], a[12:15], v[188:191]
    v_mfma_f32_16x16x32_bf16 v[188:191], v[52:55], a[28:31], v[188:191]
    s_nop 1
    ds_write_b128 v224, v[172:175] offset:3072
    s_nop 1
    ds_write_b128 v224, v[184:187] offset:19456
    s_nop 1
    ds_write_b128 v224, v[188:191] offset:35840
    s_waitcnt lgkmcnt(0)
    s_barrier
    ds_read_b128 v[128:131], v225 offset:0
    ds_read_b128 v[132:135], v226 offset:16384
    ds_read_b128 v[144:147], v227 offset:32768
    ds_read_b128 v[148:151], v225 offset:1024
    ds_read_b128 v[160:163], v226 offset:17408
    ds_read_b128 v[164:167], v227 offset:33792
    ds_read_b128 v[176:179], v225 offset:2048
    ds_read_b128 v[180:183], v226 offset:18432
    ds_read_b128 v[112:115], v227 offset:34816
    ds_read_b128 v[116:119], v225 offset:3072
    ds_read_b128 v[120:123], v226 offset:19456
    ds_read_b128 v[124:127], v227 offset:35840
    s_waitcnt lgkmcnt(11)
    v_pk_add_f32 v[64:65], v[64:65], v[128:129]
    v_pk_add_f32 v[66:67], v[66:67], v[130:131]
    s_waitcnt lgkmcnt(10)
    v_pk_add_f32 v[64:65], v[64:65], v[132:133]
    v_pk_add_f32 v[66:67], v[66:67], v[134:135]
    s_waitcnt lgkmcnt(9)
    v_pk_add_f32 v[64:65], v[64:65], v[144:145]
    v_pk_add_f32 v[66:67], v[66:67], v[146:147]
    v_cvt_pk_bf16_f32 v192, v64, v65
    v_cvt_pk_bf16_f32 v193, v66, v67
    s_waitcnt lgkmcnt(8)
    v_pk_add_f32 v[80:81], v[80:81], v[148:149]
    v_pk_add_f32 v[82:83], v[82:83], v[150:151]
    s_waitcnt lgkmcnt(7)
    v_pk_add_f32 v[80:81], v[80:81], v[160:161]
    v_pk_add_f32 v[82:83], v[82:83], v[162:163]
    s_waitcnt lgkmcnt(6)
    v_pk_add_f32 v[80:81], v[80:81], v[164:165]
    v_pk_add_f32 v[82:83], v[82:83], v[166:167]
    v_cvt_pk_bf16_f32 v194, v80, v81
    v_cvt_pk_bf16_f32 v195, v82, v83
    s_nop 0
    v_permlane16_swap_b32 v192, v194
    v_permlane16_swap_b32 v193, v195
    buffer_store_dwordx4 v[192:195], v228, s[76:79], s100 offen offset:0
    s_waitcnt lgkmcnt(5)
    v_pk_add_f32 v[136:137], v[136:137], v[176:177]
    v_pk_add_f32 v[138:139], v[138:139], v[178:179]
    s_waitcnt lgkmcnt(4)
    v_pk_add_f32 v[136:137], v[136:137], v[180:181]
    v_pk_add_f32 v[138:139], v[138:139], v[182:183]
    s_waitcnt lgkmcnt(3)
    v_pk_add_f32 v[136:137], v[136:137], v[112:113]
    v_pk_add_f32 v[138:139], v[138:139], v[114:115]
    v_cvt_pk_bf16_f32 v196, v136, v137
    v_cvt_pk_bf16_f32 v197, v138, v139
    s_waitcnt lgkmcnt(2)
    v_pk_add_f32 v[168:169], v[168:169], v[116:117]
    v_pk_add_f32 v[170:171], v[170:171], v[118:119]
    s_waitcnt lgkmcnt(1)
    v_pk_add_f32 v[168:169], v[168:169], v[120:121]
    v_pk_add_f32 v[170:171], v[170:171], v[122:123]
    s_waitcnt lgkmcnt(0)
    v_pk_add_f32 v[168:169], v[168:169], v[124:125]
    v_pk_add_f32 v[170:171], v[170:171], v[126:127]
    v_cvt_pk_bf16_f32 v198, v168, v169
    v_cvt_pk_bf16_f32 v199, v170, v171
    s_nop 0
    v_permlane16_swap_b32 v196, v198
    v_permlane16_swap_b32 v197, v199
    buffer_store_dwordx4 v[196:199], v228, s[76:79], s100 offen offset:64
    s_endpgm

L_slowA0:

    s_mov_b32 s19, 0
L_loopA0:
    buffer_load_dword v21, v23, s[80:83], 0 offen offset:64 sc1
    s_waitcnt vmcnt(0)
    v_cmp_gt_u32 vcc, 1, v21
    s_nop 1
    s_cbranch_vccz L_okA0
    s_add_u32 s19, s19, 1
    s_cmp_lt_u32 s19, 262144
    s_cbranch_scc1 L_loopA0
    s_branch L_okA0
L_slowA1:

    s_mov_b32 s19, 0
L_loopA1:
    buffer_load_dword v21, v18, s[72:75], 0 offen offset:1024 sc1
    s_waitcnt vmcnt(0)
    v_cmp_gt_u32 vcc, 2, v21
    s_nop 1
    s_cbranch_vccz L_okA1
    s_add_u32 s19, s19, 1
    s_cmp_lt_u32 s19, 262144
    s_cbranch_scc1 L_loopA1
    s_branch L_okA1
L_slowA2:

    s_mov_b32 s19, 0
L_loopA2:
    buffer_load_dword v22, v20, s[72:75], 0 offen sc1
    s_waitcnt vmcnt(0)
    v_cmp_gt_u32 vcc, 1, v22
    s_nop 1
    s_cbranch_vccz L_okA2
    s_add_u32 s19, s19, 1
    s_cmp_lt_u32 s19, 262144
    s_cbranch_scc1 L_loopA2
    s_branch L_okA2
L_slowA3:

    s_mov_b32 s19, 0
L_loopA3:
    buffer_load_dword v21, v18, s[72:75], 0 offen sc1
    s_waitcnt vmcnt(0)
    v_cmp_gt_u32 vcc, 2, v21
    s_nop 1
    s_cbranch_vccz L_okA3
    s_add_u32 s19, s19, 1
    s_cmp_lt_u32 s19, 262144
    s_cbranch_scc1 L_loopA3
    s_branch L_okA3
L_slowred:

    s_mov_b32 s19, 0
L_loopred:
    buffer_load_dwordx4 v[192:195], v24, s[72:75], s10 offen offset:0 sc1
    buffer_load_dwordx4 v[196:199], v24, s[72:75], s10 offen offset:640 sc1
    buffer_load_dwordx4 v[200:203], v24, s[72:75], s10 offen offset:1280 sc1
    buffer_load_dwordx4 v[204:207], v24, s[72:75], s10 offen offset:1920 sc1
    buffer_load_dwordx4 v[208:211], v24, s[72:75], s10 offen offset:2560 sc1
    buffer_load_dwordx4 v[212:215], v24, s[72:75], s10 offen offset:3200 sc1
    buffer_load_dwordx4 v[216:219], v24, s[72:75], s11 offen offset:0 sc1
    buffer_load_dwordx4 v[220:223], v24, s[72:75], s11 offen offset:640 sc1
    buffer_load_dwordx4 v[224:227], v24, s[72:75], s11 offen offset:1280 sc1
    buffer_load_dwordx4 v[228:231], v24, s[72:75], s11 offen offset:1920 sc1
    buffer_load_dwordx4 v[232:235], v24, s[72:75], s11 offen offset:2560 sc1
    buffer_load_dwordx4 v[236:239], v24, s[72:75], s11 offen offset:3200 sc1
    buffer_load_dwordx4 v[240:243], v24, s[72:75], s12 offen offset:0 sc1
    buffer_load_dwordx4 v[244:247], v24, s[72:75], s12 offen offset:640 sc1
    buffer_load_dwordx4 v[248:251], v24, s[72:75], s12 offen offset:1280 sc1
    buffer_load_dwordx4 v[252:255], v24, s[72:75], s12 offen offset:1920 sc1
    s_waitcnt vmcnt(0)
    v_pk_add_f32 v[192:193], v[192:193], v[196:197]
    v_pk_add_f32 v[194:195], v[194:195], v[198:199]
    v_pk_add_f32 v[192:193], v[192:193], v[200:201]
    v_pk_add_f32 v[194:195], v[194:195], v[202:203]
    v_pk_add_f32 v[192:193], v[192:193], v[204:205]
    v_pk_add_f32 v[194:195], v[194:195], v[206:207]
    v_pk_add_f32 v[192:193], v[192:193], v[208:209]
    v_pk_add_f32 v[194:195], v[194:195], v[210:211]
    v_pk_add_f32 v[192:193], v[192:193], v[212:213]
    v_pk_add_f32 v[194:195], v[194:195], v[214:215]
    v_pk_add_f32 v[192:193], v[192:193], v[216:217]
    v_pk_add_f32 v[194:195], v[194:195], v[218:219]
    v_pk_add_f32 v[192:193], v[192:193], v[220:221]
    v_pk_add_f32 v[194:195], v[194:195], v[222:223]
    v_pk_add_f32 v[192:193], v[192:193], v[224:225]
    v_pk_add_f32 v[194:195], v[194:195], v[226:227]
    v_pk_add_f32 v[192:193], v[192:193], v[228:229]
    v_pk_add_f32 v[194:195], v[194:195], v[230:231]
    v_pk_add_f32 v[192:193], v[192:193], v[232:233]
    v_pk_add_f32 v[194:195], v[194:195], v[234:235]
    v_pk_add_f32 v[192:193], v[192:193], v[236:237]
    v_pk_add_f32 v[194:195], v[194:195], v[238:239]
    v_pk_add_f32 v[192:193], v[192:193], v[240:241]
    v_pk_add_f32 v[194:195], v[194:195], v[242:243]
    v_pk_add_f32 v[192:193], v[192:193], v[244:245]
    v_pk_add_f32 v[194:195], v[194:195], v[246:247]
    v_pk_add_f32 v[192:193], v[192:193], v[248:249]
    v_pk_add_f32 v[194:195], v[194:195], v[250:251]
    v_pk_add_f32 v[192:193], v[192:193], v[252:253]
    v_pk_add_f32 v[194:195], v[194:195], v[254:255]
    v_add_f32 v12, v192, v193
    v_add_f32 v13, v194, v195
    v_cmp_u_f32 vcc, v12, v13
    s_nop 1
    s_cbranch_vccz L_okred
    s_add_u32 s19, s19, 1
    s_cmp_lt_u32 s19, 16384
    s_cbranch_scc1 L_loopred
    s_branch L_okred
L_slowA4:

    s_mov_b32 s19, 0
L_loopA4:
    buffer_load_dword v21, v18, s[72:75], 0 offen offset:1024 sc1
    s_waitcnt vmcnt(0)
    v_cmp_gt_u32 vcc, 3, v21
    s_nop 1
    s_cbranch_vccz L_okA4
    s_add_u32 s19, s19, 1
    s_cmp_lt_u32 s19, 262144
    s_cbranch_scc1 L_loopA4
    s_branch L_okA4
L_slowA5:

    s_mov_b32 s19, 0
L_loopA5:
    buffer_load_dword v23, v19, s[72:75], 0 offen sc1
    s_waitcnt vmcnt(0)
    v_cmp_gt_u32 vcc, 1, v23
    s_nop 1
    s_cbranch_vccz L_okA5
    s_add_u32 s19, s19, 1
    s_cmp_lt_u32 s19, 262144
    s_cbranch_scc1 L_loopA5
    s_branch L_okA5
L_slowA6:

    s_mov_b32 s19, 0
L_loopA6:
    buffer_load_dword v22, v18, s[72:75], 0 offen sc1
    s_waitcnt vmcnt(0)
    v_cmp_gt_u32 vcc, 3, v22
    s_nop 1
    s_cbranch_vccz L_okA6
    s_add_u32 s19, s19, 1
    s_cmp_lt_u32 s19, 262144
    s_cbranch_scc1 L_loopA6
    s_branch L_okA6
L_slowfcA7:

    s_mov_b32 s19, 0
L_loopfcA7:
    s_add_u32 s101, s16, 0
    buffer_load_dwordx4 a[224:227], v108, s[72:75], s101 offen sc1
    buffer_load_dwordx4 a[228:231], v109, s[72:75], s101 offen sc1
    buffer_load_dwordx4 a[232:235], v110, s[72:75], s101 offen sc1
    buffer_load_dwordx4 a[236:239], v111, s[72:75], s101 offen sc1
    s_add_u32 s101, s16, 4096
    buffer_load_dwordx4 a[240:243], v108, s[72:75], s101 offen sc1
    buffer_load_dwordx4 a[244:247], v109, s[72:75], s101 offen sc1
    buffer_load_dwordx4 a[248:251], v110, s[72:75], s101 offen sc1
    buffer_load_dwordx4 a[252:255], v111, s[72:75], s101 offen sc1
    s_waitcnt vmcnt(0)
    v_accvgpr_read_b32 v3, a224
    v_accvgpr_read_b32 v4, a228
    v_max_u32 v7, v3, v4
    v_accvgpr_read_b32 v3, a232
    v_accvgpr_read_b32 v4, a236
    v_max3_u32 v7, v7, v3, v4
    v_accvgpr_read_b32 v3, a240
    v_accvgpr_read_b32 v4, a244
    v_max3_u32 v7, v7, v3, v4
    v_accvgpr_read_b32 v3, a248
    v_accvgpr_read_b32 v4, a252
    v_max3_u32 v7, v7, v3, v4
    v_cmp_eq_u32 vcc, -1, v7
    s_nop 1
    s_cbranch_vccz L_okfcA7
    s_add_u32 s19, s19, 1
    s_cmp_lt_u32 s19, 65536
    s_cbranch_scc1 L_loopfcA7
    s_branch L_okfcA7
L_slowfcA8:

    s_mov_b32 s19, 0
L_loopfcA8:
    s_add_u32 s101, s16, 8192
    buffer_load_dwordx4 a[0:3], v108, s[72:75], s101 offen sc1
    buffer_load_dwordx4 a[4:7], v109, s[72:75], s101 offen sc1
    buffer_load_dwordx4 a[8:11], v110, s[72:75], s101 offen sc1
    buffer_load_dwordx4 a[12:15], v111, s[72:75], s101 offen sc1
    s_add_u32 s101, s16, 12288
    buffer_load_dwordx4 a[16:19], v108, s[72:75], s101 offen sc1
    buffer_load_dwordx4 a[20:23], v109, s[72:75], s101 offen sc1
    buffer_load_dwordx4 a[24:27], v110, s[72:75], s101 offen sc1
    buffer_load_dwordx4 a[28:31], v111, s[72:75], s101 offen sc1
    s_waitcnt vmcnt(0)
    v_accvgpr_read_b32 v3, a0
    v_accvgpr_read_b32 v4, a4
    v_max_u32 v7, v3, v4
    v_accvgpr_read_b32 v3, a8
    v_accvgpr_read_b32 v4, a12
    v_max3_u32 v7, v7, v3, v4
    v_accvgpr_read_b32 v3, a16
    v_accvgpr_read_b32 v4, a20
    v_max3_u32 v7, v7, v3, v4
    v_accvgpr_read_b32 v3, a24
    v_accvgpr_read_b32 v4, a28
    v_max3_u32 v7, v7, v3, v4
    v_cmp_eq_u32 vcc, -1, v7
    s_nop 1
    s_cbranch_vccz L_okfcA8
    s_add_u32 s19, s19, 1
    s_cmp_lt_u32 s19, 65536
    s_cbranch_scc1 L_loopfcA8
    s_branch L_okfcA8

L_endA:
.p2align 6
L_typeB:
    v_and_b32 v73, 3, v0
    s_lshl_b32 s100, s91, 2
    s_add_u32 s100, s100, s88
    v_lshl_add_u32 v73, v73, 6, s100
    v_mul_u32_u24 v20, 3072, v73
    v_mul_u32_u24 v22, 3584, v73
    s_lshl_b32 s101, s93, 2
    s_add_u32 s101, s101, s88
    s_lshl_b32 s101, s101, 11
    v_and_b32 v73, 1, v0
    v_bfe_u32 v74, v0, 1, 2
    v_lshlrev_b32 v162, 7, v74
    v_lshl_add_u32 v162, v73, 10, v162
    v_add_u32 v162, s101, v162
    v_min_u32 v73, 6, v0
    s_lshl_b32 s100, s94, 2
    s_add_u32 s100, s100, s88
    s_mul_i32 s100, s100, 7
    v_add_lshl_u32 v19, v73, s100, 10
    v_mov_b32 v172, 0
    v_mov_b32 v173, 0
    v_mov_b32 v174, 0
    v_mov_b32 v175, 0
    s_or_b32 s101, s93, s88
    s_cmp_eq_u32 s101, 0
    s_cselect_b32 s101, 16, 0
    v_lshlrev_b32 v68, 7, v0
    v_mov_b32 v69, 1073741824
    v_cmp_gt_u32 vcc, s101, v0
    s_nop 1
    v_cndmask_b32 v68, v69, v68, vcc
    s_lshl_b32 s25, s91, 11
    s_add_u32 s25, s25, 10551296
    v_add_u32 v157, s25, v68
    s_min_u32 s101, s101, 1
    s_lshl_b32 s100, s91, 2
    s_add_u32 s100, s100, 64
    v_mov_b32 v152, s100
    v_cmp_gt_u32 vcc, s101, v0
    s_nop 1
    v_cndmask_b32 v152, v69, v152, vcc
    s_lshl_b32 s100, s95, 7
    s_add_u32 s56, s16, s100
    s_addc_u32 s57, s17, 0
    s_mov_b32 s58, 1835008
    s_mov_b32 s59, 0x20000
    s_add_u32 s64, s10, s100
    s_addc_u32 s65, s11, 0
    s_mov_b32 s66, 524288
    s_mov_b32 s67, 0x20000
    s_sub_u32 s58, s58, s100
    s_sub_u32 s66, s66, s100
    s_add_u32 s60, s56, 14336
    s_addc_u32 s61, s57, 0
    s_mov_b32 s62, 0
    s_mov_b32 s63, 0x20000
    s_add_u32 s68, s64, 2048
    s_addc_u32 s69, s65, 0
    s_mov_b32 s70, 0
    s_mov_b32 s71, 0x20000
    s_sub_u32 s62, s58, 14336
    s_sub_u32 s70, s66, 2048
    s_lshl_b32 s101, s94, 16
    s_add_u32 s100, s100, s101
    s_add_u32 s76, s20, s100
    s_addc_u32 s77, s21, 0
    s_mov_b32 s78, 2097152
    s_mov_b32 s79, 0x20000
    s_sub_u32 s78, s78, s100
    s_lshl_b32 s100, s92, 7
    s_add_u32 s48, s6, s100
    s_addc_u32 s49, s7, 0
    s_mov_b32 s50, 1572864
    s_mov_b32 s51, 0x20000
    s_sub_u32 s50, s50, s100
    s_add_u32 s52, s48, 194560
    s_addc_u32 s53, s49, 0
    s_mov_b32 s54, 0
    s_mov_b32 s55, 0x20000
    s_sub_u32 s54, s50, 194560
    s_mul_i32 s100, s92, 448
    s_mul_i32 s101, s3, 192
    s_add_u32 s100, s100, s101
    s_lshr_b32 s22, s100, 6
    s_add_u32 s22, s22, s90
    s_add_u32 s20, s22, 2
    s_add_u32 s100, s100, 128
    s_add_u32 s40, s12, s100
    s_addc_u32 s41, s13, 0
    s_mov_b32 s42, 1835008
    s_mov_b32 s43, 0x20000
    s_sub_u32 s42, s42, s100
    s_add_u32 s44, s14, s100
    s_addc_u32 s45, s15, 0
    s_mov_b32 s46, 1837056
    s_mov_b32 s47, 0x20000
    s_sub_u32 s46, s46, s100
    s_sub_u32 s44, s44, 2048
    s_subb_u32 s45, s45, 0
    s_lshl_b32 s23, s92, 1
    s_add_u32 s23, s23, s90
    s_add_u32 s23, s23, 56
    s_lshl_b32 s100, s92, 11
    s_lshl_b32 s101, s90, 10
    s_add_u32 s100, s100, s101
    v_add_u32 v156, s100, v11
    v_and_b32 v154, 31, v0
    v_lshlrev_b32 v154, 5, v154
    v_lshrrev_b32 v71, 5, v0
    v_lshl_add_u32 v155, v71, 10, v154
    s_lshl_b32 s100, s93, 2
    s_add_u32 s100, s100, s88
    s_lshl_b32 s25, s100, 11
    v_add_u32 v155, s25, v155
    s_lshl_b32 s100, s100, 3
    s_lshl_b32 s101, s91, 9
    s_add_u32 s24, s100, s101
    s_add_u32 s24, s24, 10485760
    v_lshlrev_b32 v71, 2, v71
    v_cmp_eq_u32 vcc, 0, v154
    s_nop 1
    v_cndmask_b32 v146, v69, v71, vcc
    v_mov_b32 v216, -1
    v_mov_b32 v217, -1
    v_mov_b32 v218, -1
    v_mov_b32 v219, -1
    s_lshl_b32 s100, s91, 1
    s_add_u32 s100, s100, s89
    s_mul_i32 s100, s100, 72
    s_add_u32 s22, s22, s100
    s_lshl_b32 s22, s22, 12
    s_add_u32 s20, s20, s100
    s_lshl_b32 s20, s20, 12
    s_add_u32 s23, s23, s100
    s_lshl_b32 s23, s23, 12
    s_mul_i32 s100, s94, 72
    s_mul_i32 s101, s88, 14
    s_lshl_b32 s17, s101, 15
    s_add_u32 s101, s101, s100
    s_lshl_b32 s15, s101, 12
    s_lshl_b32 s101, s88, 2
    s_lshl_b32 s18, s101, 15
    s_add_u32 s101, s101, s100
    s_add_u32 s101, s101, 56
    s_lshl_b32 s16, s101, 12
    s_lshl_b32 s100, s91, 4
    s_add_u32 s100, s100, s93
    s_lshl_b32 s100, s100, 5
    s_add_u32 s100, s100, s88
    s_lshl_b32 s100, s100, 2
    s_add_u32 s14, s100, 10551296
    v_lshrrev_b32 v74, 5, v0
    v_lshlrev_b32 v74, 12, v74
    v_bfe_u32 v75, v0, 4, 1
    v_lshl_add_u32 v74, v75, 10, v74
    v_bfe_u32 v75, v0, 2, 2
    v_lshl_add_u32 v74, v75, 7, v74
    v_and_b32 v75, 3, v0
    v_lshl_add_u32 v74, v75, 3, v74
    v_bfe_u32 v75, v0, 3, 2
    v_lshl_add_u32 v74, v75, 5, v74
    s_lshl_b32 s100, s90, 6
    v_xor_b32 v7, s100, v74
    v_xor_b32 v8, 32, v7
    v_add_u32 v9, 0x10000, v7
    v_add_u32 v10, 0x10000, v8
    v_and_b32 v74, 15, v0
    v_lshrrev_b32 v75, 4, v0
    v_bfe_u32 v192, v0, 1, 3
    v_xor_b32 v75, v75, v192
    v_lshlrev_b32 v75, 4, v75
    v_lshl_add_u32 v74, v74, 7, v75
    s_lshl_b32 s100, s89, 13
    s_add_u32 s100, s100, 81920
    v_add_u32 v192, s100, v74
    v_xor_b32 v193, 4096, v192
    v_xor_b32 v194, 64, v192
    v_xor_b32 v195, 64, v193
    v_lshrrev_b32 v74, 5, v0
    v_lshlrev_b32 v74, 8, v74
    v_bfe_u32 v75, v0, 2, 2
    v_lshl_add_u32 v74, v75, 5, v74
    v_bfe_u32 v75, v0, 4, 1
    v_lshl_add_u32 v74, v75, 4, v74
    v_bfe_u32 v75, v0, 1, 1
    v_lshl_add_u32 v74, v75, 3, v74
    s_add_u32 s100, s96, 147456
    v_add_u32 v148, s100, v74
    v_xor_b32 v149, 512, v148
    v_bfe_u32 v75, v0, 2, 1
    v_mul_u32_u24 v75, 0x8000, v75
    v_lshl_or_b32 v150, v75, 16, v75
    v_and_b32 v74, 7, v0
    v_bfe_u32 v75, v0, 4, 2
    v_lshlrev_b32 v75, 1, v75
    v_xor_b32 v74, v74, v75
    v_lshlrev_b32 v74, 4, v74
    v_lshrrev_b32 v75, 3, v0
    v_lshl_add_u32 v5, v75, 10, v74
    v_add_u32 v6, 7168, v5
    s_and_b32 s7, s95, 3
    s_xor_b32 s7, s7, s88
    s_add_u32 s0, s96, 147456
    s_add_u32 m0, s96, 147456
    s_nop 0
    buffer_load_dwordx4 v156, s[84:87], 0 offen lds
    buffer_load_dwordx4 v[128:131], v155, s[28:31], 0 offen
    buffer_load_dwordx4 v[132:135], v155, s[28:31], 0 offen offset:16
    global_load_dwordx4 v[136:139], v154, s[26:27]
    global_load_dwordx4 v[140:143], v154, s[26:27] offset:16
    s_add_u32 m0, s96, 16384
    s_add_u32 s99, s5, 1
    s_and_b32 s99, s99, 7
    s_mul_i32 s99, s99, 229376
    buffer_load_dwordx4 v3, s[32:35], s99 offen offset:0 lds
    buffer_load_dwordx4 v4, s[32:35], s99 offen offset:1024 lds
    buffer_load_dwordx4 v3, s[36:39], s99 offen offset:2048 lds
    buffer_load_dwordx4 v4, s[36:39], s99 offen offset:3072 lds
    s_waitcnt vmcnt(13)
    s_barrier
    ds_read_b64_tr_b16 v[32:33], v7 offset:0
    ds_read_b64_tr_b16 v[34:35], v7 offset:512
    ds_read_b64_tr_b16 v[36:37], v7 offset:8192
    ds_read_b64_tr_b16 v[38:39], v7 offset:8704
    ds_read_b128 a[0:3], v192 offset:0
    ds_read_b128 a[16:19], v194 offset:0
    ds_read_b128 a[4:7], v192 offset:2048
    ds_read_b128 a[20:23], v194 offset:2048
    ds_read_b128 a[8:11], v193 offset:0
    ds_read_b128 a[24:27], v195 offset:0
    ds_read_b128 a[12:15], v193 offset:2048
    ds_read_b128 a[28:31], v195 offset:2048
    ds_read_b64_tr_b16 v[40:41], v8 offset:0
    ds_read_b64_tr_b16 v[42:43], v8 offset:512
    ds_read_b64_tr_b16 v[44:45], v8 offset:8192
    ds_read_b64_tr_b16 v[46:47], v8 offset:8704
    s_waitcnt lgkmcnt(11)
    v_mfma_f32_16x16x32_bf16 v[64:67], v[32:35], a[0:3], 0
    ds_read_b64_tr_b16 v[48:49], v7 offset:2048
    s_add_u32 m0, s96, 114688
    s_waitcnt lgkmcnt(11)
    v_mfma_f32_16x16x32_bf16 v[64:67], v[36:39], a[16:19], v[64:67]
    s_add_u32 s99, s5, 2
    s_and_b32 s99, s99, 7
    s_lshl_b32 s99, s99, 7
    buffer_load_dwordx4 v224, s[28:31], s99 offen offset:0 lds
    s_waitcnt lgkmcnt(10)
    v_mfma_f32_16x16x32_bf16 v[68:71], v[32:35], a[4:7], 0
    ds_read_b64_tr_b16 v[50:51], v7 offset:2560
    s_waitcnt lgkmcnt(10)
    v_mfma_f32_16x16x32_bf16 v[68:71], v[36:39], a[20:23], v[68:71]
    buffer_load_dwordx4 v225, s[28:31], s99 offen offset:1024 lds
    s_waitcnt lgkmcnt(9)
    v_mfma_f32_16x16x32_bf16 v[72:75], v[32:35], a[8:11], 0
    ds_read_b64_tr_b16 v[52:53], v7 offset:10240
    s_waitcnt lgkmcnt(9)
    v_mfma_f32_16x16x32_bf16 v[72:75], v[36:39], a[24:27], v[72:75]
    buffer_load_dwordx4 v226, s[28:31], s99 offen offset:2048 lds
    s_waitcnt lgkmcnt(8)
    v_mfma_f32_16x16x32_bf16 v[76:79], v[32:35], a[12:15], 0
    buffer_load_dwordx4 v227, s[28:31], s99 offen offset:3072 lds
    s_add_u32 m0, s96, 32768
    s_waitcnt lgkmcnt(7)
    v_mfma_f32_16x16x32_bf16 v[76:79], v[36:39], a[28:31], v[76:79]
    ds_read_b64_tr_b16 v[54:55], v7 offset:10752
    s_waitcnt lgkmcnt(4)
    v_mfma_f32_16x16x32_bf16 v[80:83], v[40:43], a[0:3], 0
    ds_read_b64_tr_b16 v[32:33], v8 offset:2048
    s_add_u32 s99, s5, 2
    v_mfma_f32_16x16x32_bf16 v[80:83], v[44:47], a[16:19], v[80:83]
    s_and_b32 s99, s99, 7
    s_mul_i32 s99, s99, 229376
    buffer_load_dwordx4 v3, s[32:35], s99 offen offset:0 lds
    v_mfma_f32_16x16x32_bf16 v[84:87], v[40:43], a[4:7], 0
    ds_read_b64_tr_b16 v[34:35], v8 offset:2560
    v_mfma_f32_16x16x32_bf16 v[84:87], v[44:47], a[20:23], v[84:87]
    buffer_load_dwordx4 v4, s[32:35], s99 offen offset:1024 lds
    v_mfma_f32_16x16x32_bf16 v[88:91], v[40:43], a[8:11], 0
    ds_read_b64_tr_b16 v[36:37], v8 offset:10240
    v_mfma_f32_16x16x32_bf16 v[88:91], v[44:47], a[24:27], v[88:91]
    buffer_load_dwordx4 v3, s[36:39], s99 offen offset:2048 lds
    v_mfma_f32_16x16x32_bf16 v[92:95], v[40:43], a[12:15], 0
    buffer_load_dwordx4 v4, s[36:39], s99 offen offset:3072 lds
    v_mfma_f32_16x16x32_bf16 v[92:95], v[44:47], a[28:31], v[92:95]
    ds_read_b64_tr_b16 v[38:39], v8 offset:10752
    s_waitcnt vmcnt(8) lgkmcnt(4)
    s_barrier
    v_mfma_f32_16x16x32_bf16 v[96:99], v[48:51], a[0:3], 0
    ds_read_b128 a[32:35], v192 offset:16384
    s_add_u32 m0, s96, 131072
    v_mfma_f32_16x16x32_bf16 v[96:99], v[52:55], a[16:19], v[96:99]
    ds_read_b128 a[48:51], v194 offset:16384
    s_add_u32 s99, s5, 3
    v_mfma_f32_16x16x32_bf16 v[100:103], v[48:51], a[4:7], 0
    ds_read_b128 a[36:39], v192 offset:18432
    s_and_b32 s99, s99, 7
    s_lshl_b32 s99, s99, 7
    buffer_load_dwordx4 v224, s[28:31], s99 offen offset:0 lds
    v_mfma_f32_16x16x32_bf16 v[100:103], v[52:55], a[20:23], v[100:103]
    ds_read_b128 a[52:55], v194 offset:18432
    v_mfma_f32_16x16x32_bf16 v[104:107], v[48:51], a[8:11], 0
    ds_read_b64_tr_b16 v[40:41], v7 offset:16384
    buffer_load_dwordx4 v225, s[28:31], s99 offen offset:1024 lds
    v_mfma_f32_16x16x32_bf16 v[104:107], v[52:55], a[24:27], v[104:107]
    ds_read_b64_tr_b16 v[42:43], v7 offset:16896
    v_mfma_f32_16x16x32_bf16 v[108:111], v[48:51], a[12:15], 0
    ds_read_b64_tr_b16 v[44:45], v7 offset:24576
    buffer_load_dwordx4 v226, s[28:31], s99 offen offset:2048 lds
    v_mfma_f32_16x16x32_bf16 v[108:111], v[52:55], a[28:31], v[108:111]
    ds_read_b64_tr_b16 v[46:47], v7 offset:25088
    s_waitcnt lgkmcnt(8)
    v_mfma_f32_16x16x32_bf16 v[112:115], v[32:35], a[0:3], 0
    ds_read_b128 a[40:43], v193 offset:16384
    v_mfma_f32_16x16x32_bf16 v[112:115], v[36:39], a[16:19], v[112:115]
    ds_read_b128 a[56:59], v195 offset:16384
    v_mfma_f32_16x16x32_bf16 v[116:119], v[32:35], a[4:7], 0
    ds_read_b128 a[44:47], v193 offset:18432
    buffer_load_dwordx4 v227, s[28:31], s99 offen offset:3072 lds
    v_mfma_f32_16x16x32_bf16 v[116:119], v[36:39], a[20:23], v[116:119]
    ds_read_b128 a[60:63], v195 offset:18432
    s_add_u32 m0, s96, 81920
    v_mfma_f32_16x16x32_bf16 v[120:123], v[32:35], a[8:11], 0
    ds_read_b64_tr_b16 v[48:49], v8 offset:16384
    s_add_u32 s99, s5, 4
    s_and_b32 s99, s99, 7
    s_lshl_b32 s99, s99, 7
    buffer_load_dwordx4 v224, s[28:31], s99 offen offset:0 lds
    v_mfma_f32_16x16x32_bf16 v[120:123], v[36:39], a[24:27], v[120:123]
    ds_read_b64_tr_b16 v[50:51], v8 offset:16896
    v_mfma_f32_16x16x32_bf16 v[124:127], v[32:35], a[12:15], 0
    ds_read_b64_tr_b16 v[52:53], v8 offset:24576
    buffer_load_dwordx4 v225, s[28:31], s99 offen offset:1024 lds
    v_mfma_f32_16x16x32_bf16 v[124:127], v[36:39], a[28:31], v[124:127]
    ds_read_b64_tr_b16 v[54:55], v8 offset:25088
    s_waitcnt lgkmcnt(4)
    v_mfma_f32_16x16x32_bf16 v[64:67], v[40:43], a[32:35], v[64:67]
    ds_read_b64_tr_b16 v[32:33], v7 offset:18432
    v_mfma_f32_16x16x32_bf16 v[64:67], v[44:47], a[48:51], v[64:67]
    ds_read_b64_tr_b16 v[34:35], v7 offset:18944
    v_mfma_f32_16x16x32_bf16 v[68:71], v[40:43], a[36:39], v[68:71]
    buffer_load_dwordx4 v226, s[28:31], s99 offen offset:2048 lds
    v_mfma_f32_16x16x32_bf16 v[68:71], v[44:47], a[52:55], v[68:71]
    ds_read_b64_tr_b16 v[36:37], v7 offset:26624
    v_mfma_f32_16x16x32_bf16 v[72:75], v[40:43], a[40:43], v[72:75]
    buffer_load_dwordx4 v227, s[28:31], s99 offen offset:3072 lds
    s_add_u32 m0, s96, 49152
    v_mfma_f32_16x16x32_bf16 v[72:75], v[44:47], a[56:59], v[72:75]
    ds_read_b64_tr_b16 v[38:39], v7 offset:27136
    s_add_u32 s99, s5, 3
    v_mfma_f32_16x16x32_bf16 v[76:79], v[40:43], a[44:47], v[76:79]
    s_and_b32 s99, s99, 7
    s_mul_i32 s99, s99, 229376
    buffer_load_dwordx4 v3, s[32:35], s99 offen offset:0 lds
    v_mfma_f32_16x16x32_bf16 v[76:79], v[44:47], a[60:63], v[76:79]
    s_waitcnt lgkmcnt(4)
    v_mfma_f32_16x16x32_bf16 v[80:83], v[48:51], a[32:35], v[80:83]
    ds_read_b64_tr_b16 v[40:41], v8 offset:18432
    v_mfma_f32_16x16x32_bf16 v[80:83], v[52:55], a[48:51], v[80:83]
    ds_read_b64_tr_b16 v[42:43], v8 offset:18944
    v_mfma_f32_16x16x32_bf16 v[84:87], v[48:51], a[36:39], v[84:87]
    buffer_load_dwordx4 v4, s[32:35], s99 offen offset:1024 lds
    v_mfma_f32_16x16x32_bf16 v[84:87], v[52:55], a[52:55], v[84:87]
    ds_read_b64_tr_b16 v[44:45], v8 offset:26624
    v_mfma_f32_16x16x32_bf16 v[88:91], v[48:51], a[40:43], v[88:91]
    buffer_load_dwordx4 v3, s[36:39], s99 offen offset:2048 lds
    v_mfma_f32_16x16x32_bf16 v[88:91], v[52:55], a[56:59], v[88:91]
    ds_read_b64_tr_b16 v[46:47], v8 offset:27136
    v_mfma_f32_16x16x32_bf16 v[92:95], v[48:51], a[44:47], v[92:95]
    buffer_load_dwordx4 v4, s[36:39], s99 offen offset:3072 lds
    v_mfma_f32_16x16x32_bf16 v[92:95], v[52:55], a[60:63], v[92:95]
    s_waitcnt vmcnt(8) lgkmcnt(4)
    s_barrier
    v_mfma_f32_16x16x32_bf16 v[96:99], v[32:35], a[32:35], v[96:99]
    ds_read_b128 a[64:67], v192 offset:32768
    s_add_u32 m0, s96, 98304
    v_mfma_f32_16x16x32_bf16 v[96:99], v[36:39], a[48:51], v[96:99]
    ds_read_b128 a[80:83], v194 offset:32768
    s_add_u32 s99, s5, 5
    v_mfma_f32_16x16x32_bf16 v[100:103], v[32:35], a[36:39], v[100:103]
    ds_read_b128 a[68:71], v192 offset:34816
    s_and_b32 s99, s99, 7
    v_mfma_f32_16x16x32_bf16 v[100:103], v[36:39], a[52:55], v[100:103]
    ds_read_b128 a[84:87], v194 offset:34816
    s_lshl_b32 s99, s99, 7
    buffer_load_dwordx4 v224, s[28:31], s99 offen offset:0 lds
    v_mfma_f32_16x16x32_bf16 v[104:107], v[32:35], a[40:43], v[104:107]
    ds_read_b64_tr_b16 v[48:49], v7 offset:32768
    v_mfma_f32_16x16x32_bf16 v[104:107], v[36:39], a[56:59], v[104:107]
    ds_read_b64_tr_b16 v[50:51], v7 offset:33280
    v_mfma_f32_16x16x32_bf16 v[108:111], v[32:35], a[44:47], v[108:111]
    ds_read_b64_tr_b16 v[52:53], v7 offset:40960
    buffer_load_dwordx4 v225, s[28:31], s99 offen offset:1024 lds
    v_mfma_f32_16x16x32_bf16 v[108:111], v[36:39], a[60:63], v[108:111]
    ds_read_b64_tr_b16 v[54:55], v7 offset:41472
    s_waitcnt lgkmcnt(8)
    v_mfma_f32_16x16x32_bf16 v[112:115], v[40:43], a[32:35], v[112:115]
    ds_read_b128 a[72:75], v193 offset:32768
    v_mfma_f32_16x16x32_bf16 v[112:115], v[44:47], a[48:51], v[112:115]
    ds_read_b128 a[88:91], v195 offset:32768
    v_mfma_f32_16x16x32_bf16 v[116:119], v[40:43], a[36:39], v[116:119]
    ds_read_b128 a[76:79], v193 offset:34816
    v_mfma_f32_16x16x32_bf16 v[116:119], v[44:47], a[52:55], v[116:119]
    ds_read_b128 a[92:95], v195 offset:34816
    buffer_load_dwordx4 v226, s[28:31], s99 offen offset:2048 lds
    v_mfma_f32_16x16x32_bf16 v[120:123], v[40:43], a[40:43], v[120:123]
    ds_read_b64_tr_b16 v[32:33], v8 offset:32768
    v_mfma_f32_16x16x32_bf16 v[120:123], v[44:47], a[56:59], v[120:123]
    ds_read_b64_tr_b16 v[34:35], v8 offset:33280
    v_mfma_f32_16x16x32_bf16 v[124:127], v[40:43], a[44:47], v[124:127]
    ds_read_b64_tr_b16 v[36:37], v8 offset:40960
    buffer_load_dwordx4 v227, s[28:31], s99 offen offset:3072 lds
    v_mfma_f32_16x16x32_bf16 v[124:127], v[44:47], a[60:63], v[124:127]
    ds_read_b64_tr_b16 v[38:39], v8 offset:41472
    s_waitcnt lgkmcnt(4)
    v_mfma_f32_16x16x32_bf16 v[64:67], v[48:51], a[64:67], v[64:67]
    ds_read_b128 a[96:99], v192 offset:49152
    s_add_u32 m0, s96, 0
    v_mfma_f32_16x16x32_bf16 v[64:67], v[52:55], a[80:83], v[64:67]
    ds_read_b128 a[112:115], v194 offset:49152
    s_add_u32 s99, s5, 4
    v_mfma_f32_16x16x32_bf16 v[68:71], v[48:51], a[68:71], v[68:71]
    ds_read_b64_tr_b16 v[40:41], v7 offset:34816
    s_and_b32 s99, s99, 7
    v_mfma_f32_16x16x32_bf16 v[68:71], v[52:55], a[84:87], v[68:71]
    s_mul_i32 s99, s99, 229376
    buffer_load_dwordx4 v3, s[32:35], s99 offen offset:0 lds
    v_mfma_f32_16x16x32_bf16 v[72:75], v[48:51], a[72:75], v[72:75]
    ds_read_b64_tr_b16 v[42:43], v7 offset:35328
    v_mfma_f32_16x16x32_bf16 v[72:75], v[52:55], a[88:91], v[72:75]
    ds_read_b64_tr_b16 v[44:45], v7 offset:43008
    v_mfma_f32_16x16x32_bf16 v[76:79], v[48:51], a[76:79], v[76:79]
    buffer_load_dwordx4 v4, s[32:35], s99 offen offset:1024 lds
    v_mfma_f32_16x16x32_bf16 v[76:79], v[52:55], a[92:95], v[76:79]
    ds_read_b64_tr_b16 v[46:47], v7 offset:43520
    s_waitcnt lgkmcnt(6)
    v_mfma_f32_16x16x32_bf16 v[80:83], v[32:35], a[64:67], v[80:83]
    ds_read_b128 a[100:103], v192 offset:51200
    v_mfma_f32_16x16x32_bf16 v[80:83], v[36:39], a[80:83], v[80:83]
    ds_read_b128 a[116:119], v194 offset:51200
    v_mfma_f32_16x16x32_bf16 v[84:87], v[32:35], a[68:71], v[84:87]
    ds_read_b64_tr_b16 v[48:49], v8 offset:34816
    v_mfma_f32_16x16x32_bf16 v[84:87], v[36:39], a[84:87], v[84:87]
    buffer_load_dwordx4 v3, s[36:39], s99 offen offset:2048 lds
    v_mfma_f32_16x16x32_bf16 v[88:91], v[32:35], a[72:75], v[88:91]
    ds_read_b64_tr_b16 v[50:51], v8 offset:35328
    v_mfma_f32_16x16x32_bf16 v[88:91], v[36:39], a[88:91], v[88:91]
    ds_read_b64_tr_b16 v[52:53], v8 offset:43008
    v_mfma_f32_16x16x32_bf16 v[92:95], v[32:35], a[76:79], v[92:95]
    buffer_load_dwordx4 v4, s[36:39], s99 offen offset:3072 lds
    v_mfma_f32_16x16x32_bf16 v[92:95], v[36:39], a[92:95], v[92:95]
    ds_read_b64_tr_b16 v[54:55], v8 offset:43520
    s_waitcnt vmcnt(8) lgkmcnt(6)
    s_barrier
    v_mfma_f32_16x16x32_bf16 v[96:99], v[40:43], a[64:67], v[96:99]
    ds_read_b128 a[104:107], v193 offset:49152
    s_add_u32 m0, s96, 114688
    v_mfma_f32_16x16x32_bf16 v[96:99], v[44:47], a[80:83], v[96:99]
    ds_read_b128 a[120:123], v195 offset:49152
    s_add_u32 s99, s5, 6
    v_mfma_f32_16x16x32_bf16 v[100:103], v[40:43], a[68:71], v[100:103]
    ds_read_b64_tr_b16 v[32:33], v7 offset:49152
    s_and_b32 s99, s99, 7
    v_mfma_f32_16x16x32_bf16 v[100:103], v[44:47], a[84:87], v[100:103]
    s_lshl_b32 s99, s99, 7
    buffer_load_dwordx4 v224, s[28:31], s99 offen offset:0 lds
    v_mfma_f32_16x16x32_bf16 v[104:107], v[40:43], a[72:75], v[104:107]
    ds_read_b64_tr_b16 v[34:35], v7 offset:49664
    v_mfma_f32_16x16x32_bf16 v[104:107], v[44:47], a[88:91], v[104:107]
    ds_read_b64_tr_b16 v[36:37], v7 offset:57344
    v_mfma_f32_16x16x32_bf16 v[108:111], v[40:43], a[76:79], v[108:111]
    buffer_load_dwordx4 v225, s[28:31], s99 offen offset:1024 lds
    v_mfma_f32_16x16x32_bf16 v[108:111], v[44:47], a[92:95], v[108:111]
    ds_read_b64_tr_b16 v[38:39], v7 offset:57856
    s_waitcnt lgkmcnt(6)
    v_mfma_f32_16x16x32_bf16 v[112:115], v[48:51], a[64:67], v[112:115]
    ds_read_b128 a[108:111], v193 offset:51200
    v_mfma_f32_16x16x32_bf16 v[112:115], v[52:55], a[80:83], v[112:115]
    ds_read_b128 a[124:127], v195 offset:51200
    v_mfma_f32_16x16x32_bf16 v[116:119], v[48:51], a[68:71], v[116:119]
    ds_read_b64_tr_b16 v[40:41], v8 offset:49152
    v_mfma_f32_16x16x32_bf16 v[116:119], v[52:55], a[84:87], v[116:119]
    buffer_load_dwordx4 v226, s[28:31], s99 offen offset:2048 lds
    v_mfma_f32_16x16x32_bf16 v[120:123], v[48:51], a[72:75], v[120:123]
    ds_read_b64_tr_b16 v[42:43], v8 offset:49664
    v_mfma_f32_16x16x32_bf16 v[120:123], v[52:55], a[88:91], v[120:123]
    ds_read_b64_tr_b16 v[44:45], v8 offset:57344
    v_mfma_f32_16x16x32_bf16 v[124:127], v[48:51], a[76:79], v[124:127]
    buffer_load_dwordx4 v227, s[28:31], s99 offen offset:3072 lds
    s_add_u32 m0, s96, 16384
    v_mfma_f32_16x16x32_bf16 v[124:127], v[52:55], a[92:95], v[124:127]
    ds_read_b64_tr_b16 v[46:47], v8 offset:57856
    s_waitcnt lgkmcnt(4)
    v_mfma_f32_16x16x32_bf16 v[64:67], v[32:35], a[96:99], v[64:67]
    ds_read_b128 a[128:131], v192 offset:0
    s_add_u32 s99, s5, 5
    v_mfma_f32_16x16x32_bf16 v[64:67], v[36:39], a[112:115], v[64:67]
    ds_read_b128 a[144:147], v194 offset:0
    s_and_b32 s99, s99, 7
    v_mfma_f32_16x16x32_bf16 v[68:71], v[32:35], a[100:103], v[68:71]
    ds_read_b64_tr_b16 v[48:49], v7 offset:51200
    s_mul_i32 s99, s99, 229376
    v_mfma_f32_16x16x32_bf16 v[68:71], v[36:39], a[116:119], v[68:71]
    buffer_load_dwordx4 v3, s[32:35], s99 offen offset:0 lds
    v_mfma_f32_16x16x32_bf16 v[72:75], v[32:35], a[104:107], v[72:75]
    ds_read_b64_tr_b16 v[50:51], v7 offset:51712
    v_mfma_f32_16x16x32_bf16 v[72:75], v[36:39], a[120:123], v[72:75]
    ds_read_b64_tr_b16 v[52:53], v7 offset:59392
    v_mfma_f32_16x16x32_bf16 v[76:79], v[32:35], a[108:111], v[76:79]
    buffer_load_dwordx4 v4, s[32:35], s99 offen offset:1024 lds
    v_mfma_f32_16x16x32_bf16 v[76:79], v[36:39], a[124:127], v[76:79]
    ds_read_b64_tr_b16 v[54:55], v7 offset:59904
    s_waitcnt lgkmcnt(6)
    v_mfma_f32_16x16x32_bf16 v[80:83], v[40:43], a[96:99], v[80:83]
    ds_read_b128 a[132:135], v192 offset:2048
    v_mfma_f32_16x16x32_bf16 v[80:83], v[44:47], a[112:115], v[80:83]
    ds_read_b128 a[148:151], v194 offset:2048
    v_mfma_f32_16x16x32_bf16 v[84:87], v[40:43], a[100:103], v[84:87]
    ds_read_b64_tr_b16 v[32:33], v8 offset:51200
    v_mfma_f32_16x16x32_bf16 v[84:87], v[44:47], a[116:119], v[84:87]
    buffer_load_dwordx4 v3, s[36:39], s99 offen offset:2048 lds
    v_mfma_f32_16x16x32_bf16 v[88:91], v[40:43], a[104:107], v[88:91]
    ds_read_b64_tr_b16 v[34:35], v8 offset:51712
    v_mfma_f32_16x16x32_bf16 v[88:91], v[44:47], a[120:123], v[88:91]
    ds_read_b64_tr_b16 v[36:37], v8 offset:59392
    v_mfma_f32_16x16x32_bf16 v[92:95], v[40:43], a[108:111], v[92:95]
    buffer_load_dwordx4 v4, s[36:39], s99 offen offset:3072 lds
    v_mfma_f32_16x16x32_bf16 v[92:95], v[44:47], a[124:127], v[92:95]
    ds_read_b64_tr_b16 v[38:39], v8 offset:59904
    s_waitcnt vmcnt(8) lgkmcnt(6)
    s_barrier
    v_mfma_f32_16x16x32_bf16 v[96:99], v[48:51], a[96:99], v[96:99]
    ds_read_b128 a[136:139], v193 offset:0
    s_add_u32 m0, s96, 131072
    v_mfma_f32_16x16x32_bf16 v[96:99], v[52:55], a[112:115], v[96:99]
    ds_read_b128 a[152:155], v195 offset:0
    s_add_u32 s99, s5, 7
    v_mfma_f32_16x16x32_bf16 v[100:103], v[48:51], a[100:103], v[100:103]
    ds_read_b64_tr_b16 v[40:41], v7 offset:0
    s_and_b32 s99, s99, 7
    s_lshl_b32 s99, s99, 7
    buffer_load_dwordx4 v224, s[28:31], s99 offen offset:0 lds
    v_mfma_f32_16x16x32_bf16 v[100:103], v[52:55], a[116:119], v[100:103]
    ds_read_b64_tr_b16 v[42:43], v7 offset:512
    v_mfma_f32_16x16x32_bf16 v[104:107], v[48:51], a[104:107], v[104:107]
    buffer_load_dwordx4 v225, s[28:31], s99 offen offset:1024 lds
    v_mfma_f32_16x16x32_bf16 v[104:107], v[52:55], a[120:123], v[104:107]
    ds_read_b64_tr_b16 v[44:45], v7 offset:8192
    v_mfma_f32_16x16x32_bf16 v[108:111], v[48:51], a[108:111], v[108:111]
    buffer_load_dwordx4 v226, s[28:31], s99 offen offset:2048 lds
    v_mfma_f32_16x16x32_bf16 v[108:111], v[52:55], a[124:127], v[108:111]
    ds_read_b64_tr_b16 v[46:47], v7 offset:8704
    s_waitcnt lgkmcnt(6)
    v_mfma_f32_16x16x32_bf16 v[112:115], v[32:35], a[96:99], v[112:115]
    ds_read_b128 a[140:143], v193 offset:2048
    v_mfma_f32_16x16x32_bf16 v[112:115], v[36:39], a[112:115], v[112:115]
    ds_read_b128 a[156:159], v195 offset:2048
    v_mfma_f32_16x16x32_bf16 v[116:119], v[32:35], a[100:103], v[116:119]
    ds_read_b64_tr_b16 v[48:49], v8 offset:0
    buffer_load_dwordx4 v227, s[28:31], s99 offen offset:3072 lds
    v_mfma_f32_16x16x32_bf16 v[116:119], v[36:39], a[116:119], v[116:119]
    ds_read_b64_tr_b16 v[50:51], v8 offset:512
    s_add_u32 m0, s96, 32768
    v_mfma_f32_16x16x32_bf16 v[120:123], v[32:35], a[104:107], v[120:123]
    s_add_u32 s99, s5, 6
    s_and_b32 s99, s99, 7
    s_mul_i32 s99, s99, 229376
    buffer_load_dwordx4 v3, s[32:35], s99 offen offset:0 lds
    v_mfma_f32_16x16x32_bf16 v[120:123], v[36:39], a[120:123], v[120:123]
    ds_read_b64_tr_b16 v[52:53], v8 offset:8192
    v_mfma_f32_16x16x32_bf16 v[124:127], v[32:35], a[108:111], v[124:127]
    buffer_load_dwordx4 v4, s[32:35], s99 offen offset:1024 lds
    v_mfma_f32_16x16x32_bf16 v[124:127], v[36:39], a[124:127], v[124:127]
    ds_read_b64_tr_b16 v[54:55], v8 offset:8704
    s_waitcnt lgkmcnt(4)
    v_mfma_f32_16x16x32_bf16 v[64:67], v[40:43], a[128:131], v[64:67]
    ds_read_b128 a[160:163], v192 offset:16384
    v_mfma_f32_16x16x32_bf16 v[64:67], v[44:47], a[144:147], v[64:67]
    ds_read_b128 a[176:179], v194 offset:16384
    v_mfma_f32_16x16x32_bf16 v[68:71], v[40:43], a[132:135], v[68:71]
    ds_read_b64_tr_b16 v[32:33], v7 offset:2048
    buffer_load_dwordx4 v3, s[36:39], s99 offen offset:2048 lds
    v_mfma_f32_16x16x32_bf16 v[68:71], v[44:47], a[148:151], v[68:71]
    ds_read_b64_tr_b16 v[34:35], v7 offset:2560
    v_mfma_f32_16x16x32_bf16 v[72:75], v[40:43], a[136:139], v[72:75]
    buffer_load_dwordx4 v4, s[36:39], s99 offen offset:3072 lds
    s_add_u32 m0, s96, 65536
    v_mfma_f32_16x16x32_bf16 v[72:75], v[44:47], a[152:155], v[72:75]
    ds_read_b64_tr_b16 v[36:37], v7 offset:10240
    s_add_u32 s99, s5, 7
    v_mfma_f32_16x16x32_bf16 v[76:79], v[40:43], a[140:143], v[76:79]
    s_and_b32 s99, s99, 7
    s_mul_i32 s99, s99, 229376
    buffer_load_dwordx4 v3, s[32:35], s99 offen offset:0 lds
    v_mfma_f32_16x16x32_bf16 v[76:79], v[44:47], a[156:159], v[76:79]
    ds_read_b64_tr_b16 v[38:39], v7 offset:10752
    s_waitcnt lgkmcnt(6)
    v_mfma_f32_16x16x32_bf16 v[80:83], v[48:51], a[128:131], v[80:83]
    ds_read_b128 a[164:167], v192 offset:18432
    v_mfma_f32_16x16x32_bf16 v[80:83], v[52:55], a[144:147], v[80:83]
    ds_read_b128 a[180:183], v194 offset:18432
    v_mfma_f32_16x16x32_bf16 v[84:87], v[48:51], a[132:135], v[84:87]
    ds_read_b64_tr_b16 v[40:41], v8 offset:2048
    buffer_load_dwordx4 v4, s[32:35], s99 offen offset:1024 lds
    v_mfma_f32_16x16x32_bf16 v[84:87], v[52:55], a[148:151], v[84:87]
    ds_read_b64_tr_b16 v[42:43], v8 offset:2560
    v_mfma_f32_16x16x32_bf16 v[88:91], v[48:51], a[136:139], v[88:91]
    buffer_load_dwordx4 v3, s[36:39], s99 offen offset:2048 lds
    v_mfma_f32_16x16x32_bf16 v[88:91], v[52:55], a[152:155], v[88:91]
    ds_read_b64_tr_b16 v[44:45], v8 offset:10240
    v_mfma_f32_16x16x32_bf16 v[92:95], v[48:51], a[140:143], v[92:95]
    buffer_load_dwordx4 v4, s[36:39], s99 offen offset:3072 lds
    v_mfma_f32_16x16x32_bf16 v[92:95], v[52:55], a[156:159], v[92:95]
    ds_read_b64_tr_b16 v[46:47], v8 offset:10752
    s_waitcnt vmcnt(12) lgkmcnt(6)
    s_barrier
    v_mfma_f32_16x16x32_bf16 v[96:99], v[32:35], a[128:131], v[96:99]
    ds_read_b128 a[168:171], v193 offset:16384
    s_add_u32 m0, s96, 49152
    v_mfma_f32_16x16x32_bf16 v[96:99], v[36:39], a[144:147], v[96:99]
    ds_read_b128 a[184:187], v195 offset:16384
    s_add_u32 s99, s5, 0
    v_mfma_f32_16x16x32_bf16 v[100:103], v[32:35], a[132:135], v[100:103]
    ds_read_b64_tr_b16 v[48:49], v7 offset:16384
    s_and_b32 s99, s99, 7
    v_mfma_f32_16x16x32_bf16 v[100:103], v[36:39], a[148:151], v[100:103]
    s_mul_i32 s99, s99, 229376
    buffer_load_dwordx4 v3, s[40:43], s99 offen offset:0 lds
    v_mfma_f32_16x16x32_bf16 v[104:107], v[32:35], a[136:139], v[104:107]
    ds_read_b64_tr_b16 v[50:51], v7 offset:16896
    v_mfma_f32_16x16x32_bf16 v[104:107], v[36:39], a[152:155], v[104:107]
    ds_read_b64_tr_b16 v[52:53], v7 offset:24576
    v_mfma_f32_16x16x32_bf16 v[108:111], v[32:35], a[140:143], v[108:111]
    buffer_load_dwordx4 v4, s[40:43], s99 offen offset:1024 lds
    v_mfma_f32_16x16x32_bf16 v[108:111], v[36:39], a[156:159], v[108:111]
    ds_read_b64_tr_b16 v[54:55], v7 offset:25088
    s_waitcnt lgkmcnt(6)
    v_mfma_f32_16x16x32_bf16 v[112:115], v[40:43], a[128:131], v[112:115]
    ds_read_b128 a[172:175], v193 offset:18432
    v_mfma_f32_16x16x32_bf16 v[112:115], v[44:47], a[144:147], v[112:115]
    ds_read_b128 a[188:191], v195 offset:18432
    v_mfma_f32_16x16x32_bf16 v[116:119], v[40:43], a[132:135], v[116:119]
    ds_read_b64_tr_b16 v[32:33], v8 offset:16384
    v_mfma_f32_16x16x32_bf16 v[116:119], v[44:47], a[148:151], v[116:119]
    buffer_load_dwordx4 v3, s[44:47], s99 offen offset:2048 lds
    v_mfma_f32_16x16x32_bf16 v[120:123], v[40:43], a[136:139], v[120:123]
    ds_read_b64_tr_b16 v[34:35], v8 offset:16896
    v_mfma_f32_16x16x32_bf16 v[120:123], v[44:47], a[152:155], v[120:123]
    ds_read_b64_tr_b16 v[36:37], v8 offset:24576
    v_mfma_f32_16x16x32_bf16 v[124:127], v[40:43], a[140:143], v[124:127]
    buffer_load_dwordx4 v4, s[44:47], s99 offen offset:3072 lds
    s_add_u32 m0, s96, 81920
    v_mfma_f32_16x16x32_bf16 v[124:127], v[44:47], a[156:159], v[124:127]
    ds_read_b64_tr_b16 v[38:39], v8 offset:25088
    s_waitcnt lgkmcnt(4)
    v_mfma_f32_16x16x32_bf16 v[64:67], v[48:51], a[160:163], v[64:67]
    ds_read_b128 a[192:195], v192 offset:32768
    s_add_u32 s99, s5, 1
    v_mfma_f32_16x16x32_bf16 v[64:67], v[52:55], a[176:179], v[64:67]
    ds_read_b128 a[208:211], v194 offset:32768
    s_and_b32 s99, s99, 7
    v_mfma_f32_16x16x32_bf16 v[68:71], v[48:51], a[164:167], v[68:71]
    ds_read_b64_tr_b16 v[40:41], v7 offset:18432
    s_mul_i32 s99, s99, 229376
    v_mfma_f32_16x16x32_bf16 v[68:71], v[52:55], a[180:183], v[68:71]
    buffer_load_dwordx4 v3, s[40:43], s99 offen offset:0 lds
    v_mfma_f32_16x16x32_bf16 v[72:75], v[48:51], a[168:171], v[72:75]
    ds_read_b64_tr_b16 v[42:43], v7 offset:18944
    v_mfma_f32_16x16x32_bf16 v[72:75], v[52:55], a[184:187], v[72:75]
    ds_read_b64_tr_b16 v[44:45], v7 offset:26624
    v_mfma_f32_16x16x32_bf16 v[76:79], v[48:51], a[172:175], v[76:79]
    buffer_load_dwordx4 v4, s[40:43], s99 offen offset:1024 lds
    v_mfma_f32_16x16x32_bf16 v[76:79], v[52:55], a[188:191], v[76:79]
    ds_read_b64_tr_b16 v[46:47], v7 offset:27136
    s_waitcnt lgkmcnt(6)
    v_mfma_f32_16x16x32_bf16 v[80:83], v[32:35], a[160:163], v[80:83]
    ds_read_b128 a[196:199], v192 offset:34816
    v_mfma_f32_16x16x32_bf16 v[80:83], v[36:39], a[176:179], v[80:83]
    ds_read_b128 a[212:215], v194 offset:34816
    v_mfma_f32_16x16x32_bf16 v[84:87], v[32:35], a[164:167], v[84:87]
    ds_read_b64_tr_b16 v[48:49], v8 offset:18432
    v_mfma_f32_16x16x32_bf16 v[84:87], v[36:39], a[180:183], v[84:87]
    buffer_load_dwordx4 v3, s[44:47], s99 offen offset:2048 lds
    v_mfma_f32_16x16x32_bf16 v[88:91], v[32:35], a[168:171], v[88:91]
    ds_read_b64_tr_b16 v[50:51], v8 offset:18944
    v_mfma_f32_16x16x32_bf16 v[88:91], v[36:39], a[184:187], v[88:91]
    ds_read_b64_tr_b16 v[52:53], v8 offset:26624
    v_mfma_f32_16x16x32_bf16 v[92:95], v[32:35], a[172:175], v[92:95]
    buffer_load_dwordx4 v4, s[44:47], s99 offen offset:3072 lds
    v_mfma_f32_16x16x32_bf16 v[92:95], v[36:39], a[188:191], v[92:95]
    ds_read_b64_tr_b16 v[54:55], v8 offset:27136
    s_waitcnt vmcnt(12) lgkmcnt(6)
    s_barrier
    v_mfma_f32_16x16x32_bf16 v[96:99], v[40:43], a[160:163], v[96:99]
    ds_read_b128 a[200:203], v193 offset:32768
    v_and_b32 v23, 15, v0
    v_mfma_f32_16x16x32_bf16 v[96:99], v[44:47], a[176:179], v[96:99]
    ds_read_b128 a[216:219], v195 offset:32768
    v_lshlrev_b32 v23, 2, v23
    v_mfma_f32_16x16x32_bf16 v[100:103], v[40:43], a[164:167], v[100:103]
    ds_read_b64_tr_b16 v[32:33], v7 offset:32768
    v_mfma_f32_16x16x32_bf16 v[100:103], v[44:47], a[180:183], v[100:103]
    ds_read_b64_tr_b16 v[34:35], v7 offset:33280
    v_mfma_f32_16x16x32_bf16 v[104:107], v[40:43], a[168:171], v[104:107]
    ds_read_b64_tr_b16 v[36:37], v7 offset:40960
    v_mfma_f32_16x16x32_bf16 v[104:107], v[44:47], a[184:187], v[104:107]
    ds_read_b64_tr_b16 v[38:39], v7 offset:41472
    v_mfma_f32_16x16x32_bf16 v[108:111], v[40:43], a[172:175], v[108:111]
    ds_read_b64_tr_b16 v[56:57], v148 offset:0
    v_mfma_f32_16x16x32_bf16 v[108:111], v[44:47], a[188:191], v[108:111]
    s_waitcnt lgkmcnt(7)
    v_dot2_f32_bf16 v144, v128, v136, 0
    v_mfma_f32_16x16x32_bf16 v[112:115], v[48:51], a[160:163], v[112:115]
    ds_read_b128 a[204:207], v193 offset:34816
    v_mfma_f32_16x16x32_bf16 v[112:115], v[52:55], a[176:179], v[112:115]
    ds_read_b128 a[220:223], v195 offset:34816
    v_mfma_f32_16x16x32_bf16 v[116:119], v[48:51], a[164:167], v[116:119]
    ds_read_b64_tr_b16 v[40:41], v8 offset:32768
    v_mfma_f32_16x16x32_bf16 v[116:119], v[52:55], a[180:183], v[116:119]
    ds_read_b64_tr_b16 v[42:43], v8 offset:33280
    v_mfma_f32_16x16x32_bf16 v[120:123], v[48:51], a[168:171], v[120:123]
    ds_read_b64_tr_b16 v[44:45], v8 offset:40960
    v_mfma_f32_16x16x32_bf16 v[120:123], v[52:55], a[184:187], v[120:123]
    ds_read_b64_tr_b16 v[46:47], v8 offset:41472
    v_mfma_f32_16x16x32_bf16 v[124:127], v[48:51], a[172:175], v[124:127]
    ds_read_b64_tr_b16 v[58:59], v148 offset:128
    s_waitcnt lgkmcnt(7)
    v_xor_b32 v56, v150, v56
    v_mfma_f32_16x16x32_bf16 v[124:127], v[52:55], a[188:191], v[124:127]
    s_waitcnt lgkmcnt(5)
    v_dot2_f32_bf16 v144, v129, v137, v144
    v_mfma_f32_16x16x32_bf16 v[64:67], v[32:35], a[192:195], v[64:67]
    ds_read_b128 a[224:227], v192 offset:49152
    v_xor_b32 v57, v150, v57
    v_mfma_f32_16x16x32_bf16 v[64:67], v[36:39], a[208:211], v[64:67]
    ds_read_b128 a[240:243], v194 offset:49152
    v_mfma_f32_16x16x32_bf16 v[68:71], v[32:35], a[196:199], v[68:71]
    ds_read_b64_tr_b16 v[48:49], v7 offset:34816
    v_mfma_f32_16x16x32_bf16 v[68:71], v[36:39], a[212:215], v[68:71]
    ds_read_b64_tr_b16 v[50:51], v7 offset:35328
    v_mfma_f32_16x16x32_bf16 v[72:75], v[32:35], a[200:203], v[72:75]
    ds_read_b64_tr_b16 v[52:53], v7 offset:43008
    v_mfma_f32_16x16x32_bf16 v[72:75], v[36:39], a[216:219], v[72:75]
    ds_read_b64_tr_b16 v[54:55], v7 offset:43520
    v_mfma_f32_16x16x32_bf16 v[76:79], v[32:35], a[204:207], v[76:79]
    ds_read_b64_tr_b16 v[60:61], v149 offset:0
    s_waitcnt lgkmcnt(7)
    v_xor_b32 v58, v150, v58
    v_mfma_f32_16x16x32_bf16 v[76:79], v[36:39], a[220:223], v[76:79]
    v_dot2_f32_bf16 v144, v130, v138, v144
    v_mfma_f32_16x16x32_bf16 v[80:83], v[40:43], a[192:195], v[80:83]
    ds_read_b128 a[228:231], v192 offset:51200
    v_xor_b32 v59, v150, v59
    v_mfma_f32_16x16x32_bf16 v[80:83], v[44:47], a[208:211], v[80:83]
    ds_read_b128 a[244:247], v194 offset:51200
    v_mfma_f32_16x16x32_bf16 v[84:87], v[40:43], a[196:199], v[84:87]
    ds_read_b64_tr_b16 v[32:33], v8 offset:34816
    v_mfma_f32_16x16x32_bf16 v[84:87], v[44:47], a[212:215], v[84:87]
    ds_read_b64_tr_b16 v[34:35], v8 offset:35328
    v_mfma_f32_16x16x32_bf16 v[88:91], v[40:43], a[200:203], v[88:91]
    ds_read_b64_tr_b16 v[36:37], v8 offset:43008
    v_mfma_f32_16x16x32_bf16 v[88:91], v[44:47], a[216:219], v[88:91]
    ds_read_b64_tr_b16 v[38:39], v8 offset:43520
    v_mfma_f32_16x16x32_bf16 v[92:95], v[40:43], a[204:207], v[92:95]
    ds_read_b64_tr_b16 v[62:63], v149 offset:128
    s_waitcnt lgkmcnt(7)
    v_xor_b32 v60, v150, v60
    v_mfma_f32_16x16x32_bf16 v[92:95], v[44:47], a[220:223], v[92:95]
    s_waitcnt vmcnt(8)
    s_barrier
    v_xor_b32 v61, v150, v61
    v_mfma_f32_16x16x32_bf16 v[96:99], v[48:51], a[192:195], v[96:99]
    ds_read_b128 a[232:235], v193 offset:49152
    v_mfma_f32_16x16x32_bf16 v[96:99], v[52:55], a[208:211], v[96:99]
    ds_read_b128 a[248:251], v195 offset:49152
    v_mfma_f32_16x16x32_bf16 v[100:103], v[48:51], a[196:199], v[100:103]
    ds_read_b64_tr_b16 v[40:41], v9 offset:0
    v_mfma_f32_16x16x32_bf16 v[100:103], v[52:55], a[212:215], v[100:103]
    buffer_load_dword v21, v23, s[80:83], 0 offen offset:64 sc1
    s_add_u32 m0, s96, 0
    v_mfma_f32_16x16x32_bf16 v[104:107], v[48:51], a[200:203], v[104:107]
    ds_read_b64_tr_b16 v[42:43], v9 offset:512
    s_add_u32 s99, s5, 2
    v_mfma_f32_16x16x32_bf16 v[104:107], v[52:55], a[216:219], v[104:107]
    ds_read_b64_tr_b16 v[44:45], v9 offset:8192
    s_and_b32 s99, s99, 7
    v_mfma_f32_16x16x32_bf16 v[108:111], v[48:51], a[204:207], v[108:111]
    s_mul_i32 s99, s99, 229376
    buffer_load_dwordx4 v3, s[40:43], s99 offen offset:0 lds
    v_mfma_f32_16x16x32_bf16 v[108:111], v[52:55], a[220:223], v[108:111]
    ds_read_b64_tr_b16 v[46:47], v9 offset:8704
    s_waitcnt lgkmcnt(7)
    v_mfma_f32_16x16x32_bf16 v[112:115], v[32:35], a[192:195], v[112:115]
    ds_read_b128 a[236:239], v193 offset:51200
    s_waitcnt lgkmcnt(7)
    v_xor_b32 v62, v150, v62
    v_mfma_f32_16x16x32_bf16 v[112:115], v[36:39], a[208:211], v[112:115]
    ds_read_b128 a[252:255], v195 offset:51200
    v_xor_b32 v63, v150, v63
    v_mfma_f32_16x16x32_bf16 v[116:119], v[32:35], a[196:199], v[116:119]
    ds_read_b64_tr_b16 v[48:49], v10 offset:0
    v_mfma_f32_16x16x32_bf16 v[116:119], v[36:39], a[212:215], v[116:119]
    ds_read_b64_tr_b16 v[50:51], v10 offset:512
    v_mfma_f32_16x16x32_bf16 v[120:123], v[32:35], a[200:203], v[120:123]
    ds_read_b64_tr_b16 v[52:53], v10 offset:8192
    v_mfma_f32_16x16x32_bf16 v[120:123], v[36:39], a[216:219], v[120:123]
    ds_read_b64_tr_b16 v[54:55], v10 offset:8704
    v_mfma_f32_16x16x32_bf16 v[124:127], v[32:35], a[204:207], v[124:127]
    buffer_load_dwordx4 v4, s[40:43], s99 offen offset:1024 lds
    v_mfma_f32_16x16x32_bf16 v[124:127], v[36:39], a[220:223], v[124:127]
    s_waitcnt lgkmcnt(4)
    v_dot2_f32_bf16 v144, v131, v139, v144
    v_dot2_f32_bf16 v144, v132, v140, v144
    v_dot2_f32_bf16 v144, v133, v141, v144
    v_dot2_f32_bf16 v144, v134, v142, v144
    v_dot2_f32_bf16 v144, v135, v143, v144
    s_nop 2
    v_add_f32_dpp v144, v144, v144 row_ror:8 row_mask:0xf bank_mask:0xf
    s_nop 1
    v_add_f32_dpp v144, v144, v144 row_ror:4 row_mask:0xf bank_mask:0xf
    s_nop 1
    v_add_f32_dpp v144, v144, v144 row_ror:2 row_mask:0xf bank_mask:0xf
    s_nop 1
    v_add_f32_dpp v144, v144, v144 row_ror:1 row_mask:0xf bank_mask:0xf
    v_mov_b32 v145, v144
    s_nop 1
    v_permlane16_swap_b32 v144, v145
    v_add_f32 v144, v144, v145
    v_mul_f32 v144, s98, v144
    v_exp_f32 v144, v144
    s_nop 0
    v_add_f32 v144, 1.0, v144
    v_rcp_f32 v144, v144
    buffer_store_dword v144, v146, s[72:75], s24 offen sc1
    v_mfma_f32_16x16x32_bf16 v[64:67], v[40:43], a[224:227], v[64:67]
    ds_read_b64_tr_b16 v[32:33], v9 offset:2048
    v_mfma_f32_16x16x32_bf16 v[64:67], v[44:47], a[240:243], v[64:67]
    ds_read_b64_tr_b16 v[34:35], v9 offset:2560
    v_mfma_f32_16x16x32_bf16 v[68:71], v[40:43], a[228:231], v[68:71]
    ds_read_b64_tr_b16 v[36:37], v9 offset:10240
    v_mfma_f32_16x16x32_bf16 v[68:71], v[44:47], a[244:247], v[68:71]
    ds_read_b64_tr_b16 v[38:39], v9 offset:10752
    v_mfma_f32_16x16x32_bf16 v[72:75], v[40:43], a[232:235], v[72:75]
    v_mfma_f32_16x16x32_bf16 v[72:75], v[44:47], a[248:251], v[72:75]
    v_mfma_f32_16x16x32_bf16 v[76:79], v[40:43], a[236:239], v[76:79]
    buffer_load_dwordx4 v3, s[44:47], s99 offen offset:2048 lds
    v_mfma_f32_16x16x32_bf16 v[76:79], v[44:47], a[252:255], v[76:79]
    s_waitcnt lgkmcnt(4)
    v_mfma_f32_16x16x32_bf16 v[80:83], v[48:51], a[224:227], v[80:83]
    ds_read_b64_tr_b16 v[40:41], v10 offset:2048
    v_mfma_f32_16x16x32_bf16 v[80:83], v[52:55], a[240:243], v[80:83]
    ds_read_b64_tr_b16 v[42:43], v10 offset:2560
    v_mfma_f32_16x16x32_bf16 v[84:87], v[48:51], a[228:231], v[84:87]
    ds_read_b64_tr_b16 v[44:45], v10 offset:10240
    v_mfma_f32_16x16x32_bf16 v[84:87], v[52:55], a[244:247], v[84:87]
    ds_read_b64_tr_b16 v[46:47], v10 offset:10752
    v_mfma_f32_16x16x32_bf16 v[88:91], v[48:51], a[232:235], v[88:91]
    v_mfma_f32_16x16x32_bf16 v[88:91], v[52:55], a[248:251], v[88:91]
    v_mfma_f32_16x16x32_bf16 v[92:95], v[48:51], a[236:239], v[92:95]
    buffer_load_dwordx4 v4, s[44:47], s99 offen offset:3072 lds
    v_mfma_f32_16x16x32_bf16 v[92:95], v[52:55], a[252:255], v[92:95]
    s_waitcnt vmcnt(10) lgkmcnt(4)
    s_barrier
    v_mfma_f32_16x16x32_bf16 v[96:99], v[32:35], a[224:227], v[96:99]
    ds_read_b64_tr_b16 v[48:49], v7 offset:49152
    s_add_u32 m0, s96, 16384
    v_mfma_f32_16x16x32_bf16 v[96:99], v[36:39], a[240:243], v[96:99]
    ds_read_b64_tr_b16 v[50:51], v7 offset:49664
    s_add_u32 s99, s5, 3
    v_mfma_f32_16x16x32_bf16 v[100:103], v[32:35], a[228:231], v[100:103]
    s_and_b32 s99, s99, 7
    s_mul_i32 s99, s99, 229376
    buffer_load_dwordx4 v3, s[40:43], s99 offen offset:0 lds
    v_mfma_f32_16x16x32_bf16 v[100:103], v[36:39], a[244:247], v[100:103]
    ds_read_b64_tr_b16 v[52:53], v7 offset:57344
    v_mfma_f32_16x16x32_bf16 v[104:107], v[32:35], a[232:235], v[104:107]
    buffer_load_dwordx4 v4, s[40:43], s99 offen offset:1024 lds
    v_mfma_f32_16x16x32_bf16 v[104:107], v[36:39], a[248:251], v[104:107]
    ds_read_b64_tr_b16 v[54:55], v7 offset:57856
    v_mfma_f32_16x16x32_bf16 v[108:111], v[32:35], a[236:239], v[108:111]
    buffer_load_dwordx4 v3, s[44:47], s99 offen offset:2048 lds
    v_mfma_f32_16x16x32_bf16 v[108:111], v[36:39], a[252:255], v[108:111]
    s_waitcnt lgkmcnt(4)
    v_mfma_f32_16x16x32_bf16 v[112:115], v[40:43], a[224:227], v[112:115]
    ds_read_b64_tr_b16 v[32:33], v8 offset:49152
    v_mfma_f32_16x16x32_bf16 v[112:115], v[44:47], a[240:243], v[112:115]
    ds_read_b64_tr_b16 v[34:35], v8 offset:49664
    v_mfma_f32_16x16x32_bf16 v[116:119], v[40:43], a[228:231], v[116:119]
    buffer_load_dwordx4 v4, s[44:47], s99 offen offset:3072 lds
    s_add_u32 m0, s96, 32768
    v_mfma_f32_16x16x32_bf16 v[116:119], v[44:47], a[244:247], v[116:119]
    ds_read_b64_tr_b16 v[36:37], v8 offset:57344
    s_add_u32 s99, s5, 4
    v_mfma_f32_16x16x32_bf16 v[120:123], v[40:43], a[232:235], v[120:123]
    s_and_b32 s99, s99, 7
    s_mul_i32 s99, s99, 229376
    buffer_load_dwordx4 v3, s[40:43], s99 offen offset:0 lds
    v_mfma_f32_16x16x32_bf16 v[120:123], v[44:47], a[248:251], v[120:123]
    ds_read_b64_tr_b16 v[38:39], v8 offset:57856
    v_mfma_f32_16x16x32_bf16 v[124:127], v[40:43], a[236:239], v[124:127]
    buffer_load_dwordx4 v4, s[40:43], s99 offen offset:1024 lds
    v_mfma_f32_16x16x32_bf16 v[124:127], v[44:47], a[252:255], v[124:127]
    s_waitcnt lgkmcnt(4)
    v_mfma_f32_16x16x32_bf16 v[128:131], v[48:51], a[0:3], 0
    ds_read_b64_tr_b16 v[40:41], v7 offset:51200
    v_mul_f32 v64, s98, v64
    v_mul_f32 v65, s98, v65
    v_mfma_f32_16x16x32_bf16 v[128:131], v[52:55], a[16:19], v[128:131]
    ds_read_b64_tr_b16 v[42:43], v7 offset:51712
    v_exp_f32 v64, v64
    v_mfma_f32_16x16x32_bf16 v[132:135], v[48:51], a[4:7], 0
    buffer_load_dwordx4 v3, s[44:47], s99 offen offset:2048 lds
    v_exp_f32 v65, v65
    v_mfma_f32_16x16x32_bf16 v[132:135], v[52:55], a[20:23], v[132:135]
    ds_read_b64_tr_b16 v[44:45], v7 offset:59392
    v_mul_f32 v66, s98, v66
    v_mul_f32 v67, s98, v67
    v_mfma_f32_16x16x32_bf16 v[136:139], v[48:51], a[8:11], 0
    buffer_load_dwordx4 v4, s[44:47], s99 offen offset:3072 lds
    s_add_u32 m0, s96, 98304
    v_mul_f32 v80, s98, v80
    v_mfma_f32_16x16x32_bf16 v[136:139], v[52:55], a[24:27], v[136:139]
    ds_read_b64_tr_b16 v[46:47], v7 offset:59904
    s_add_u32 s99, s5, 5
    v_mul_f32 v81, s98, v81
    v_mfma_f32_16x16x32_bf16 v[140:143], v[48:51], a[12:15], 0
    s_and_b32 s99, s99, 7
    s_mul_i32 s99, s99, 229376
    buffer_load_dwordx4 v3, s[40:43], s99 offen offset:0 lds
    v_mfma_f32_16x16x32_bf16 v[140:143], v[52:55], a[28:31], v[140:143]
    s_waitcnt lgkmcnt(4)
    v_exp_f32 v66, v66
    v_mul_f32 v82, s98, v82
    v_mfma_f32_16x16x32_bf16 v[144:147], v[32:35], a[0:3], 0
    ds_read_b64_tr_b16 v[48:49], v8 offset:51200
    v_exp_f32 v67, v67
    v_mfma_f32_16x16x32_bf16 v[144:147], v[36:39], a[16:19], v[144:147]
    ds_read_b64_tr_b16 v[50:51], v8 offset:51712
    v_exp_f32 v80, v80
    v_mfma_f32_16x16x32_bf16 v[148:151], v[32:35], a[4:7], 0
    buffer_load_dwordx4 v4, s[40:43], s99 offen offset:1024 lds
    v_exp_f32 v81, v81
    v_mfma_f32_16x16x32_bf16 v[148:151], v[36:39], a[20:23], v[148:151]
    ds_read_b64_tr_b16 v[52:53], v8 offset:59392
    v_exp_f32 v82, v82
    v_mfma_f32_16x16x32_bf16 v[152:155], v[32:35], a[8:11], 0
    buffer_load_dwordx4 v3, s[44:47], s99 offen offset:2048 lds
    v_mul_f32 v83, s98, v83
    v_add_f32 v64, 1.0, v64
    v_mfma_f32_16x16x32_bf16 v[152:155], v[36:39], a[24:27], v[152:155]
    ds_read_b64_tr_b16 v[54:55], v8 offset:59904
    v_exp_f32 v83, v83
    v_mfma_f32_16x16x32_bf16 v[156:159], v[32:35], a[12:15], 0
    buffer_load_dwordx4 v4, s[44:47], s99 offen offset:3072 lds
    v_rcp_f32 v64, v64
    v_mfma_f32_16x16x32_bf16 v[156:159], v[36:39], a[28:31], v[156:159]
    s_waitcnt vmcnt(18) lgkmcnt(4)
    s_barrier
    v_add_f32 v65, 1.0, v65
    v_add_f32 v66, 1.0, v66
    v_mfma_f32_16x16x32_bf16 v[160:163], v[40:43], a[0:3], 0
    ds_read_b64_tr_b16 v[32:33], v9 offset:16384
    s_add_u32 m0, s96, 65536
    v_add_f32 v67, 1.0, v67
    v_mfma_f32_16x16x32_bf16 v[160:163], v[44:47], a[16:19], v[160:163]
    ds_read_b64_tr_b16 v[34:35], v9 offset:16896
    s_add_u32 s99, s5, 6
    v_add_f32 v80, 1.0, v80
    v_mfma_f32_16x16x32_bf16 v[164:167], v[40:43], a[4:7], 0
    ds_read_b64_tr_b16 v[36:37], v9 offset:24576
    s_and_b32 s99, s99, 7
    v_add_f32 v81, 1.0, v81
    v_mfma_f32_16x16x32_bf16 v[164:167], v[44:47], a[20:23], v[164:167]
    ds_read_b64_tr_b16 v[38:39], v9 offset:25088
    s_mul_i32 s99, s99, 229376
    v_add_f32 v82, 1.0, v82
    v_mfma_f32_16x16x32_bf16 v[168:171], v[40:43], a[8:11], 0
    s_lshl_b32 s13, s92, 1
    v_rcp_f32 v65, v65
    v_add_f32 v83, 1.0, v83
    v_mfma_f32_16x16x32_bf16 v[168:171], v[44:47], a[24:27], v[168:171]
    s_add_u32 s13, s13, s90
    v_rcp_f32 v66, v66
    v_mul_f32 v96, v96, v64
    v_mfma_f32_16x16x32_bf16 v[172:175], v[40:43], a[12:15], 0
    buffer_load_dwordx4 v3, s[40:43], s99 offen offset:0 lds
    v_rcp_f32 v67, v67
    v_mfma_f32_16x16x32_bf16 v[172:175], v[44:47], a[28:31], v[172:175]
    s_waitcnt lgkmcnt(4)
    v_rcp_f32 v80, v80
    v_mul_f32 v97, v97, v65
    v_mfma_f32_16x16x32_bf16 v[176:179], v[48:51], a[0:3], 0
    ds_read_b64_tr_b16 v[40:41], v10 offset:16384
    v_rcp_f32 v81, v81
    v_mfma_f32_16x16x32_bf16 v[176:179], v[52:55], a[16:19], v[176:179]
    ds_read_b64_tr_b16 v[42:43], v10 offset:16896
    v_rcp_f32 v82, v82
    v_mfma_f32_16x16x32_bf16 v[180:183], v[48:51], a[4:7], 0
    ds_read_b64_tr_b16 v[44:45], v10 offset:24576
    v_rcp_f32 v83, v83
    v_mfma_f32_16x16x32_bf16 v[180:183], v[52:55], a[20:23], v[180:183]
    ds_read_b64_tr_b16 v[46:47], v10 offset:25088
    v_mul_f32 v98, v98, v66
    v_mul_f32 v99, v99, v67
    v_mfma_f32_16x16x32_bf16 v[184:187], v[48:51], a[8:11], 0
    s_mul_i32 s13, s13, 2176
    v_mul_f32 v112, v112, v80
    v_mul_f32 v113, v113, v81
    v_mul_f32 v114, v114, v82
    v_mfma_f32_16x16x32_bf16 v[184:187], v[52:55], a[24:27], v[184:187]
    s_add_u32 s13, s13, 13631488
    v_mul_f32 v115, v115, v83
    v_cvt_pk_bf16_f32 v64, v96, v97
    v_cvt_pk_bf16_f32 v65, v98, v99
    v_mfma_f32_16x16x32_bf16 v[188:191], v[48:51], a[12:15], 0
    buffer_load_dwordx4 v4, s[40:43], s99 offen offset:1024 lds
    v_cvt_pk_bf16_f32 v66, v112, v113
    v_cvt_pk_bf16_f32 v67, v114, v115
    v_mfma_f32_16x16x32_bf16 v[188:191], v[52:55], a[28:31], v[188:191]
    s_waitcnt lgkmcnt(4)
    v_mul_f32 v68, s98, v68
    v_exp_f32 v68, v68
    v_mfma_f32_16x16x32_bf16 v[128:131], v[32:35], a[32:35], v[128:131]
    ds_read_b64_tr_b16 v[48:49], v9 offset:18432
    v_mul_f32 v69, s98, v69
    v_mul_f32 v70, s98, v70
    v_mfma_f32_16x16x32_bf16 v[128:131], v[36:39], a[48:51], v[128:131]
    ds_read_b64_tr_b16 v[50:51], v9 offset:18944
    v_exp_f32 v69, v69
    v_mfma_f32_16x16x32_bf16 v[132:135], v[32:35], a[36:39], v[132:135]
    ds_read_b64_tr_b16 v[52:53], v9 offset:26624
    v_exp_f32 v70, v70
    v_mfma_f32_16x16x32_bf16 v[132:135], v[36:39], a[52:55], v[132:135]
    ds_read_b64_tr_b16 v[54:55], v9 offset:27136
    v_mul_f32 v71, s98, v71
    v_mul_f32 v84, s98, v84
    v_mfma_f32_16x16x32_bf16 v[136:139], v[32:35], a[40:43], v[136:139]
    buffer_store_dwordx4 v[64:67], v11, s[72:75], s22 offen offset:0 sc1
    v_exp_f32 v71, v71
    v_mfma_f32_16x16x32_bf16 v[136:139], v[36:39], a[56:59], v[136:139]
    s_lshl_b32 s24, s91, 1
    v_exp_f32 v84, v84
    v_mul_f32 v85, s98, v85
    v_mfma_f32_16x16x32_bf16 v[140:143], v[32:35], a[44:47], v[140:143]
    buffer_load_dwordx4 v3, s[44:47], s99 offen offset:2048 lds
    v_exp_f32 v85, v85
    v_mfma_f32_16x16x32_bf16 v[140:143], v[36:39], a[60:63], v[140:143]
    s_waitcnt lgkmcnt(4)
    v_mul_f32 v86, s98, v86
    v_exp_f32 v86, v86
    v_mfma_f32_16x16x32_bf16 v[144:147], v[40:43], a[32:35], v[144:147]
    ds_read_b64_tr_b16 v[32:33], v10 offset:18432
    v_mul_f32 v87, s98, v87
    v_add_f32 v68, 1.0, v68
    v_mfma_f32_16x16x32_bf16 v[144:147], v[44:47], a[48:51], v[144:147]
    ds_read_b64_tr_b16 v[34:35], v10 offset:18944
    v_exp_f32 v87, v87
    v_mfma_f32_16x16x32_bf16 v[148:151], v[40:43], a[36:39], v[148:151]
    ds_read_b64_tr_b16 v[36:37], v10 offset:26624
    v_rcp_f32 v68, v68
    v_mfma_f32_16x16x32_bf16 v[148:151], v[44:47], a[52:55], v[148:151]
    ds_read_b64_tr_b16 v[38:39], v10 offset:27136
    v_add_f32 v69, 1.0, v69
    v_add_f32 v70, 1.0, v70
    v_mfma_f32_16x16x32_bf16 v[152:155], v[40:43], a[40:43], v[152:155]
    s_add_u32 s24, s24, s89
    v_rcp_f32 v69, v69
    v_add_f32 v71, 1.0, v71
    v_mfma_f32_16x16x32_bf16 v[152:155], v[44:47], a[56:59], v[152:155]
    s_lshl_b32 s24, s24, 8
    v_rcp_f32 v70, v70
    v_add_f32 v84, 1.0, v84
    v_mfma_f32_16x16x32_bf16 v[156:159], v[40:43], a[44:47], v[156:159]
    buffer_load_dwordx4 v4, s[44:47], s99 offen offset:3072 lds
    v_rcp_f32 v71, v71
    v_mfma_f32_16x16x32_bf16 v[156:159], v[44:47], a[60:63], v[156:159]
    s_waitcnt vmcnt(17) lgkmcnt(4)
    s_barrier
    v_rcp_f32 v84, v84
    v_cmp_gt_u32 vcc, 1, v21
    s_nop 0
    s_cbranch_vccnz L_slowB0
L_okB0:
    v_mfma_f32_16x16x32_bf16 v[160:163], v[48:51], a[32:35], v[160:163]
    ds_read_b64_tr_b16 v[40:41], v7 offset:0
    s_add_u32 m0, s96, 49152
    v_add_f32 v85, 1.0, v85
    v_mfma_f32_16x16x32_bf16 v[160:163], v[52:55], a[48:51], v[160:163]
    ds_read_b64_tr_b16 v[42:43], v7 offset:512
    s_add_u32 s99, s5, 7
    v_add_f32 v86, 1.0, v86
    v_mfma_f32_16x16x32_bf16 v[164:167], v[48:51], a[36:39], v[164:167]
    s_and_b32 s99, s99, 7
    s_mul_i32 s99, s99, 229376
    buffer_load_dwordx4 v3, s[40:43], s99 offen offset:0 lds
    v_mfma_f32_16x16x32_bf16 v[164:167], v[52:55], a[52:55], v[164:167]
    ds_read_b64_tr_b16 v[44:45], v7 offset:8192
    v_rcp_f32 v85, v85
    v_mfma_f32_16x16x32_bf16 v[168:171], v[48:51], a[40:43], v[168:171]
    buffer_load_dwordx4 v4, s[40:43], s99 offen offset:1024 lds
    v_rcp_f32 v86, v86
    v_mfma_f32_16x16x32_bf16 v[168:171], v[52:55], a[56:59], v[168:171]
    ds_read_b64_tr_b16 v[46:47], v7 offset:8704
    v_add_f32 v87, 1.0, v87
    v_mul_f32 v100, v100, v68
    v_mfma_f32_16x16x32_bf16 v[172:175], v[48:51], a[44:47], v[172:175]
    buffer_load_dwordx4 v3, s[44:47], s99 offen offset:2048 lds
    v_rcp_f32 v87, v87
    v_mfma_f32_16x16x32_bf16 v[172:175], v[52:55], a[60:63], v[172:175]
    s_waitcnt lgkmcnt(4)
    v_mul_f32 v101, v101, v69
    v_mul_f32 v102, v102, v70
    v_mul_f32 v103, v103, v71
    v_mfma_f32_16x16x32_bf16 v[176:179], v[32:35], a[32:35], v[176:179]
    ds_read_b64_tr_b16 v[48:49], v8 offset:0
    v_mul_f32 v116, v116, v84
    v_mul_f32 v117, v117, v85
    v_mfma_f32_16x16x32_bf16 v[176:179], v[36:39], a[48:51], v[176:179]
    ds_read_b64_tr_b16 v[50:51], v8 offset:512
    v_mul_f32 v118, v118, v86
    v_mul_f32 v119, v119, v87
    v_mfma_f32_16x16x32_bf16 v[180:183], v[32:35], a[36:39], v[180:183]
    buffer_load_dwordx4 v4, s[44:47], s99 offen offset:3072 lds
    s_add_u32 m0, s96, 114688
    v_cvt_pk_bf16_f32 v68, v100, v101
    v_mfma_f32_16x16x32_bf16 v[180:183], v[36:39], a[52:55], v[180:183]
    ds_read_b64_tr_b16 v[52:53], v8 offset:8192
    s_add_u32 s99, s5, 0
    v_cvt_pk_bf16_f32 v69, v102, v103
    v_mfma_f32_16x16x32_bf16 v[184:187], v[32:35], a[40:43], v[184:187]
    s_and_b32 s99, s99, 7
    s_mul_i32 s99, s99, 196608
    buffer_load_dwordx4 v1, s[48:51], s99 offen offset:0 lds
    v_mfma_f32_16x16x32_bf16 v[184:187], v[36:39], a[56:59], v[184:187]
    ds_read_b64_tr_b16 v[54:55], v8 offset:8704
    v_cvt_pk_bf16_f32 v70, v116, v117
    v_cvt_pk_bf16_f32 v71, v118, v119
    v_mfma_f32_16x16x32_bf16 v[188:191], v[32:35], a[44:47], v[188:191]
    buffer_load_dwordx4 v2, s[48:51], s99 offen offset:1024 lds
    v_mul_f32 v72, s98, v72
    v_mul_f32 v73, s98, v73
    v_mfma_f32_16x16x32_bf16 v[188:191], v[36:39], a[60:63], v[188:191]
    s_waitcnt lgkmcnt(4)
    v_exp_f32 v72, v72
    v_mul_f32 v74, s98, v74
    v_mfma_f32_16x16x32_bf16 v[128:131], v[40:43], a[64:67], v[128:131]
    ds_read_b64_tr_b16 v[32:33], v7 offset:2048
    v_exp_f32 v73, v73
    v_mfma_f32_16x16x32_bf16 v[128:131], v[44:47], a[80:83], v[128:131]
    ds_read_b64_tr_b16 v[34:35], v7 offset:2560
    v_exp_f32 v74, v74
    v_mfma_f32_16x16x32_bf16 v[132:135], v[40:43], a[68:71], v[132:135]
    buffer_load_dwordx4 v1, s[52:55], s99 offen offset:2048 lds
    v_mul_f32 v75, s98, v75
    v_mfma_f32_16x16x32_bf16 v[132:135], v[44:47], a[84:87], v[132:135]
    ds_read_b64_tr_b16 v[36:37], v7 offset:10240
    v_mul_f32 v88, s98, v88
    v_mfma_f32_16x16x32_bf16 v[136:139], v[40:43], a[72:75], v[136:139]
    buffer_load_dwordx4 v2, s[52:55], s99 offen offset:3072 lds
    v_mul_f32 v89, s98, v89
    v_mfma_f32_16x16x32_bf16 v[136:139], v[44:47], a[88:91], v[136:139]
    ds_read_b64_tr_b16 v[38:39], v7 offset:10752
    v_exp_f32 v75, v75
    v_mfma_f32_16x16x32_bf16 v[140:143], v[40:43], a[76:79], v[140:143]
    s_lshr_b32 s100, s56, 7
    s_sub_u32 s100, 3, s100
    s_add_u32 s100, s100, s95
    s_and_b32 s100, s100, 7
    s_sub_u32 s100, s100, s95
    s_lshl_b32 s100, s100, 7
    s_lshr_b32 s99, s2, 3
    s_sub_u32 s99, s99, s94
    s_mul_i32 s99, s99, 28672
    s_add_u32 s100, s100, s99
    v_add_u32 v27, s100, v19
    s_mov_b32 s99, 0
    buffer_load_dword v18, v27, s[56:59], s99 offen offset:0
    v_mfma_f32_16x16x32_bf16 v[140:143], v[44:47], a[92:95], v[140:143]
    s_waitcnt lgkmcnt(4)
    v_exp_f32 v88, v88
    v_mul_f32 v90, s98, v90
    v_mfma_f32_16x16x32_bf16 v[144:147], v[48:51], a[64:67], v[144:147]
    ds_read_b64_tr_b16 v[40:41], v8 offset:2048
    v_mul_f32 v91, s98, v91
    v_mfma_f32_16x16x32_bf16 v[144:147], v[52:55], a[80:83], v[144:147]
    ds_read_b64_tr_b16 v[42:43], v8 offset:2560
    v_add_f32 v72, 1.0, v72
    v_mfma_f32_16x16x32_bf16 v[148:151], v[48:51], a[68:71], v[148:151]
    s_lshr_b32 s100, s56, 7
    s_sub_u32 s100, 3, s100
    s_add_u32 s100, s100, s95
    s_and_b32 s100, s100, 7
    s_sub_u32 s100, s100, s95
    s_lshl_b32 s100, s100, 7
    s_lshr_b32 s99, s2, 3
    s_sub_u32 s99, s99, s94
    s_mul_i32 s99, s99, 28672
    s_add_u32 s100, s100, s99
    v_add_u32 v27, s100, v19
    s_mov_b32 s99, 917504
    buffer_load_dword v18, v27, s[56:59], s99 offen offset:0
    v_mfma_f32_16x16x32_bf16 v[148:151], v[52:55], a[84:87], v[148:151]
    ds_read_b64_tr_b16 v[44:45], v8 offset:10240
    v_exp_f32 v89, v89
    v_mfma_f32_16x16x32_bf16 v[152:155], v[48:51], a[72:75], v[152:155]
    s_lshr_b32 s100, s64, 7
    s_sub_u32 s100, 3, s100
    s_add_u32 s100, s100, s95
    s_and_b32 s100, s100, 7
    s_sub_u32 s100, s100, s95
    s_lshl_b32 s100, s100, 7
    s_lshr_b32 s99, s2, 3
    s_sub_u32 s99, s99, s94
    s_mul_i32 s99, s99, 28672
    s_add_u32 s100, s100, s99
    v_add_u32 v27, s100, v19
    s_mov_b32 s99, 0
    buffer_load_dword v18, v27, s[64:67], s99 offen offset:0
    v_mfma_f32_16x16x32_bf16 v[152:155], v[52:55], a[88:91], v[152:155]
    ds_read_b64_tr_b16 v[46:47], v8 offset:10752
    v_exp_f32 v90, v90
    v_mfma_f32_16x16x32_bf16 v[156:159], v[48:51], a[76:79], v[156:159]
    v_mov_b32 v27, 1
    buffer_store_dword v27, off, s[72:75], s14 sc1
    v_mfma_f32_16x16x32_bf16 v[156:159], v[52:55], a[92:95], v[156:159]
    s_waitcnt vmcnt(25) lgkmcnt(4)
    s_barrier
    v_exp_f32 v91, v91
    v_mfma_f32_16x16x32_bf16 v[160:163], v[32:35], a[64:67], v[160:163]
    ds_read_b64_tr_b16 v[48:49], v7 offset:16384
    v_rcp_f32 v72, v72
    v_mfma_f32_16x16x32_bf16 v[160:163], v[36:39], a[80:83], v[160:163]
    ds_read_b64_tr_b16 v[50:51], v7 offset:16896
    v_add_f32 v73, 1.0, v73
    v_add_f32 v74, 1.0, v74
    v_mfma_f32_16x16x32_bf16 v[164:167], v[32:35], a[68:71], v[164:167]
    ds_read_b64_tr_b16 v[52:53], v7 offset:24576
    v_add_f32 v75, 1.0, v75
    v_mfma_f32_16x16x32_bf16 v[164:167], v[36:39], a[84:87], v[164:167]
    buffer_store_dwordx4 v[216:219], v11, s[72:75], s23 offen offset:0 sc1
    v_add_f32 v88, 1.0, v88
    v_mfma_f32_16x16x32_bf16 v[168:171], v[32:35], a[72:75], v[168:171]
    ds_read_b64_tr_b16 v[54:55], v7 offset:25088
    v_add_f32 v89, 1.0, v89
    v_mfma_f32_16x16x32_bf16 v[168:171], v[36:39], a[88:91], v[168:171]
    buffer_store_dwordx4 v[68:71], v11, s[72:75], s22 offen offset:1024 sc1
    v_rcp_f32 v73, v73
    v_mfma_f32_16x16x32_bf16 v[172:175], v[32:35], a[76:79], v[172:175]
    buffer_store_dwordx4 v[216:219], v11, s[72:75], s23 offen offset:1024 sc1
    s_mov_b32 s99, 0
    v_mfma_f32_16x16x32_bf16 v[172:175], v[36:39], a[92:95], v[172:175]
    s_waitcnt lgkmcnt(4)
    v_rcp_f32 v74, v74
    v_mfma_f32_16x16x32_bf16 v[176:179], v[40:43], a[64:67], v[176:179]
    ds_read_b64_tr_b16 v[32:33], v8 offset:16384
    v_add_f32 v90, 1.0, v90
    v_mfma_f32_16x16x32_bf16 v[176:179], v[44:47], a[80:83], v[176:179]
    ds_read_b64_tr_b16 v[34:35], v8 offset:16896
    v_add_f32 v91, 1.0, v91
    v_mfma_f32_16x16x32_bf16 v[180:183], v[40:43], a[68:71], v[180:183]
    ds_read_b64_tr_b16 v[36:37], v8 offset:24576
    v_mul_f32 v104, v104, v72
    v_mfma_f32_16x16x32_bf16 v[180:183], v[44:47], a[84:87], v[180:183]
    ds_read_b64_tr_b16 v[38:39], v8 offset:25088
    v_mul_f32 v105, v105, v73
    v_mfma_f32_16x16x32_bf16 v[184:187], v[40:43], a[72:75], v[184:187]
    s_add_u32 s24, s24, 10485760
    v_rcp_f32 v75, v75
    v_mfma_f32_16x16x32_bf16 v[184:187], v[44:47], a[88:91], v[184:187]
    v_rcp_f32 v88, v88
    v_mfma_f32_16x16x32_bf16 v[188:191], v[40:43], a[76:79], v[188:191]
    buffer_load_dword v18, v19, s[56:59], s99 offen offset:0
    s_mov_b32 s99, 917504
    v_mfma_f32_16x16x32_bf16 v[188:191], v[44:47], a[92:95], v[188:191]
    s_waitcnt lgkmcnt(4)
    v_rcp_f32 v89, v89
    v_mfma_f32_16x16x32_bf16 v[128:131], v[48:51], a[96:99], v[128:131]
    ds_read_b64_tr_b16 v[40:41], v7 offset:18432
    v_mul_f32 v106, v106, v74
    v_mfma_f32_16x16x32_bf16 v[128:131], v[52:55], a[112:115], v[128:131]
    ds_read_b64_tr_b16 v[42:43], v7 offset:18944
    v_mul_f32 v107, v107, v75
    v_mfma_f32_16x16x32_bf16 v[132:135], v[48:51], a[100:103], v[132:135]
    ds_read_b64_tr_b16 v[44:45], v7 offset:26624
    v_mul_f32 v120, v120, v88
    v_mfma_f32_16x16x32_bf16 v[132:135], v[52:55], a[116:119], v[132:135]
    ds_read_b64_tr_b16 v[46:47], v7 offset:27136
    v_mul_f32 v121, v121, v89
    v_mfma_f32_16x16x32_bf16 v[136:139], v[48:51], a[104:107], v[136:139]
    v_rcp_f32 v90, v90
    v_mfma_f32_16x16x32_bf16 v[136:139], v[52:55], a[120:123], v[136:139]
    v_rcp_f32 v91, v91
    v_mfma_f32_16x16x32_bf16 v[140:143], v[48:51], a[108:111], v[140:143]
    buffer_load_dword v18, v19, s[56:59], s99 offen offset:0
    s_mov_b32 s99, 0
    v_mfma_f32_16x16x32_bf16 v[140:143], v[52:55], a[124:127], v[140:143]
    s_waitcnt lgkmcnt(4)
    v_mul_f32 v122, v122, v90
    v_mul_f32 v123, v123, v91
    v_mfma_f32_16x16x32_bf16 v[144:147], v[32:35], a[96:99], v[144:147]
    ds_read_b64_tr_b16 v[48:49], v8 offset:18432
    v_cvt_pk_bf16_f32 v72, v104, v105
    v_mfma_f32_16x16x32_bf16 v[144:147], v[36:39], a[112:115], v[144:147]
    ds_read_b64_tr_b16 v[50:51], v8 offset:18944
    v_cvt_pk_bf16_f32 v73, v106, v107
    v_mfma_f32_16x16x32_bf16 v[148:151], v[32:35], a[100:103], v[148:151]
    ds_read_b64_tr_b16 v[52:53], v8 offset:26624
    v_cvt_pk_bf16_f32 v74, v120, v121
    v_mfma_f32_16x16x32_bf16 v[148:151], v[36:39], a[116:119], v[148:151]
    ds_read_b64_tr_b16 v[54:55], v8 offset:27136
    v_cvt_pk_bf16_f32 v75, v122, v123
    v_mfma_f32_16x16x32_bf16 v[152:155], v[32:35], a[104:107], v[152:155]
    buffer_store_dwordx4 v[72:75], v11, s[72:75], s22 offen offset:2048 sc1
    v_mul_f32 v76, s98, v76
    v_mfma_f32_16x16x32_bf16 v[152:155], v[36:39], a[120:123], v[152:155]
    v_exp_f32 v76, v76
    v_mfma_f32_16x16x32_bf16 v[156:159], v[32:35], a[108:111], v[156:159]
    buffer_load_dword v18, v19, s[64:67], s99 offen offset:0
    v_mul_f32 v77, s98, v77
    v_mfma_f32_16x16x32_bf16 v[156:159], v[36:39], a[124:127], v[156:159]
    s_waitcnt vmcnt(28) lgkmcnt(4)
    s_barrier
    v_mul_f32 v78, s98, v78
    v_mfma_f32_16x16x32_bf16 v[160:163], v[40:43], a[96:99], v[160:163]
    ds_read_b64_tr_b16 v[32:33], v7 offset:32768
    s_add_u32 m0, s96, 0
    v_mfma_f32_16x16x32_bf16 v[160:163], v[44:47], a[112:115], v[160:163]
    ds_read_b64_tr_b16 v[34:35], v7 offset:33280
    s_add_u32 s99, s5, 2
    v_mfma_f32_16x16x32_bf16 v[164:167], v[40:43], a[100:103], v[164:167]
    ds_read_b64_tr_b16 v[36:37], v7 offset:40960
    s_and_b32 s99, s99, 7
    v_mfma_f32_16x16x32_bf16 v[164:167], v[44:47], a[116:119], v[164:167]
    s_mul_i32 s99, s99, 196608
    buffer_load_dwordx4 v1, s[48:51], s99 offen offset:0 lds
    v_mfma_f32_16x16x32_bf16 v[168:171], v[40:43], a[104:107], v[168:171]
    ds_read_b64_tr_b16 v[38:39], v7 offset:41472
    v_exp_f32 v77, v77
    v_mfma_f32_16x16x32_bf16 v[168:171], v[44:47], a[120:123], v[168:171]
    v_exp_f32 v78, v78
    v_mul_f32 v79, s98, v79
    v_mfma_f32_16x16x32_bf16 v[172:175], v[40:43], a[108:111], v[172:175]
    buffer_load_dwordx4 v2, s[48:51], s99 offen offset:1024 lds
    v_mul_f32 v92, s98, v92
    v_mfma_f32_16x16x32_bf16 v[172:175], v[44:47], a[124:127], v[172:175]
    s_waitcnt lgkmcnt(4)
    v_exp_f32 v79, v79
    v_mfma_f32_16x16x32_bf16 v[176:179], v[48:51], a[96:99], v[176:179]
    ds_read_b64_tr_b16 v[40:41], v8 offset:32768
    v_mul_f32 v93, s98, v93
    v_mfma_f32_16x16x32_bf16 v[176:179], v[52:55], a[112:115], v[176:179]
    ds_read_b64_tr_b16 v[42:43], v8 offset:33280
    v_mul_f32 v94, s98, v94
    v_mfma_f32_16x16x32_bf16 v[180:183], v[48:51], a[100:103], v[180:183]
    ds_read_b64_tr_b16 v[44:45], v8 offset:40960
    v_mul_f32 v95, s98, v95
    v_mfma_f32_16x16x32_bf16 v[180:183], v[52:55], a[116:119], v[180:183]
    ds_read_b64_tr_b16 v[46:47], v8 offset:41472
    v_add_f32 v76, 1.0, v76
    v_mfma_f32_16x16x32_bf16 v[184:187], v[48:51], a[104:107], v[184:187]
    v_exp_f32 v92, v92
    v_mfma_f32_16x16x32_bf16 v[184:187], v[52:55], a[120:123], v[184:187]
    v_exp_f32 v93, v93
    v_mfma_f32_16x16x32_bf16 v[188:191], v[48:51], a[108:111], v[188:191]
    buffer_load_dwordx4 v1, s[52:55], s99 offen offset:2048 lds
    v_add_f32 v77, 1.0, v77
    v_mfma_f32_16x16x32_bf16 v[188:191], v[52:55], a[124:127], v[188:191]
    s_waitcnt lgkmcnt(4)
    v_exp_f32 v94, v94
    v_mfma_f32_16x16x32_bf16 v[128:131], v[32:35], a[128:131], v[128:131]
    ds_read_b64_tr_b16 v[48:49], v7 offset:34816
    v_add_f32 v78, 1.0, v78
    v_mfma_f32_16x16x32_bf16 v[128:131], v[36:39], a[144:147], v[128:131]
    ds_read_b64_tr_b16 v[50:51], v7 offset:35328
    v_add_f32 v79, 1.0, v79
    v_mfma_f32_16x16x32_bf16 v[132:135], v[32:35], a[132:135], v[132:135]
    ds_read_b64_tr_b16 v[52:53], v7 offset:43008
    v_add_f32 v92, 1.0, v92
    v_mfma_f32_16x16x32_bf16 v[132:135], v[36:39], a[148:151], v[132:135]
    ds_read_b64_tr_b16 v[54:55], v7 offset:43520
    v_add_f32 v93, 1.0, v93
    v_mfma_f32_16x16x32_bf16 v[136:139], v[32:35], a[136:139], v[136:139]
    v_exp_f32 v95, v95
    v_mfma_f32_16x16x32_bf16 v[136:139], v[36:39], a[152:155], v[136:139]
    v_rcp_f32 v76, v76
    v_mfma_f32_16x16x32_bf16 v[140:143], v[32:35], a[140:143], v[140:143]
    buffer_load_dwordx4 v2, s[52:55], s99 offen offset:3072 lds
    v_add_f32 v94, 1.0, v94
    v_mfma_f32_16x16x32_bf16 v[140:143], v[36:39], a[156:159], v[140:143]
    s_waitcnt lgkmcnt(4)
    v_rcp_f32 v77, v77
    v_mfma_f32_16x16x32_bf16 v[144:147], v[40:43], a[128:131], v[144:147]
    ds_read_b64_tr_b16 v[32:33], v8 offset:34816
    v_add_f32 v95, 1.0, v95
    v_mfma_f32_16x16x32_bf16 v[144:147], v[44:47], a[144:147], v[144:147]
    ds_read_b64_tr_b16 v[34:35], v8 offset:35328
    v_mul_f32 v108, v108, v76
    v_mfma_f32_16x16x32_bf16 v[148:151], v[40:43], a[132:135], v[148:151]
    ds_read_b64_tr_b16 v[36:37], v8 offset:43008
    v_mul_f32 v109, v109, v77
    v_mfma_f32_16x16x32_bf16 v[148:151], v[44:47], a[148:151], v[148:151]
    ds_read_b64_tr_b16 v[38:39], v8 offset:43520
    v_cvt_pk_bf16_f32 v76, v108, v109
    v_mfma_f32_16x16x32_bf16 v[152:155], v[40:43], a[136:139], v[152:155]
    v_rcp_f32 v78, v78
    v_mfma_f32_16x16x32_bf16 v[152:155], v[44:47], a[152:155], v[152:155]
    v_rcp_f32 v79, v79
    v_mfma_f32_16x16x32_bf16 v[156:159], v[40:43], a[140:143], v[156:159]
    buffer_store_dwordx4 v[216:219], v11, s[72:75], s23 offen offset:2048 sc1
    v_mul_f32 v110, v110, v78
    v_mfma_f32_16x16x32_bf16 v[156:159], v[44:47], a[156:159], v[156:159]
    s_waitcnt vmcnt(29) lgkmcnt(4)
    s_barrier
    v_mul_f32 v111, v111, v79
    v_mfma_f32_16x16x32_bf16 v[160:163], v[48:51], a[128:131], v[160:163]
    ds_read_b64_tr_b16 v[40:41], v9 offset:32768
    s_add_u32 m0, s96, 16384
    v_mfma_f32_16x16x32_bf16 v[160:163], v[52:55], a[144:147], v[160:163]
    ds_read_b64_tr_b16 v[42:43], v9 offset:33280
    s_add_u32 s99, s5, 4
    v_mfma_f32_16x16x32_bf16 v[164:167], v[48:51], a[132:135], v[164:167]
    ds_read_b64_tr_b16 v[44:45], v9 offset:40960
    s_and_b32 s99, s99, 7
    v_mfma_f32_16x16x32_bf16 v[164:167], v[52:55], a[148:151], v[164:167]
    s_mul_i32 s99, s99, 196608
    buffer_load_dwordx4 v1, s[48:51], s99 offen offset:0 lds
    v_mfma_f32_16x16x32_bf16 v[168:171], v[48:51], a[136:139], v[168:171]
    ds_read_b64_tr_b16 v[46:47], v9 offset:41472
    v_rcp_f32 v92, v92
    v_mfma_f32_16x16x32_bf16 v[168:171], v[52:55], a[152:155], v[168:171]
    v_rcp_f32 v93, v93
    v_mul_f32 v124, v124, v92
    v_mfma_f32_16x16x32_bf16 v[172:175], v[48:51], a[140:143], v[172:175]
    buffer_load_dwordx4 v2, s[48:51], s99 offen offset:1024 lds
    v_mul_f32 v125, v125, v93
    v_mfma_f32_16x16x32_bf16 v[172:175], v[52:55], a[156:159], v[172:175]
    s_waitcnt lgkmcnt(4)
    v_rcp_f32 v94, v94
    v_mfma_f32_16x16x32_bf16 v[176:179], v[32:35], a[128:131], v[176:179]
    ds_read_b64_tr_b16 v[48:49], v10 offset:32768
    v_mul_f32 v126, v126, v94
    v_mfma_f32_16x16x32_bf16 v[176:179], v[36:39], a[144:147], v[176:179]
    ds_read_b64_tr_b16 v[50:51], v10 offset:33280
    v_cvt_pk_bf16_f32 v77, v110, v111
    v_mfma_f32_16x16x32_bf16 v[180:183], v[32:35], a[132:135], v[180:183]
    ds_read_b64_tr_b16 v[52:53], v10 offset:40960
    v_cvt_pk_bf16_f32 v78, v124, v125
    v_mfma_f32_16x16x32_bf16 v[180:183], v[36:39], a[148:151], v[180:183]
    ds_read_b64_tr_b16 v[54:55], v10 offset:41472
    v_bfe_u32 v16, v0, 3, 1
    v_mfma_f32_16x16x32_bf16 v[184:187], v[32:35], a[136:139], v[184:187]
    v_rcp_f32 v95, v95
    v_lshlrev_b32 v16, 2, v16
    v_mfma_f32_16x16x32_bf16 v[184:187], v[36:39], a[152:155], v[184:187]
    v_mul_f32 v127, v127, v95
    v_cvt_pk_bf16_f32 v79, v126, v127
    v_and_b32 v17, 3, v0
    v_mfma_f32_16x16x32_bf16 v[188:191], v[32:35], a[140:143], v[188:191]
    buffer_load_dwordx4 v1, s[52:55], s99 offen offset:2048 lds
    v_add_u32 v16, v16, v17
    v_mfma_f32_16x16x32_bf16 v[188:191], v[36:39], a[156:159], v[188:191]
    s_waitcnt lgkmcnt(4)
    v_bfe_u32 v17, v0, 2, 1
    v_lshl_add_u32 v16, v17, 3, v16
    v_bfe_u32 v17, v0, 4, 1
    buffer_store_dwordx4 v[76:79], v11, s[72:75], s22 offen offset:3072 sc1
    v_lshlrev_b32 v17, 4, v17
    v_max_u32 v16, v16, v17
    v_lshlrev_b32 v16, 5, v16
    v_lshrrev_b32 v17, 5, v0
    v_mul_u32_u24 v17, 544, v17
    v_add_u32 v24, v16, v17
    v_and_b32 v25, 31, v0
    v_lshlrev_b32 v25, 2, v25
    v_mfma_f32_16x16x32_bf16 v[128:131], v[40:43], a[160:163], v[128:131]
    ds_read_b64_tr_b16 v[32:33], v9 offset:34816
    v_lshrrev_b32 v110, 2, v0
    v_mfma_f32_16x16x32_bf16 v[128:131], v[44:47], a[176:179], v[128:131]
    ds_read_b64_tr_b16 v[34:35], v9 offset:35328
    v_lshlrev_b32 v110, 7, v110
    v_mfma_f32_16x16x32_bf16 v[132:135], v[40:43], a[164:167], v[132:135]
    ds_read_b64_tr_b16 v[36:37], v9 offset:43008
    v_and_b32 v111, 3, v0
    v_mfma_f32_16x16x32_bf16 v[132:135], v[44:47], a[180:183], v[132:135]
    ds_read_b64_tr_b16 v[38:39], v9 offset:43520
    v_lshl_add_u32 v110, v111, 3, v110
    v_mfma_f32_16x16x32_bf16 v[136:139], v[40:43], a[168:171], v[136:139]
    s_lshl_b32 s100, s7, 10
    v_add_u32 v108, s100, v11
    v_add_u32 v110, s96, v110
    v_mfma_f32_16x16x32_bf16 v[136:139], v[44:47], a[184:187], v[136:139]
    v_bfe_u32 v111, v0, 3, 2
    v_lshl_add_u32 v96, v111, 5, v110
    v_mfma_f32_16x16x32_bf16 v[140:143], v[40:43], a[172:175], v[140:143]
    buffer_load_dwordx4 v2, s[52:55], s99 offen offset:3072 lds
    v_xor_b32 v97, 32, v96
    v_mfma_f32_16x16x32_bf16 v[140:143], v[44:47], a[188:191], v[140:143]
    s_waitcnt lgkmcnt(4)
    v_xor_b32 v98, 64, v96
    v_xor_b32 v99, 96, v96
    v_mfma_f32_16x16x32_bf16 v[144:147], v[48:51], a[160:163], v[144:147]
    ds_read_b64_tr_b16 v[40:41], v10 offset:34816
    v_add_u32 v100, 0x10000, v96
    v_mfma_f32_16x16x32_bf16 v[144:147], v[52:55], a[176:179], v[144:147]
    ds_read_b64_tr_b16 v[42:43], v10 offset:35328
    v_add_u32 v101, 0x10000, v97
    v_mfma_f32_16x16x32_bf16 v[148:151], v[48:51], a[164:167], v[148:151]
    ds_read_b64_tr_b16 v[44:45], v10 offset:43008
    v_add_u32 v102, 0x10000, v98
    v_mfma_f32_16x16x32_bf16 v[148:151], v[52:55], a[180:183], v[148:151]
    ds_read_b64_tr_b16 v[46:47], v10 offset:43520
    v_add_u32 v103, 0x10000, v99
    v_mfma_f32_16x16x32_bf16 v[152:155], v[48:51], a[168:171], v[152:155]
    v_add_u32 v104, 0x20000, v96
    v_add_u32 v105, 0x20000, v97
    v_mfma_f32_16x16x32_bf16 v[152:155], v[52:55], a[184:187], v[152:155]
    v_add_u32 v106, 0x20000, v98
    v_add_u32 v107, 0x20000, v99
    v_mfma_f32_16x16x32_bf16 v[156:159], v[48:51], a[172:175], v[156:159]
    buffer_store_dwordx4 v[216:219], v11, s[72:75], s23 offen offset:3072 sc1
    v_lshrrev_b32 v110, 5, v0
    v_mfma_f32_16x16x32_bf16 v[156:159], v[52:55], a[188:191], v[156:159]
    s_waitcnt vmcnt(30) lgkmcnt(4)
    s_barrier
    v_bfe_u32 v111, v0, 3, 2
    v_mfma_f32_16x16x32_bf16 v[160:163], v[32:35], a[160:163], v[160:163]
    ds_read_b64_tr_b16 v[48:49], v9 offset:0
    s_add_u32 m0, s96, 32768
    v_mfma_f32_16x16x32_bf16 v[160:163], v[36:39], a[176:179], v[160:163]
    ds_read_b64_tr_b16 v[50:51], v9 offset:512
    s_add_u32 s99, s5, 6
    v_mfma_f32_16x16x32_bf16 v[164:167], v[32:35], a[164:167], v[164:167]
    ds_read_b64_tr_b16 v[52:53], v9 offset:8192
    s_and_b32 s99, s99, 7
    v_mfma_f32_16x16x32_bf16 v[164:167], v[36:39], a[180:183], v[164:167]
    s_mul_i32 s99, s99, 196608
    buffer_load_dwordx4 v1, s[48:51], s99 offen offset:0 lds
    v_mfma_f32_16x16x32_bf16 v[168:171], v[32:35], a[168:171], v[168:171]
    ds_read_b64_tr_b16 v[54:55], v9 offset:8704
    v_lshl_add_u32 v110, v110, 4, v111
    v_mfma_f32_16x16x32_bf16 v[168:171], v[36:39], a[184:187], v[168:171]
    v_and_b32 v111, 0x70, v5
    v_lshl_add_u32 v14, v110, 10, v111
    v_mfma_f32_16x16x32_bf16 v[172:175], v[32:35], a[172:175], v[172:175]
    buffer_load_dwordx4 v2, s[48:51], s99 offen offset:1024 lds
    v_add_u32 v15, 7168, v14
    v_mfma_f32_16x16x32_bf16 v[172:175], v[36:39], a[188:191], v[172:175]
    s_waitcnt lgkmcnt(4)
    v_xor_b32 v109, 1024, v108
    v_xor_b32 v110, 2048, v108
    v_mfma_f32_16x16x32_bf16 v[176:179], v[40:43], a[160:163], v[176:179]
    ds_read_b64_tr_b16 v[32:33], v10 offset:0
    v_xor_b32 v111, 3072, v108
    v_mfma_f32_16x16x32_bf16 v[176:179], v[44:47], a[176:179], v[176:179]
    ds_read_b64_tr_b16 v[34:35], v10 offset:512
    v_mfma_f32_16x16x32_bf16 v[180:183], v[40:43], a[164:167], v[180:183]
    ds_read_b64_tr_b16 v[36:37], v10 offset:8192
    v_mfma_f32_16x16x32_bf16 v[180:183], v[44:47], a[180:183], v[180:183]
    buffer_load_dwordx4 v1, s[52:55], s99 offen offset:2048 lds
    v_mfma_f32_16x16x32_bf16 v[184:187], v[40:43], a[168:171], v[184:187]
    ds_read_b64_tr_b16 v[38:39], v10 offset:8704
    v_mfma_f32_16x16x32_bf16 v[184:187], v[44:47], a[184:187], v[184:187]
    v_mfma_f32_16x16x32_bf16 v[188:191], v[40:43], a[172:175], v[188:191]
    buffer_load_dwordx4 v2, s[52:55], s99 offen offset:3072 lds
    s_add_u32 m0, s96, 131072
    v_mfma_f32_16x16x32_bf16 v[188:191], v[44:47], a[188:191], v[188:191]
    s_waitcnt lgkmcnt(4)
    v_mfma_f32_16x16x32_bf16 v[128:131], v[48:51], a[192:195], v[128:131]
    ds_read_b64_tr_b16 v[40:41], v9 offset:2048
    s_add_u32 s99, s17, 0
    v_mfma_f32_16x16x32_bf16 v[128:131], v[52:55], a[208:211], v[128:131]
    ds_read_b64_tr_b16 v[42:43], v9 offset:2560
    v_mfma_f32_16x16x32_bf16 v[132:135], v[48:51], a[196:199], v[132:135]
    ds_read_b64_tr_b16 v[44:45], v9 offset:10240
    v_mfma_f32_16x16x32_bf16 v[132:135], v[52:55], a[212:215], v[132:135]
    buffer_load_dwordx4 v5, s[56:59], s99 offen lds
    v_mfma_f32_16x16x32_bf16 v[136:139], v[48:51], a[200:203], v[136:139]
    ds_read_b64_tr_b16 v[46:47], v9 offset:10752
    v_mfma_f32_16x16x32_bf16 v[136:139], v[52:55], a[216:219], v[136:139]
    v_mfma_f32_16x16x32_bf16 v[140:143], v[48:51], a[204:207], v[140:143]
    buffer_load_dwordx4 v6, s[56:59], s99 offen offset:1024 lds
    v_mfma_f32_16x16x32_bf16 v[140:143], v[52:55], a[220:223], v[140:143]
    s_waitcnt lgkmcnt(4)
    v_mfma_f32_16x16x32_bf16 v[144:147], v[32:35], a[192:195], v[144:147]
    ds_read_b64_tr_b16 v[48:49], v10 offset:2048
    v_mfma_f32_16x16x32_bf16 v[144:147], v[36:39], a[208:211], v[144:147]
    ds_read_b64_tr_b16 v[50:51], v10 offset:2560
    v_mfma_f32_16x16x32_bf16 v[148:151], v[32:35], a[196:199], v[148:151]
    ds_read_b64_tr_b16 v[52:53], v10 offset:10240
    v_mfma_f32_16x16x32_bf16 v[148:151], v[36:39], a[212:215], v[148:151]
    buffer_load_dwordx4 v5, s[60:63], s99 offen offset:2048 lds
    v_mfma_f32_16x16x32_bf16 v[152:155], v[32:35], a[200:203], v[152:155]
    ds_read_b64_tr_b16 v[54:55], v10 offset:10752
    v_mfma_f32_16x16x32_bf16 v[152:155], v[36:39], a[216:219], v[152:155]
    v_mfma_f32_16x16x32_bf16 v[156:159], v[32:35], a[204:207], v[156:159]
    buffer_load_dwordx4 v6, s[60:63], s99 offen offset:3072 lds
    v_mfma_f32_16x16x32_bf16 v[156:159], v[36:39], a[220:223], v[156:159]
    s_waitcnt vmcnt(34) lgkmcnt(4)
    s_barrier
    v_mfma_f32_16x16x32_bf16 v[160:163], v[40:43], a[192:195], v[160:163]
    ds_read_b64_tr_b16 v[32:33], v7 offset:49152
    v_mfma_f32_16x16x32_bf16 v[160:163], v[44:47], a[208:211], v[160:163]
    ds_read_b64_tr_b16 v[34:35], v7 offset:49664
    v_mfma_f32_16x16x32_bf16 v[164:167], v[40:43], a[196:199], v[164:167]
    ds_read_b64_tr_b16 v[36:37], v7 offset:57344
    v_mfma_f32_16x16x32_bf16 v[164:167], v[44:47], a[212:215], v[164:167]
    ds_read_b64_tr_b16 v[38:39], v7 offset:57856
    v_mfma_f32_16x16x32_bf16 v[168:171], v[40:43], a[200:203], v[168:171]
    v_mfma_f32_16x16x32_bf16 v[168:171], v[44:47], a[216:219], v[168:171]
    v_mfma_f32_16x16x32_bf16 v[172:175], v[40:43], a[204:207], v[172:175]
    s_waitcnt vmcnt(8)
    v_mov_b32 v27, 2
    buffer_store_dword v27, off, s[72:75], s14 sc1
    v_mfma_f32_16x16x32_bf16 v[172:175], v[44:47], a[220:223], v[172:175]
    s_waitcnt lgkmcnt(4)
    v_mfma_f32_16x16x32_bf16 v[176:179], v[48:51], a[192:195], v[176:179]
    ds_read_b64_tr_b16 v[40:41], v8 offset:49152
    v_mfma_f32_16x16x32_bf16 v[176:179], v[52:55], a[208:211], v[176:179]
    ds_read_b64_tr_b16 v[42:43], v8 offset:49664
    v_mfma_f32_16x16x32_bf16 v[180:183], v[48:51], a[196:199], v[180:183]
    ds_read_b64_tr_b16 v[44:45], v8 offset:57344
    v_mfma_f32_16x16x32_bf16 v[180:183], v[52:55], a[212:215], v[180:183]
    ds_read_b64_tr_b16 v[46:47], v8 offset:57856
    v_mfma_f32_16x16x32_bf16 v[184:187], v[48:51], a[200:203], v[184:187]
    v_mfma_f32_16x16x32_bf16 v[184:187], v[52:55], a[216:219], v[184:187]
    v_mfma_f32_16x16x32_bf16 v[188:191], v[48:51], a[204:207], v[188:191]
    v_mfma_f32_16x16x32_bf16 v[188:191], v[52:55], a[220:223], v[188:191]
    s_waitcnt lgkmcnt(4)
    v_mfma_f32_16x16x32_bf16 v[128:131], v[32:35], a[224:227], v[128:131]
    ds_read_b64_tr_b16 v[48:49], v7 offset:51200
    v_mfma_f32_16x16x32_bf16 v[128:131], v[36:39], a[240:243], v[128:131]
    ds_read_b64_tr_b16 v[50:51], v7 offset:51712
    v_mfma_f32_16x16x32_bf16 v[132:135], v[32:35], a[228:231], v[132:135]
    ds_read_b64_tr_b16 v[52:53], v7 offset:59392
    v_mfma_f32_16x16x32_bf16 v[132:135], v[36:39], a[244:247], v[132:135]
    ds_read_b64_tr_b16 v[54:55], v7 offset:59904
    v_mfma_f32_16x16x32_bf16 v[136:139], v[32:35], a[232:235], v[136:139]
    v_mfma_f32_16x16x32_bf16 v[136:139], v[36:39], a[248:251], v[136:139]
    v_mfma_f32_16x16x32_bf16 v[140:143], v[32:35], a[236:239], v[140:143]
    v_mfma_f32_16x16x32_bf16 v[140:143], v[36:39], a[252:255], v[140:143]
    s_waitcnt lgkmcnt(4)
    v_mfma_f32_16x16x32_bf16 v[144:147], v[40:43], a[224:227], v[144:147]
    ds_read_b64_tr_b16 v[32:33], v8 offset:51200
    v_mfma_f32_16x16x32_bf16 v[144:147], v[44:47], a[240:243], v[144:147]
    ds_read_b64_tr_b16 v[34:35], v8 offset:51712
    v_mfma_f32_16x16x32_bf16 v[148:151], v[40:43], a[228:231], v[148:151]
    ds_read_b64_tr_b16 v[36:37], v8 offset:59392
    v_mfma_f32_16x16x32_bf16 v[148:151], v[44:47], a[244:247], v[148:151]
    ds_read_b64_tr_b16 v[38:39], v8 offset:59904
    v_mfma_f32_16x16x32_bf16 v[152:155], v[40:43], a[232:235], v[152:155]
    v_mfma_f32_16x16x32_bf16 v[152:155], v[44:47], a[248:251], v[152:155]
    v_mfma_f32_16x16x32_bf16 v[156:159], v[40:43], a[236:239], v[156:159]
    v_mfma_f32_16x16x32_bf16 v[156:159], v[44:47], a[252:255], v[156:159]
    s_waitcnt lgkmcnt(4)
    s_barrier
    v_mfma_f32_16x16x32_bf16 v[160:163], v[48:51], a[224:227], v[160:163]
    ds_read_b64_tr_b16 v[40:41], v9 offset:49152
    s_add_u32 m0, s96, 147456
    v_mfma_f32_16x16x32_bf16 v[160:163], v[52:55], a[240:243], v[160:163]
    s_add_u32 s99, s17, 32768
    buffer_load_dwordx4 v5, s[56:59], s99 offen lds
    v_mfma_f32_16x16x32_bf16 v[164:167], v[48:51], a[228:231], v[164:167]
    ds_read_b64_tr_b16 v[42:43], v9 offset:49664
    v_bfe_u32 v20, v0, 2, 3
    v_mfma_f32_16x16x32_bf16 v[164:167], v[52:55], a[244:247], v[164:167]
    buffer_load_dwordx4 v6, s[56:59], s99 offen offset:1024 lds
    v_and_b32 v22, 3, v0
    v_mfma_f32_16x16x32_bf16 v[168:171], v[48:51], a[232:235], v[168:171]
    ds_read_b64_tr_b16 v[44:45], v9 offset:57344
    v_lshlrev_b32 v22, 2, v22
    v_mfma_f32_16x16x32_bf16 v[168:171], v[52:55], a[248:251], v[168:171]
    buffer_load_dwordx4 v5, s[60:63], s99 offen offset:2048 lds
    v_lshl_add_u32 v20, v20, 7, v22
    v_mfma_f32_16x16x32_bf16 v[172:175], v[48:51], a[236:239], v[172:175]
    buffer_load_dwordx4 v6, s[60:63], s99 offen offset:3072 lds
    s_add_u32 m0, s96, 98304
    v_mfma_f32_16x16x32_bf16 v[172:175], v[52:55], a[252:255], v[172:175]
    ds_read_b64_tr_b16 v[46:47], v9 offset:57856
    s_waitcnt lgkmcnt(4)
    v_mfma_f32_16x16x32_bf16 v[176:179], v[32:35], a[224:227], v[176:179]
    ds_read_b64_tr_b16 v[48:49], v10 offset:49152
    s_add_u32 s99, s17, 327680
    v_mfma_f32_16x16x32_bf16 v[176:179], v[36:39], a[240:243], v[176:179]
    buffer_load_dwordx4 v5, s[56:59], s99 offen lds
    v_bfe_u32 v22, v0, 1, 4
    v_mfma_f32_16x16x32_bf16 v[180:183], v[32:35], a[228:231], v[180:183]
    ds_read_b64_tr_b16 v[50:51], v10 offset:49664
    v_lshlrev_b32 v22, 11, v22
    v_mfma_f32_16x16x32_bf16 v[180:183], v[36:39], a[244:247], v[180:183]
    buffer_load_dwordx4 v6, s[56:59], s99 offen offset:1024 lds
    v_lshrrev_b32 v21, 5, v0
    v_mfma_f32_16x16x32_bf16 v[184:187], v[32:35], a[232:235], v[184:187]
    ds_read_b64_tr_b16 v[52:53], v10 offset:57344
    s_lshl_b32 s100, s91, 1
    s_add_u32 s100, s100, s89
    s_lshl_b32 s100, s100, 10
    v_add_u32 v20, s100, v20
    v_mfma_f32_16x16x32_bf16 v[184:187], v[36:39], a[248:251], v[184:187]
    buffer_load_dwordx4 v5, s[60:63], s99 offen offset:2048 lds
    s_lshl_b32 s100, s92, 7
    v_add_u32 v22, s100, v22
    v_mfma_f32_16x16x32_bf16 v[188:191], v[32:35], a[236:239], v[188:191]
    buffer_load_dwordx4 v6, s[60:63], s99 offen offset:3072 lds
    s_add_u32 m0, s96, 81920
    v_mfma_f32_16x16x32_bf16 v[188:191], v[36:39], a[252:255], v[188:191]
    ds_read_b64_tr_b16 v[54:55], v10 offset:57856
    s_waitcnt lgkmcnt(4)
    v_sub_u32 v22, v22, v20
    v_mad_i32_i24 v20, v22, v21, v20
    v_add_u32 v20, 10551296, v20
    v_mfma_f32_16x16x32_bf16 v[64:67], v[40:43], a[0:3], 0
    ds_read_b64_tr_b16 v[32:33], v9 offset:51200
    s_add_u32 s99, s17, 360448
    v_mul_f32 v128, s98, v128
    v_mfma_f32_16x16x32_bf16 v[64:67], v[44:47], a[16:19], v[64:67]
    buffer_load_dwordx4 v5, s[56:59], s99 offen lds
    v_exp_f32 v128, v128
    v_mfma_f32_16x16x32_bf16 v[68:71], v[40:43], a[4:7], 0
    ds_read_b64_tr_b16 v[34:35], v9 offset:51712
    v_mul_f32 v129, s98, v129
    v_mul_f32 v130, s98, v130
    v_mfma_f32_16x16x32_bf16 v[68:71], v[44:47], a[20:23], v[68:71]
    buffer_load_dwordx4 v6, s[56:59], s99 offen offset:1024 lds
    v_exp_f32 v129, v129
    v_mfma_f32_16x16x32_bf16 v[72:75], v[40:43], a[8:11], 0
    ds_read_b64_tr_b16 v[36:37], v9 offset:59392
    v_exp_f32 v130, v130
    v_mfma_f32_16x16x32_bf16 v[72:75], v[44:47], a[24:27], v[72:75]
    buffer_load_dwordx4 v5, s[60:63], s99 offen offset:2048 lds
    v_mul_f32 v131, s98, v131
    v_mul_f32 v144, s98, v144
    v_mfma_f32_16x16x32_bf16 v[76:79], v[40:43], a[12:15], 0
    buffer_load_dwordx4 v6, s[60:63], s99 offen offset:3072 lds
    s_add_u32 m0, s96, 65536
    v_mul_f32 v145, s98, v145
    v_mfma_f32_16x16x32_bf16 v[76:79], v[44:47], a[28:31], v[76:79]
    ds_read_b64_tr_b16 v[38:39], v9 offset:59904
    s_waitcnt lgkmcnt(4)
    v_mul_f32 v146, s98, v146
    v_mfma_f32_16x16x32_bf16 v[80:83], v[48:51], a[0:3], 0
    ds_read_b64_tr_b16 v[40:41], v10 offset:51200
    s_add_u32 s99, s17, 131072
    v_mul_f32 v147, s98, v147
    v_mfma_f32_16x16x32_bf16 v[80:83], v[52:55], a[16:19], v[80:83]
    buffer_load_dwordx4 v5, s[56:59], s99 offen lds
    v_exp_f32 v131, v131
    v_mfma_f32_16x16x32_bf16 v[84:87], v[48:51], a[4:7], 0
    ds_read_b64_tr_b16 v[42:43], v10 offset:51712
    v_exp_f32 v144, v144
    v_mfma_f32_16x16x32_bf16 v[84:87], v[52:55], a[20:23], v[84:87]
    buffer_load_dwordx4 v6, s[56:59], s99 offen offset:1024 lds
    v_exp_f32 v145, v145
    v_mfma_f32_16x16x32_bf16 v[88:91], v[48:51], a[8:11], 0
    ds_read_b64_tr_b16 v[44:45], v10 offset:59392
    v_exp_f32 v146, v146
    v_mfma_f32_16x16x32_bf16 v[88:91], v[52:55], a[24:27], v[88:91]
    buffer_load_dwordx4 v5, s[60:63], s99 offen offset:2048 lds
    v_exp_f32 v147, v147
    v_mfma_f32_16x16x32_bf16 v[92:95], v[48:51], a[12:15], 0
    buffer_load_dwordx4 v6, s[60:63], s99 offen offset:3072 lds
    v_add_f32 v128, 1.0, v128
    v_add_f32 v129, 1.0, v129
    v_mfma_f32_16x16x32_bf16 v[92:95], v[52:55], a[28:31], v[92:95]
    ds_read_b64_tr_b16 v[46:47], v10 offset:59904
    s_waitcnt lgkmcnt(4)
    s_barrier
    v_mfma_f32_16x16x32_bf16 v[64:67], v[32:35], a[32:35], v[64:67]
    ds_read_b64_tr_b16 v[48:49], v7 offset:0
    v_rcp_f32 v128, v128
    v_bfe_u32 v19, v0, 2, 3
    v_mfma_f32_16x16x32_bf16 v[64:67], v[36:39], a[48:51], v[64:67]
    ds_read_b64_tr_b16 v[50:51], v7 offset:512
    v_rcp_f32 v129, v129
    v_and_b32 v21, 3, v0
    v_mfma_f32_16x16x32_bf16 v[68:71], v[32:35], a[36:39], v[68:71]
    ds_read_b64_tr_b16 v[52:53], v7 offset:8192
    v_lshlrev_b32 v21, 2, v21
    v_lshl_add_u32 v19, v19, 7, v21
    v_and_b32 v18, 1, v0
    v_mfma_f32_16x16x32_bf16 v[68:71], v[36:39], a[52:55], v[68:71]
    buffer_load_dword v22, v20, s[72:75], 0 offen sc1
    s_add_u32 m0, s96, 49152
    v_lshlrev_b32 v18, 7, v18
    v_bfe_u32 v21, v0, 1, 1
    v_mfma_f32_16x16x32_bf16 v[72:75], v[32:35], a[40:43], v[72:75]
    ds_read_b64_tr_b16 v[54:55], v7 offset:8704
    s_add_u32 s99, s17, 163840
    v_lshl_add_u32 v18, v21, 2, v18
    v_add_f32 v130, 1.0, v130
    v_mfma_f32_16x16x32_bf16 v[72:75], v[36:39], a[56:59], v[72:75]
    s_lshl_b32 s100, s94, 10
    s_add_u32 s100, s100, 10551296
    v_add_u32 v19, s100, v19
    v_rcp_f32 v130, v130
    v_mfma_f32_16x16x32_bf16 v[76:79], v[32:35], a[44:47], v[76:79]
    buffer_load_dwordx4 v5, s[56:59], s99 offen lds
    v_add_f32 v131, 1.0, v131
    v_rcp_f32 v131, v131
    v_mfma_f32_16x16x32_bf16 v[76:79], v[36:39], a[60:63], v[76:79]
    s_waitcnt lgkmcnt(4)
    v_add_f32 v144, 1.0, v144
    v_rcp_f32 v144, v144
    v_add_f32 v145, 1.0, v145
    v_mfma_f32_16x16x32_bf16 v[80:83], v[40:43], a[32:35], v[80:83]
    ds_read_b64_tr_b16 v[32:33], v8 offset:0
    v_rcp_f32 v145, v145
    v_add_f32 v146, 1.0, v146
    v_mfma_f32_16x16x32_bf16 v[80:83], v[44:47], a[48:51], v[80:83]
    ds_read_b64_tr_b16 v[34:35], v8 offset:512
    v_rcp_f32 v146, v146
    v_add_f32 v147, 1.0, v147
    v_mfma_f32_16x16x32_bf16 v[84:87], v[40:43], a[36:39], v[84:87]
    ds_read_b64_tr_b16 v[36:37], v8 offset:8192
    v_rcp_f32 v147, v147
    v_mul_f32 v160, v160, v128
    v_mfma_f32_16x16x32_bf16 v[84:87], v[44:47], a[52:55], v[84:87]
    ds_read_b64_tr_b16 v[38:39], v8 offset:8704
    v_mul_f32 v161, v161, v129
    v_mul_f32 v162, v162, v130
    v_mul_f32 v163, v163, v131
    v_mfma_f32_16x16x32_bf16 v[88:91], v[40:43], a[40:43], v[88:91]
    s_lshr_b32 s100, s94, 1
    s_lshl_b32 s100, s100, 3
    s_add_u32 s100, s100, s88
    s_lshl_b32 s100, s100, 8
    v_add_u32 v18, s100, v18
    v_mfma_f32_16x16x32_bf16 v[88:91], v[44:47], a[56:59], v[88:91]
    s_and_b32 s100, s94, 1
    s_lshl_b32 s100, s100, 3
    s_add_u32 s100, s100, 10551296
    v_add_u32 v18, s100, v18
    v_mul_f32 v176, v176, v144
    v_mfma_f32_16x16x32_bf16 v[92:95], v[40:43], a[44:47], v[92:95]
    buffer_load_dwordx4 v6, s[56:59], s99 offen offset:1024 lds
    v_mul_f32 v177, v177, v145
    v_mul_f32 v178, v178, v146
    v_mul_f32 v179, v179, v147
    v_mfma_f32_16x16x32_bf16 v[92:95], v[44:47], a[60:63], v[92:95]
    s_waitcnt lgkmcnt(4)
    v_cvt_pk_bf16_f32 v128, v160, v161
    v_cvt_pk_bf16_f32 v129, v162, v163
    v_cvt_pk_bf16_f32 v130, v176, v177
    v_cvt_pk_bf16_f32 v131, v178, v179
    v_mfma_f32_16x16x32_bf16 v[64:67], v[48:51], a[64:67], v[64:67]
    ds_read_b64_tr_b16 v[40:41], v7 offset:2048
    v_mul_f32 v132, s98, v132
    v_exp_f32 v132, v132
    v_mfma_f32_16x16x32_bf16 v[64:67], v[52:55], a[80:83], v[64:67]
    ds_read_b64_tr_b16 v[42:43], v7 offset:2560
    v_mul_f32 v133, s98, v133
    v_exp_f32 v133, v133
    v_mfma_f32_16x16x32_bf16 v[68:71], v[48:51], a[68:71], v[68:71]
    ds_read_b64_tr_b16 v[44:45], v7 offset:10240
    v_mul_f32 v134, s98, v134
    v_mul_f32 v135, s98, v135
    v_mfma_f32_16x16x32_bf16 v[68:71], v[52:55], a[84:87], v[68:71]
    ds_read_b64_tr_b16 v[46:47], v7 offset:10752
    v_exp_f32 v134, v134
    v_mfma_f32_16x16x32_bf16 v[72:75], v[48:51], a[72:75], v[72:75]
    buffer_store_dwordx4 v[128:131], v11, s[72:75], s20 offen offset:0 sc1
    v_exp_f32 v135, v135
    v_mfma_f32_16x16x32_bf16 v[72:75], v[52:55], a[88:91], v[72:75]
    v_mul_f32 v148, s98, v148
    v_exp_f32 v148, v148
    v_mfma_f32_16x16x32_bf16 v[76:79], v[48:51], a[76:79], v[76:79]
    buffer_load_dwordx4 v5, s[60:63], s99 offen offset:2048 lds
    v_mul_f32 v149, s98, v149
    v_mul_f32 v150, s98, v150
    v_mfma_f32_16x16x32_bf16 v[76:79], v[52:55], a[92:95], v[76:79]
    s_waitcnt lgkmcnt(4)
    v_exp_f32 v149, v149
    v_mul_f32 v151, s98, v151
    v_mfma_f32_16x16x32_bf16 v[80:83], v[32:35], a[64:67], v[80:83]
    ds_read_b64_tr_b16 v[48:49], v8 offset:2048
    v_exp_f32 v150, v150
    v_mfma_f32_16x16x32_bf16 v[80:83], v[36:39], a[80:83], v[80:83]
    ds_read_b64_tr_b16 v[50:51], v8 offset:2560
    v_exp_f32 v151, v151
    v_mfma_f32_16x16x32_bf16 v[84:87], v[32:35], a[68:71], v[84:87]
    ds_read_b64_tr_b16 v[52:53], v8 offset:10240
    v_add_f32 v132, 1.0, v132
    v_add_f32 v133, 1.0, v133
    v_mfma_f32_16x16x32_bf16 v[84:87], v[36:39], a[84:87], v[84:87]
    ds_read_b64_tr_b16 v[54:55], v8 offset:10752
    v_rcp_f32 v132, v132
    v_mfma_f32_16x16x32_bf16 v[88:91], v[32:35], a[72:75], v[88:91]
    v_rcp_f32 v133, v133
    v_add_f32 v134, 1.0, v134
    v_mfma_f32_16x16x32_bf16 v[88:91], v[36:39], a[88:91], v[88:91]
    v_rcp_f32 v134, v134
    v_add_f32 v135, 1.0, v135
    v_mfma_f32_16x16x32_bf16 v[92:95], v[32:35], a[76:79], v[92:95]
    buffer_load_dwordx4 v6, s[60:63], s99 offen offset:3072 lds
    v_rcp_f32 v135, v135
    v_mfma_f32_16x16x32_bf16 v[92:95], v[36:39], a[92:95], v[92:95]
    s_waitcnt lgkmcnt(4)
    s_barrier
    v_add_f32 v148, 1.0, v148
    v_add_f32 v149, 1.0, v149
    v_mfma_f32_16x16x32_bf16 v[64:67], v[40:43], a[96:99], v[64:67]
    ds_read_b64_tr_b16 v[32:33], v7 offset:16384
    v_rcp_f32 v148, v148
    v_mfma_f32_16x16x32_bf16 v[64:67], v[44:47], a[112:115], v[64:67]
    ds_read_b64_tr_b16 v[34:35], v7 offset:16896
    v_rcp_f32 v149, v149
    v_mfma_f32_16x16x32_bf16 v[68:71], v[40:43], a[100:103], v[68:71]
    ds_read_b64_tr_b16 v[36:37], v7 offset:24576
    v_add_f32 v150, 1.0, v150
    v_add_f32 v151, 1.0, v151
    v_mfma_f32_16x16x32_bf16 v[68:71], v[44:47], a[116:119], v[68:71]
    buffer_load_dword v21, v18, s[72:75], 0 offen offset:1024 sc1
    v_rcp_f32 v150, v150
    v_mfma_f32_16x16x32_bf16 v[72:75], v[40:43], a[104:107], v[72:75]
    ds_read_b64_tr_b16 v[38:39], v7 offset:25088
    v_rcp_f32 v151, v151
    v_mfma_f32_16x16x32_bf16 v[72:75], v[44:47], a[120:123], v[72:75]
    v_mul_f32 v164, v164, v132
    v_mul_f32 v165, v165, v133
    v_mul_f32 v166, v166, v134
    v_mfma_f32_16x16x32_bf16 v[76:79], v[40:43], a[108:111], v[76:79]
    buffer_load_dword v23, v19, s[72:75], 0 offen sc1
    s_add_u32 m0, s96, 114688
    v_mul_f32 v167, v167, v135
    v_mfma_f32_16x16x32_bf16 v[76:79], v[44:47], a[124:127], v[76:79]
    s_waitcnt lgkmcnt(4)
    v_mul_f32 v180, v180, v148
    v_mul_f32 v181, v181, v149
    v_mul_f32 v182, v182, v150
    v_mfma_f32_16x16x32_bf16 v[80:83], v[48:51], a[96:99], v[80:83]
    ds_read_b64_tr_b16 v[40:41], v8 offset:16384
    s_add_u32 s99, s17, 262144
    v_mul_f32 v183, v183, v151
    v_mfma_f32_16x16x32_bf16 v[80:83], v[52:55], a[112:115], v[80:83]
    ds_read_b64_tr_b16 v[42:43], v8 offset:16896
    v_cvt_pk_bf16_f32 v132, v164, v165
    v_cvt_pk_bf16_f32 v133, v166, v167
    v_mfma_f32_16x16x32_bf16 v[84:87], v[48:51], a[100:103], v[84:87]
    ds_read_b64_tr_b16 v[44:45], v8 offset:24576
    v_cvt_pk_bf16_f32 v134, v180, v181
    v_cvt_pk_bf16_f32 v135, v182, v183
    v_mfma_f32_16x16x32_bf16 v[84:87], v[52:55], a[116:119], v[84:87]
    buffer_load_dwordx4 v5, s[56:59], s99 offen lds
    v_mul_f32 v136, s98, v136
    v_mul_f32 v137, s98, v137
    v_mfma_f32_16x16x32_bf16 v[88:91], v[48:51], a[104:107], v[88:91]
    ds_read_b64_tr_b16 v[46:47], v8 offset:25088
    v_exp_f32 v136, v136
    v_mfma_f32_16x16x32_bf16 v[88:91], v[52:55], a[120:123], v[88:91]
    buffer_store_dwordx4 v[132:135], v11, s[72:75], s20 offen offset:1024 sc1
    v_exp_f32 v137, v137
    v_mfma_f32_16x16x32_bf16 v[92:95], v[48:51], a[108:111], v[92:95]
    buffer_load_dwordx4 v6, s[56:59], s99 offen offset:1024 lds
    v_mul_f32 v138, s98, v138
    v_mul_f32 v139, s98, v139
    v_mfma_f32_16x16x32_bf16 v[92:95], v[52:55], a[124:127], v[92:95]
    s_waitcnt lgkmcnt(4)
    v_exp_f32 v138, v138
    v_mul_f32 v152, s98, v152
    v_mfma_f32_16x16x32_bf16 v[64:67], v[32:35], a[128:131], v[64:67]
    ds_read_b64_tr_b16 v[48:49], v7 offset:18432
    v_exp_f32 v139, v139
    v_mfma_f32_16x16x32_bf16 v[64:67], v[36:39], a[144:147], v[64:67]
    ds_read_b64_tr_b16 v[50:51], v7 offset:18944
    v_exp_f32 v152, v152
    v_mfma_f32_16x16x32_bf16 v[68:71], v[32:35], a[132:135], v[68:71]
    ds_read_b64_tr_b16 v[52:53], v7 offset:26624
    v_mul_f32 v153, s98, v153
    v_mul_f32 v154, s98, v154
    v_mfma_f32_16x16x32_bf16 v[68:71], v[36:39], a[148:151], v[68:71]
    ds_read_b64_tr_b16 v[54:55], v7 offset:27136
    v_exp_f32 v153, v153
    v_mfma_f32_16x16x32_bf16 v[72:75], v[32:35], a[136:139], v[72:75]
    v_exp_f32 v154, v154
    v_mul_f32 v155, s98, v155
    v_mfma_f32_16x16x32_bf16 v[72:75], v[36:39], a[152:155], v[72:75]
    v_exp_f32 v155, v155
    v_add_f32 v136, 1.0, v136
    v_mfma_f32_16x16x32_bf16 v[76:79], v[32:35], a[140:143], v[76:79]
    buffer_load_dwordx4 v5, s[60:63], s99 offen offset:2048 lds
    v_rcp_f32 v136, v136
    v_mfma_f32_16x16x32_bf16 v[76:79], v[36:39], a[156:159], v[76:79]
    s_waitcnt lgkmcnt(4)
    v_add_f32 v137, 1.0, v137
    v_rcp_f32 v137, v137
    v_mfma_f32_16x16x32_bf16 v[80:83], v[40:43], a[128:131], v[80:83]
    ds_read_b64_tr_b16 v[32:33], v8 offset:18432
    v_add_f32 v138, 1.0, v138
    v_add_f32 v139, 1.0, v139
    v_mfma_f32_16x16x32_bf16 v[80:83], v[44:47], a[144:147], v[80:83]
    ds_read_b64_tr_b16 v[34:35], v8 offset:18944
    v_rcp_f32 v138, v138
    v_mfma_f32_16x16x32_bf16 v[84:87], v[40:43], a[132:135], v[84:87]
    ds_read_b64_tr_b16 v[36:37], v8 offset:26624
    v_rcp_f32 v139, v139
    v_mfma_f32_16x16x32_bf16 v[84:87], v[44:47], a[148:151], v[84:87]
    ds_read_b64_tr_b16 v[38:39], v8 offset:27136
    v_add_f32 v152, 1.0, v152
    v_add_f32 v153, 1.0, v153
    v_mfma_f32_16x16x32_bf16 v[88:91], v[40:43], a[136:139], v[88:91]
    v_rcp_f32 v152, v152
    v_add_f32 v154, 1.0, v154
    v_mfma_f32_16x16x32_bf16 v[88:91], v[44:47], a[152:155], v[88:91]
    v_rcp_f32 v153, v153
    v_add_f32 v155, 1.0, v155
    v_mfma_f32_16x16x32_bf16 v[92:95], v[40:43], a[140:143], v[92:95]
    buffer_load_dwordx4 v6, s[60:63], s99 offen offset:3072 lds
    v_rcp_f32 v154, v154
    v_mfma_f32_16x16x32_bf16 v[92:95], v[44:47], a[156:159], v[92:95]
    s_waitcnt vmcnt(34) lgkmcnt(4)
    s_barrier
    v_rcp_f32 v155, v155
    s_waitcnt vmcnt(6)
    v_cmp_gt_u32 vcc, 2, v21
    s_nop 0
    s_cbranch_vccnz L_slowB1
L_okB1:
    v_mfma_f32_16x16x32_bf16 v[64:67], v[48:51], a[160:163], v[64:67]
    ds_read_b64_tr_b16 v[40:41], v7 offset:32768
    s_add_u32 m0, s96, 0
    v_mul_f32 v168, v168, v136
    v_mfma_f32_16x16x32_bf16 v[64:67], v[52:55], a[176:179], v[64:67]
    ds_read_b64_tr_b16 v[42:43], v7 offset:33280
    s_add_u32 s99, s17, 294912
    v_mul_f32 v169, v169, v137
    v_mfma_f32_16x16x32_bf16 v[68:71], v[48:51], a[164:167], v[68:71]
    buffer_load_dwordx4 v5, s[56:59], s99 offen lds
    v_mul_f32 v170, v170, v138
    v_mul_f32 v171, v171, v139
    v_mfma_f32_16x16x32_bf16 v[68:71], v[52:55], a[180:183], v[68:71]
    ds_read_b64_tr_b16 v[44:45], v7 offset:40960
    v_mul_f32 v184, v184, v152
    v_mul_f32 v185, v185, v153
    v_mfma_f32_16x16x32_bf16 v[72:75], v[48:51], a[168:171], v[72:75]
    buffer_load_dwordx4 v6, s[56:59], s99 offen offset:1024 lds
    v_mul_f32 v186, v186, v154
    v_mul_f32 v187, v187, v155
    v_mfma_f32_16x16x32_bf16 v[72:75], v[52:55], a[184:187], v[72:75]
    ds_read_b64_tr_b16 v[46:47], v7 offset:41472
    v_cvt_pk_bf16_f32 v136, v168, v169
    v_cvt_pk_bf16_f32 v137, v170, v171
    v_mfma_f32_16x16x32_bf16 v[76:79], v[48:51], a[172:175], v[76:79]
    buffer_load_dwordx4 v5, s[60:63], s99 offen offset:2048 lds
    v_cvt_pk_bf16_f32 v138, v184, v185
    v_cvt_pk_bf16_f32 v139, v186, v187
    v_mfma_f32_16x16x32_bf16 v[76:79], v[52:55], a[188:191], v[76:79]
    s_waitcnt lgkmcnt(4)
    v_mul_f32 v140, s98, v140
    v_exp_f32 v140, v140
    v_mfma_f32_16x16x32_bf16 v[80:83], v[32:35], a[160:163], v[80:83]
    ds_read_b64_tr_b16 v[48:49], v8 offset:32768
    v_mul_f32 v141, s98, v141
    v_mul_f32 v142, s98, v142
    v_mfma_f32_16x16x32_bf16 v[80:83], v[36:39], a[176:179], v[80:83]
    ds_read_b64_tr_b16 v[50:51], v8 offset:33280
    v_exp_f32 v141, v141
    v_mfma_f32_16x16x32_bf16 v[84:87], v[32:35], a[164:167], v[84:87]
    buffer_load_dwordx4 v6, s[60:63], s99 offen offset:3072 lds
    s_add_u32 s25, s15, 0
    v_mul_f32 v143, s98, v143
    v_mfma_f32_16x16x32_bf16 v[84:87], v[36:39], a[180:183], v[84:87]
    ds_read_b64_tr_b16 v[52:53], v8 offset:40960
    v_exp_f32 v142, v142
    v_mfma_f32_16x16x32_bf16 v[88:91], v[32:35], a[168:171], v[88:91]
    buffer_load_dwordx4 a[0:3], v108, s[72:75], s25 offen sc1
    v_exp_f32 v143, v143
    v_mfma_f32_16x16x32_bf16 v[88:91], v[36:39], a[184:187], v[88:91]
    ds_read_b64_tr_b16 v[54:55], v8 offset:41472
    v_mul_f32 v156, s98, v156
    v_mul_f32 v157, s98, v157
    v_mfma_f32_16x16x32_bf16 v[92:95], v[32:35], a[172:175], v[92:95]
    buffer_load_dwordx4 a[4:7], v109, s[72:75], s25 offen sc1
    v_exp_f32 v156, v156
    v_mfma_f32_16x16x32_bf16 v[92:95], v[36:39], a[188:191], v[92:95]
    s_waitcnt lgkmcnt(4)
    v_exp_f32 v157, v157
    v_mul_f32 v158, s98, v158
    v_mfma_f32_16x16x32_bf16 v[64:67], v[40:43], a[192:195], v[64:67]
    ds_read_b64_tr_b16 v[32:33], v7 offset:34816
    v_exp_f32 v158, v158
    v_mfma_f32_16x16x32_bf16 v[64:67], v[44:47], a[208:211], v[64:67]
    ds_read_b64_tr_b16 v[34:35], v7 offset:35328
    v_mul_f32 v159, s98, v159
    v_add_f32 v140, 1.0, v140
    v_mfma_f32_16x16x32_bf16 v[68:71], v[40:43], a[196:199], v[68:71]
    buffer_load_dwordx4 a[8:11], v110, s[72:75], s25 offen sc1
    v_exp_f32 v159, v159
    v_mfma_f32_16x16x32_bf16 v[68:71], v[44:47], a[212:215], v[68:71]
    ds_read_b64_tr_b16 v[36:37], v7 offset:43008
    v_rcp_f32 v140, v140
    v_mfma_f32_16x16x32_bf16 v[72:75], v[40:43], a[200:203], v[72:75]
    buffer_load_dwordx4 a[12:15], v111, s[72:75], s25 offen sc1
    s_add_u32 s25, s15, 4096
    v_add_f32 v141, 1.0, v141
    v_mfma_f32_16x16x32_bf16 v[72:75], v[44:47], a[216:219], v[72:75]
    ds_read_b64_tr_b16 v[38:39], v7 offset:43520
    v_rcp_f32 v141, v141
    v_mfma_f32_16x16x32_bf16 v[76:79], v[40:43], a[204:207], v[76:79]
    buffer_load_dwordx4 a[16:19], v108, s[72:75], s25 offen sc1
    v_add_f32 v142, 1.0, v142
    v_add_f32 v143, 1.0, v143
    v_mfma_f32_16x16x32_bf16 v[76:79], v[44:47], a[220:223], v[76:79]
    s_waitcnt lgkmcnt(4)
    v_rcp_f32 v142, v142
    v_add_f32 v156, 1.0, v156
    v_mfma_f32_16x16x32_bf16 v[80:83], v[48:51], a[192:195], v[80:83]
    ds_read_b64_tr_b16 v[40:41], v8 offset:34816
    v_rcp_f32 v143, v143
    v_mfma_f32_16x16x32_bf16 v[80:83], v[52:55], a[208:211], v[80:83]
    ds_read_b64_tr_b16 v[42:43], v8 offset:35328
    v_rcp_f32 v156, v156
    v_mfma_f32_16x16x32_bf16 v[84:87], v[48:51], a[196:199], v[84:87]
    buffer_load_dwordx4 a[20:23], v109, s[72:75], s25 offen sc1
    v_add_f32 v157, 1.0, v157
    v_add_f32 v158, 1.0, v158
    v_mfma_f32_16x16x32_bf16 v[84:87], v[52:55], a[212:215], v[84:87]
    ds_read_b64_tr_b16 v[44:45], v8 offset:43008
    v_rcp_f32 v157, v157
    v_mfma_f32_16x16x32_bf16 v[88:91], v[48:51], a[200:203], v[88:91]
    buffer_load_dwordx4 a[24:27], v110, s[72:75], s25 offen sc1
    v_rcp_f32 v158, v158
    v_mfma_f32_16x16x32_bf16 v[88:91], v[52:55], a[216:219], v[88:91]
    ds_read_b64_tr_b16 v[46:47], v8 offset:43520
    v_add_f32 v159, 1.0, v159
    v_mul_f32 v172, v172, v140
    v_mfma_f32_16x16x32_bf16 v[92:95], v[48:51], a[204:207], v[92:95]
    buffer_load_dwordx4 a[28:31], v111, s[72:75], s25 offen sc1
    v_rcp_f32 v159, v159
    v_mfma_f32_16x16x32_bf16 v[92:95], v[52:55], a[220:223], v[92:95]
    s_waitcnt lgkmcnt(4)
    s_barrier
    v_mul_f32 v173, v173, v141
    v_mul_f32 v174, v174, v142
    v_mfma_f32_16x16x32_bf16 v[64:67], v[32:35], a[224:227], v[64:67]
    s_add_u32 m0, s96, 16384
    v_mul_f32 v175, v175, v143
    v_mul_f32 v188, v188, v156
    v_mul_f32 v189, v189, v157
    v_mfma_f32_16x16x32_bf16 v[64:67], v[36:39], a[240:243], v[64:67]
    s_add_u32 s99, s17, 65536
    v_mul_f32 v190, v190, v158
    v_mul_f32 v191, v191, v159
    v_cvt_pk_bf16_f32 v140, v172, v173
    v_mfma_f32_16x16x32_bf16 v[68:71], v[32:35], a[228:231], v[68:71]
    buffer_load_dwordx4 v5, s[56:59], s99 offen lds
    v_cvt_pk_bf16_f32 v141, v174, v175
    v_cvt_pk_bf16_f32 v142, v188, v189
    v_mfma_f32_16x16x32_bf16 v[68:71], v[36:39], a[244:247], v[68:71]
    buffer_store_dwordx4 v[136:139], v11, s[72:75], s20 offen offset:2048 sc1
    v_cvt_pk_bf16_f32 v143, v190, v191
    v_mfma_f32_16x16x32_bf16 v[72:75], v[32:35], a[232:235], v[72:75]
    buffer_load_dwordx4 v6, s[56:59], s99 offen offset:1024 lds
    v_mfma_f32_16x16x32_bf16 v[72:75], v[36:39], a[248:251], v[72:75]
    buffer_store_dwordx4 v[140:143], v11, s[72:75], s20 offen offset:3072 sc1
    v_mfma_f32_16x16x32_bf16 v[76:79], v[32:35], a[236:239], v[76:79]
    buffer_load_dwordx4 v5, s[60:63], s99 offen offset:2048 lds
    v_mfma_f32_16x16x32_bf16 v[76:79], v[36:39], a[252:255], v[76:79]
    s_waitcnt lgkmcnt(0)
    v_mfma_f32_16x16x32_bf16 v[80:83], v[40:43], a[224:227], v[80:83]
    v_mfma_f32_16x16x32_bf16 v[80:83], v[44:47], a[240:243], v[80:83]
    v_mfma_f32_16x16x32_bf16 v[84:87], v[40:43], a[228:231], v[84:87]
    buffer_load_dwordx4 v6, s[60:63], s99 offen offset:3072 lds
    s_add_u32 s25, s15, 40960
    v_mfma_f32_16x16x32_bf16 v[84:87], v[44:47], a[244:247], v[84:87]
    v_mfma_f32_16x16x32_bf16 v[88:91], v[40:43], a[232:235], v[88:91]
    buffer_load_dwordx4 a[32:35], v108, s[72:75], s25 offen sc1
    v_mfma_f32_16x16x32_bf16 v[88:91], v[44:47], a[248:251], v[88:91]
    v_mfma_f32_16x16x32_bf16 v[92:95], v[40:43], a[236:239], v[92:95]
    buffer_load_dwordx4 a[36:39], v109, s[72:75], s25 offen sc1
    v_mfma_f32_16x16x32_bf16 v[92:95], v[44:47], a[252:255], v[92:95]
    buffer_load_dwordx4 a[40:43], v110, s[72:75], s25 offen sc1
    buffer_load_dwordx4 a[44:47], v111, s[72:75], s25 offen sc1
    s_add_u32 s25, s15, 45056
    buffer_load_dwordx4 a[48:51], v108, s[72:75], s25 offen sc1
    buffer_load_dwordx4 a[52:55], v109, s[72:75], s25 offen sc1
    buffer_load_dwordx4 a[56:59], v110, s[72:75], s25 offen sc1
    buffer_load_dwordx4 a[60:63], v111, s[72:75], s25 offen sc1
    s_barrier
    v_cmp_gt_u32 vcc, 1, v22
    s_nop 0
    s_cbranch_vccnz L_slowB2
L_okB2:
    ds_read_b64_tr_b16 v[32:33], v104 offset:0
    ds_read_b64_tr_b16 v[34:35], v104 offset:2048
    ds_read_b64_tr_b16 v[36:37], v104 offset:16384
    ds_read_b64_tr_b16 v[38:39], v104 offset:18432
    ds_read_b64_tr_b16 v[40:41], v105 offset:0
    ds_read_b64_tr_b16 v[42:43], v105 offset:2048
    ds_read_b64_tr_b16 v[44:45], v105 offset:16384
    ds_read_b64_tr_b16 v[46:47], v105 offset:18432
    s_waitcnt lgkmcnt(4)
    s_waitcnt vmcnt(21)
    v_mfma_f32_16x16x32_bf16 v[128:131], v[32:35], a[0:3], 0
    ds_read_b64_tr_b16 v[48:49], v106 offset:0
    v_cvt_pk_bf16_f32 v64, v64, v65
    v_cvt_pk_bf16_f32 v65, v66, v67
    v_cvt_pk_bf16_f32 v66, v68, v69
    v_cvt_pk_bf16_f32 v67, v70, v71
    s_waitcnt vmcnt(17)
    v_mfma_f32_16x16x32_bf16 v[128:131], v[36:39], a[16:19], v[128:131]
    ds_read_b64_tr_b16 v[50:51], v106 offset:2048
    v_permlane16_swap_b32 v64, v66
    v_permlane16_swap_b32 v65, v67
    v_cvt_pk_bf16_f32 v80, v80, v81
    v_cvt_pk_bf16_f32 v81, v82, v83
    v_mfma_f32_32x32x16_bf16 v[224:239], v[56:59], v[64:67], 0
    v_cvt_pk_bf16_f32 v82, v84, v85
    v_cvt_pk_bf16_f32 v83, v86, v87
    v_cvt_pk_bf16_f32 v72, v72, v73
    v_permlane16_swap_b32 v80, v82
    v_permlane16_swap_b32 v81, v83
    v_cvt_pk_bf16_f32 v73, v74, v75
    v_cvt_pk_bf16_f32 v74, v76, v77
    v_cvt_pk_bf16_f32 v75, v78, v79
    v_mfma_f32_32x32x16_bf16 v[240:255], v[60:63], v[80:83], 0
    v_permlane16_swap_b32 v72, v74
    v_permlane16_swap_b32 v73, v75
    v_mfma_f32_16x16x32_bf16 v[132:135], v[32:35], a[4:7], 0
    ds_read_b64_tr_b16 v[52:53], v106 offset:16384
    v_max3_f32 v12, v224, v225, v226
    v_max3_f32 v12, v12, v227, v228
    v_max3_f32 v12, v12, v229, v230
    v_max3_f32 v12, v12, v231, v232
    s_waitcnt vmcnt(16)
    v_mfma_f32_16x16x32_bf16 v[132:135], v[36:39], a[20:23], v[132:135]
    buffer_load_dword v22, v18, s[72:75], 0 offen sc1
    s_add_u32 m0, s96, 32768
    v_max3_f32 v12, v12, v233, v234
    v_max3_f32 v12, v12, v235, v236
    v_max3_f32 v12, v12, v237, v238
    v_mfma_f32_16x16x32_bf16 v[136:139], v[32:35], a[8:11], 0
    ds_read_b64_tr_b16 v[54:55], v106 offset:18432
    s_add_u32 s99, s17, 98304
    v_max_f32 v12, v12, v239
    v_mul_f32 v12, s98, v12
    v_fma_f32 v224, v224, s97, v12
    s_waitcnt vmcnt(16)
    v_mfma_f32_16x16x32_bf16 v[136:139], v[36:39], a[24:27], v[136:139]
    v_exp_f32 v224, v224
    v_fma_f32 v225, v225, s97, v12
    v_exp_f32 v225, v225
    v_mfma_f32_16x16x32_bf16 v[140:143], v[32:35], a[12:15], 0
    buffer_load_dwordx4 v5, s[56:59], s99 offen lds
    v_fma_f32 v226, v226, s97, v12
    v_exp_f32 v226, v226
    v_fma_f32 v227, v227, s97, v12
    s_waitcnt vmcnt(16)
    v_mfma_f32_16x16x32_bf16 v[140:143], v[36:39], a[28:31], v[140:143]
    s_waitcnt lgkmcnt(4)
    v_exp_f32 v227, v227
    v_fma_f32 v228, v228, s97, v12
    v_exp_f32 v228, v228
    v_mfma_f32_16x16x32_bf16 v[144:147], v[40:43], a[0:3], 0
    ds_read_b64_tr_b16 v[32:33], v107 offset:0
    v_fma_f32 v229, v229, s97, v12
    v_exp_f32 v229, v229
    v_fma_f32 v230, v230, s97, v12
    v_mfma_f32_16x16x32_bf16 v[144:147], v[44:47], a[16:19], v[144:147]
    ds_read_b64_tr_b16 v[34:35], v107 offset:2048
    v_exp_f32 v230, v230
    v_fma_f32 v231, v231, s97, v12
    v_fma_f32 v232, v232, s97, v12
    v_mfma_f32_16x16x32_bf16 v[148:151], v[40:43], a[4:7], 0
    ds_read_b64_tr_b16 v[36:37], v107 offset:16384
    v_exp_f32 v231, v231
    v_exp_f32 v232, v232
    v_mfma_f32_16x16x32_bf16 v[148:151], v[44:47], a[20:23], v[148:151]
    buffer_load_dwordx4 v6, s[56:59], s99 offen offset:1024 lds
    v_fma_f32 v233, v233, s97, v12
    v_exp_f32 v233, v233
    v_fma_f32 v234, v234, s97, v12
    v_mfma_f32_16x16x32_bf16 v[152:155], v[40:43], a[8:11], 0
    ds_read_b64_tr_b16 v[38:39], v107 offset:18432
    v_exp_f32 v234, v234
    v_fma_f32 v235, v235, s97, v12
    v_fma_f32 v236, v236, s97, v12
    v_mfma_f32_16x16x32_bf16 v[152:155], v[44:47], a[24:27], v[152:155]
    v_exp_f32 v235, v235
    v_exp_f32 v236, v236
    v_fma_f32 v237, v237, s97, v12
    v_mfma_f32_16x16x32_bf16 v[156:159], v[40:43], a[12:15], 0
    buffer_load_dwordx4 v5, s[60:63], s99 offen offset:2048 lds
    v_exp_f32 v237, v237
    v_fma_f32 v238, v238, s97, v12
    v_fma_f32 v239, v239, s97, v12
    v_mfma_f32_16x16x32_bf16 v[156:159], v[44:47], a[28:31], v[156:159]
    s_waitcnt lgkmcnt(4)
    v_exp_f32 v238, v238
    v_exp_f32 v239, v239
    v_add_f32 v13, v224, v225
    v_mfma_f32_16x16x32_bf16 v[160:163], v[48:51], a[0:3], 0
    ds_read_b64_tr_b16 v[40:41], v100 offset:32768
    v_add_f32 v13, v13, v226
    v_add_f32 v13, v13, v227
    v_add_f32 v13, v13, v228
    v_add_f32 v13, v13, v229
    v_mfma_f32_16x16x32_bf16 v[160:163], v[52:55], a[16:19], v[160:163]
    ds_read_b64_tr_b16 v[42:43], v100 offset:34816
    v_add_f32 v13, v13, v230
    v_add_f32 v13, v13, v231
    v_add_f32 v13, v13, v232
    v_add_f32 v13, v13, v233
    v_mfma_f32_16x16x32_bf16 v[164:167], v[48:51], a[4:7], 0
    ds_read_b64_tr_b16 v[44:45], v100 offset:16384
    v_add_f32 v13, v13, v234
    v_add_f32 v13, v13, v235
    v_add_f32 v13, v13, v236
    v_add_f32 v13, v13, v237
    v_mfma_f32_16x16x32_bf16 v[164:167], v[52:55], a[20:23], v[164:167]
    ds_read_b64_tr_b16 v[46:47], v100 offset:18432
    v_add_f32 v13, v13, v238
    v_add_f32 v13, v13, v239
    v_rcp_f32 v13, v13
    v_mfma_f32_16x16x32_bf16 v[168:171], v[48:51], a[8:11], 0
    v_mul_f32 v224, v224, v13
    v_mul_f32 v225, v225, v13
    v_mul_f32 v226, v226, v13
    v_mul_f32 v227, v227, v13
    v_mul_f32 v228, v228, v13
    v_mfma_f32_16x16x32_bf16 v[168:171], v[52:55], a[24:27], v[168:171]
    v_mul_f32 v229, v229, v13
    v_mul_f32 v230, v230, v13
    v_mul_f32 v231, v231, v13
    v_mul_f32 v232, v232, v13
    v_mfma_f32_16x16x32_bf16 v[172:175], v[48:51], a[12:15], 0
    buffer_load_dwordx4 v6, s[60:63], s99 offen offset:3072 lds
    v_mul_f32 v233, v233, v13
    v_mul_f32 v234, v234, v13
    v_mul_f32 v235, v235, v13
    v_mfma_f32_16x16x32_bf16 v[172:175], v[52:55], a[28:31], v[172:175]
    s_waitcnt lgkmcnt(4)
    v_mul_f32 v236, v236, v13
    v_mul_f32 v237, v237, v13
    v_mul_f32 v238, v238, v13
    v_mul_f32 v239, v239, v13
    v_mfma_f32_16x16x32_bf16 v[176:179], v[32:35], a[0:3], 0
    ds_read_b64_tr_b16 v[48:49], v101 offset:32768
    v_cvt_pk_bf16_f32 v192, v224, v225
    v_cvt_pk_bf16_f32 v193, v226, v227
    v_cvt_pk_bf16_f32 v194, v228, v229
    v_mfma_f32_16x16x32_bf16 v[176:179], v[36:39], a[16:19], v[176:179]
    ds_read_b64_tr_b16 v[50:51], v101 offset:34816
    v_cvt_pk_bf16_f32 v195, v230, v231
    v_cvt_pk_bf16_f32 v196, v232, v233
    v_cvt_pk_bf16_f32 v197, v234, v235
    v_mfma_f32_16x16x32_bf16 v[180:183], v[32:35], a[4:7], 0
    ds_read_b64_tr_b16 v[52:53], v101 offset:16384
    v_cvt_pk_bf16_f32 v198, v236, v237
    v_cvt_pk_bf16_f32 v199, v238, v239
    v_max3_f32 v12, v240, v241, v242
    v_mfma_f32_32x32x16_bf16 v[224:239], v[56:59], v[72:75], 0
    v_max3_f32 v12, v12, v243, v244
    v_max3_f32 v12, v12, v245, v246
    v_max3_f32 v12, v12, v247, v248
    v_max3_f32 v12, v12, v249, v250
    v_max3_f32 v12, v12, v251, v252
    v_max3_f32 v12, v12, v253, v254
    v_max_f32 v12, v12, v255
    v_mul_f32 v12, s98, v12
    v_mfma_f32_16x16x32_bf16 v[180:183], v[36:39], a[20:23], v[180:183]
    ds_read_b64_tr_b16 v[54:55], v101 offset:18432
    v_fma_f32 v240, v240, s97, v12
    v_exp_f32 v240, v240
    v_mfma_f32_16x16x32_bf16 v[184:187], v[32:35], a[8:11], 0
    v_fma_f32 v241, v241, s97, v12
    v_exp_f32 v241, v241
    v_fma_f32 v242, v242, s97, v12
    v_mfma_f32_16x16x32_bf16 v[184:187], v[36:39], a[24:27], v[184:187]
    v_exp_f32 v242, v242
    v_fma_f32 v243, v243, s97, v12
    v_fma_f32 v244, v244, s97, v12
    v_mfma_f32_16x16x32_bf16 v[188:191], v[32:35], a[12:15], 0
    s_waitcnt vmcnt(15)
    v_mov_b32 v27, 3
    buffer_store_dword v27, off, s[72:75], s14 sc1
    v_mfma_f32_16x16x32_bf16 v[188:191], v[36:39], a[28:31], v[188:191]
    s_waitcnt lgkmcnt(4)
    v_exp_f32 v243, v243
    v_exp_f32 v244, v244
    s_waitcnt vmcnt(5)
    v_cmp_gt_u32 vcc, 2, v22
    s_nop 0
    s_cbranch_vccnz L_slowB3
L_okB3:
    v_mfma_f32_16x16x32_bf16 v[128:131], v[40:43], a[32:35], v[128:131]
    ds_read_b64_tr_b16 v[32:33], v102 offset:32768
    s_add_u32 s25, s15, 16384
    v_fma_f32 v245, v245, s97, v12
    v_fma_f32 v246, v246, s97, v12
    v_mfma_f32_16x16x32_bf16 v[128:131], v[44:47], a[48:51], v[128:131]
    buffer_load_dwordx4 a[64:67], v108, s[72:75], s25 offen sc1
    v_exp_f32 v245, v245
    v_fma_f32 v247, v247, s97, v12
    v_mfma_f32_16x16x32_bf16 v[132:135], v[40:43], a[36:39], v[132:135]
    ds_read_b64_tr_b16 v[34:35], v102 offset:34816
    v_exp_f32 v246, v246
    v_fma_f32 v248, v248, s97, v12
    v_mfma_f32_16x16x32_bf16 v[132:135], v[44:47], a[52:55], v[132:135]
    buffer_load_dwordx4 a[68:71], v109, s[72:75], s25 offen sc1
    v_exp_f32 v247, v247
    v_fma_f32 v249, v249, s97, v12
    v_mfma_f32_16x16x32_bf16 v[136:139], v[40:43], a[40:43], v[136:139]
    ds_read_b64_tr_b16 v[36:37], v102 offset:16384
    v_exp_f32 v248, v248
    v_fma_f32 v250, v250, s97, v12
    v_mfma_f32_16x16x32_bf16 v[136:139], v[44:47], a[56:59], v[136:139]
    buffer_load_dwordx4 a[72:75], v110, s[72:75], s25 offen sc1
    v_exp_f32 v249, v249
    v_fma_f32 v251, v251, s97, v12
    v_mfma_f32_16x16x32_bf16 v[140:143], v[40:43], a[44:47], v[140:143]
    buffer_load_dwordx4 a[76:79], v111, s[72:75], s25 offen sc1
    s_add_u32 s25, s15, 20480
    v_exp_f32 v250, v250
    v_mfma_f32_16x16x32_bf16 v[140:143], v[44:47], a[60:63], v[140:143]
    ds_read_b64_tr_b16 v[38:39], v102 offset:18432
    s_waitcnt lgkmcnt(4)
    v_exp_f32 v251, v251
    v_mfma_f32_16x16x32_bf16 v[144:147], v[48:51], a[32:35], v[144:147]
    ds_read_b64_tr_b16 v[40:41], v103 offset:32768
    v_fma_f32 v252, v252, s97, v12
    v_exp_f32 v252, v252
    v_mfma_f32_16x16x32_bf16 v[144:147], v[52:55], a[48:51], v[144:147]
    buffer_load_dwordx4 a[80:83], v108, s[72:75], s25 offen sc1
    v_fma_f32 v253, v253, s97, v12
    v_exp_f32 v253, v253
    v_mfma_f32_16x16x32_bf16 v[148:151], v[48:51], a[36:39], v[148:151]
    ds_read_b64_tr_b16 v[42:43], v103 offset:34816
    v_fma_f32 v254, v254, s97, v12
    v_exp_f32 v254, v254
    v_mfma_f32_16x16x32_bf16 v[148:151], v[52:55], a[52:55], v[148:151]
    buffer_load_dwordx4 a[84:87], v109, s[72:75], s25 offen sc1
    v_fma_f32 v255, v255, s97, v12
    v_exp_f32 v255, v255
    v_mfma_f32_16x16x32_bf16 v[152:155], v[48:51], a[40:43], v[152:155]
    ds_read_b64_tr_b16 v[44:45], v103 offset:16384
    v_add_f32 v13, v240, v241
    v_add_f32 v13, v13, v242
    v_add_f32 v13, v13, v243
    v_mfma_f32_16x16x32_bf16 v[152:155], v[52:55], a[56:59], v[152:155]
    buffer_load_dwordx4 a[88:91], v110, s[72:75], s25 offen sc1
    v_add_f32 v13, v13, v244
    v_add_f32 v13, v13, v245
    v_add_f32 v13, v13, v246
    v_mfma_f32_16x16x32_bf16 v[156:159], v[48:51], a[44:47], v[156:159]
    buffer_load_dwordx4 a[92:95], v111, s[72:75], s25 offen sc1
    s_add_u32 m0, s96, 131072
    v_add_f32 v13, v13, v247
    v_add_f32 v13, v13, v248
    v_mfma_f32_16x16x32_bf16 v[156:159], v[52:55], a[60:63], v[156:159]
    ds_read_b64_tr_b16 v[46:47], v103 offset:18432
    s_waitcnt lgkmcnt(4)
    v_add_f32 v13, v13, v249
    v_add_f32 v13, v13, v250
    v_mfma_f32_16x16x32_bf16 v[160:163], v[32:35], a[32:35], v[160:163]
    ds_read_b64_tr_b16 v[48:49], v100 offset:0
    s_add_u32 s99, s17, 393216
    v_add_f32 v13, v13, v251
    v_add_f32 v13, v13, v252
    v_mfma_f32_16x16x32_bf16 v[160:163], v[36:39], a[48:51], v[160:163]
    buffer_load_dwordx4 v5, s[56:59], s99 offen lds
    v_add_f32 v13, v13, v253
    v_add_f32 v13, v13, v254
    v_add_f32 v13, v13, v255
    v_mfma_f32_16x16x32_bf16 v[164:167], v[32:35], a[36:39], v[164:167]
    ds_read_b64_tr_b16 v[50:51], v100 offset:2048
    v_rcp_f32 v13, v13
    v_cvt_pk_bf16_f32 v88, v88, v89
    v_mfma_f32_16x16x32_bf16 v[164:167], v[36:39], a[52:55], v[164:167]
    buffer_load_dwordx4 v6, s[56:59], s99 offen offset:1024 lds
    v_mul_f32 v240, v240, v13
    v_mul_f32 v241, v241, v13
    v_mul_f32 v242, v242, v13
    v_mfma_f32_16x16x32_bf16 v[168:171], v[32:35], a[40:43], v[168:171]
    ds_read_b64_tr_b16 v[52:53], v96 offset:49152
    v_mul_f32 v243, v243, v13
    v_mul_f32 v244, v244, v13
    v_mul_f32 v245, v245, v13
    v_mfma_f32_16x16x32_bf16 v[168:171], v[36:39], a[56:59], v[168:171]
    buffer_load_dwordx4 v5, s[60:63], s99 offen offset:2048 lds
    v_mul_f32 v246, v246, v13
    v_mul_f32 v247, v247, v13
    v_mul_f32 v248, v248, v13
    v_mfma_f32_16x16x32_bf16 v[172:175], v[32:35], a[44:47], v[172:175]
    buffer_load_dwordx4 v6, s[60:63], s99 offen offset:3072 lds
    s_add_u32 s25, s15, 32768
    v_mul_f32 v249, v249, v13
    v_mul_f32 v250, v250, v13
    v_mfma_f32_16x16x32_bf16 v[172:175], v[36:39], a[60:63], v[172:175]
    ds_read_b64_tr_b16 v[54:55], v96 offset:51200
    s_waitcnt lgkmcnt(4)
    v_mul_f32 v251, v251, v13
    v_mul_f32 v252, v252, v13
    v_mfma_f32_16x16x32_bf16 v[176:179], v[40:43], a[32:35], v[176:179]
    ds_read_b64_tr_b16 v[32:33], v101 offset:0
    v_mul_f32 v253, v253, v13
    v_mul_f32 v254, v254, v13
    v_mul_f32 v255, v255, v13
    v_mfma_f32_16x16x32_bf16 v[176:179], v[44:47], a[48:51], v[176:179]
    buffer_load_dwordx4 a[96:99], v108, s[72:75], s25 offen sc1
    v_cvt_pk_bf16_f32 v200, v240, v241
    v_cvt_pk_bf16_f32 v201, v242, v243
    v_cvt_pk_bf16_f32 v202, v244, v245
    v_mfma_f32_16x16x32_bf16 v[180:183], v[40:43], a[36:39], v[180:183]
    ds_read_b64_tr_b16 v[34:35], v101 offset:2048
    v_cvt_pk_bf16_f32 v203, v246, v247
    v_cvt_pk_bf16_f32 v204, v248, v249
    v_cvt_pk_bf16_f32 v205, v250, v251
    v_mfma_f32_16x16x32_bf16 v[180:183], v[44:47], a[52:55], v[180:183]
    buffer_load_dwordx4 a[100:103], v109, s[72:75], s25 offen sc1
    v_cvt_pk_bf16_f32 v206, v252, v253
    v_cvt_pk_bf16_f32 v207, v254, v255
    v_cvt_pk_bf16_f32 v89, v90, v91
    v_mfma_f32_16x16x32_bf16 v[184:187], v[40:43], a[40:43], v[184:187]
    ds_read_b64_tr_b16 v[36:37], v97 offset:49152
    v_cvt_pk_bf16_f32 v90, v92, v93
    v_cvt_pk_bf16_f32 v91, v94, v95
    v_max3_f32 v12, v224, v225, v226
    v_mfma_f32_16x16x32_bf16 v[184:187], v[44:47], a[56:59], v[184:187]
    buffer_load_dwordx4 a[104:107], v110, s[72:75], s25 offen sc1
    v_permlane16_swap_b32 v88, v90
    v_permlane16_swap_b32 v89, v91
    v_max3_f32 v12, v12, v227, v228
    v_mfma_f32_16x16x32_bf16 v[188:191], v[40:43], a[44:47], v[188:191]
    buffer_load_dwordx4 a[108:111], v111, s[72:75], s25 offen sc1
    v_max3_f32 v12, v12, v229, v230
    v_max3_f32 v12, v12, v231, v232
    v_max3_f32 v12, v12, v233, v234
    v_mfma_f32_32x32x16_bf16 v[240:255], v[60:63], v[88:91], 0
    v_max3_f32 v12, v12, v235, v236
    v_max3_f32 v12, v12, v237, v238
    v_max_f32 v12, v12, v239
    v_mul_f32 v12, s98, v12
    v_fma_f32 v224, v224, s97, v12
    v_exp_f32 v224, v224
    v_fma_f32 v225, v225, s97, v12
    v_mfma_f32_16x16x32_bf16 v[188:191], v[44:47], a[60:63], v[188:191]
    ds_read_b64_tr_b16 v[38:39], v97 offset:51200
    s_waitcnt lgkmcnt(4)
    v_exp_f32 v225, v225
    s_waitcnt vmcnt(15)
    v_mfma_f32_16x16x32_bf16 v[128:131], v[48:51], a[64:67], v[128:131]
    ds_read_b64_tr_b16 v[40:41], v102 offset:0
    v_fma_f32 v226, v226, s97, v12
    v_exp_f32 v226, v226
    s_waitcnt vmcnt(11)
    v_mfma_f32_16x16x32_bf16 v[128:131], v[52:55], a[80:83], v[128:131]
    buffer_load_dword v21, v18, s[72:75], 0 offen offset:1024 sc1
    s_add_u32 s25, s15, 36864
    v_fma_f32 v227, v227, s97, v12
    v_fma_f32 v228, v228, s97, v12
    v_mfma_f32_16x16x32_bf16 v[132:135], v[48:51], a[68:71], v[132:135]
    ds_read_b64_tr_b16 v[42:43], v102 offset:2048
    v_exp_f32 v227, v227
    v_fma_f32 v229, v229, s97, v12
    s_waitcnt vmcnt(11)
    v_mfma_f32_16x16x32_bf16 v[132:135], v[52:55], a[84:87], v[132:135]
    buffer_load_dwordx4 a[112:115], v108, s[72:75], s25 offen sc1
    v_exp_f32 v228, v228
    v_fma_f32 v230, v230, s97, v12
    v_mfma_f32_16x16x32_bf16 v[136:139], v[48:51], a[72:75], v[136:139]
    ds_read_b64_tr_b16 v[44:45], v98 offset:49152
    v_exp_f32 v229, v229
    v_fma_f32 v231, v231, s97, v12
    s_waitcnt vmcnt(11)
    v_mfma_f32_16x16x32_bf16 v[136:139], v[52:55], a[88:91], v[136:139]
    buffer_load_dwordx4 a[116:119], v109, s[72:75], s25 offen sc1
    v_exp_f32 v230, v230
    v_fma_f32 v232, v232, s97, v12
    v_mfma_f32_16x16x32_bf16 v[140:143], v[48:51], a[76:79], v[140:143]
    buffer_load_dwordx4 a[120:123], v110, s[72:75], s25 offen sc1
    v_exp_f32 v231, v231
    v_fma_f32 v233, v233, s97, v12
    s_waitcnt vmcnt(12)
    v_mfma_f32_16x16x32_bf16 v[140:143], v[52:55], a[92:95], v[140:143]
    ds_read_b64_tr_b16 v[46:47], v98 offset:51200
    s_waitcnt lgkmcnt(4)
    v_exp_f32 v232, v232
    v_mfma_f32_16x16x32_bf16 v[144:147], v[32:35], a[64:67], v[144:147]
    ds_read_b64_tr_b16 v[48:49], v103 offset:0
    v_exp_f32 v233, v233
    v_fma_f32 v234, v234, s97, v12
    v_mfma_f32_16x16x32_bf16 v[144:147], v[36:39], a[80:83], v[144:147]
    ds_read_b64_tr_b16 v[50:51], v103 offset:2048
    v_exp_f32 v234, v234
    v_fma_f32 v235, v235, s97, v12
    v_mfma_f32_16x16x32_bf16 v[148:151], v[32:35], a[68:71], v[148:151]
    buffer_load_dwordx4 a[124:127], v111, s[72:75], s25 offen sc1
    s_add_u32 m0, s96, 147456
    v_exp_f32 v235, v235
    v_mfma_f32_16x16x32_bf16 v[148:151], v[36:39], a[84:87], v[148:151]
    ds_read_b64_tr_b16 v[52:53], v99 offset:49152
    s_add_u32 s99, s17, 425984
    v_fma_f32 v236, v236, s97, v12
    v_fma_f32 v237, v237, s97, v12
    v_mfma_f32_16x16x32_bf16 v[152:155], v[32:35], a[72:75], v[152:155]
    buffer_load_dwordx4 v5, s[56:59], s99 offen lds
    v_exp_f32 v236, v236
    v_fma_f32 v238, v238, s97, v12
    v_mfma_f32_16x16x32_bf16 v[152:155], v[36:39], a[88:91], v[152:155]
    ds_read_b64_tr_b16 v[54:55], v99 offset:51200
    v_exp_f32 v237, v237
    v_fma_f32 v239, v239, s97, v12
    v_mfma_f32_16x16x32_bf16 v[156:159], v[32:35], a[76:79], v[156:159]
    buffer_load_dwordx4 v6, s[56:59], s99 offen offset:1024 lds
    v_exp_f32 v238, v238
    v_add_f32 v13, v224, v225
    v_mfma_f32_16x16x32_bf16 v[156:159], v[36:39], a[92:95], v[156:159]
    s_waitcnt lgkmcnt(4)
    v_exp_f32 v239, v239
    v_add_f32 v13, v13, v226
    v_add_f32 v13, v13, v227
    v_mfma_f32_16x16x32_bf16 v[160:163], v[40:43], a[64:67], v[160:163]
    ds_read_b64_tr_b16 v[32:33], v100 offset:49152
    v_add_f32 v13, v13, v228
    v_add_f32 v13, v13, v229
    v_add_f32 v13, v13, v230
    v_mfma_f32_16x16x32_bf16 v[160:163], v[44:47], a[80:83], v[160:163]
    ds_read_b64_tr_b16 v[34:35], v100 offset:51200
    v_add_f32 v13, v13, v231
    v_add_f32 v13, v13, v232
    v_add_f32 v13, v13, v233
    v_mfma_f32_16x16x32_bf16 v[164:167], v[40:43], a[68:71], v[164:167]
    buffer_load_dwordx4 v5, s[60:63], s99 offen offset:2048 lds
    v_add_f32 v13, v13, v234
    v_add_f32 v13, v13, v235
    v_add_f32 v13, v13, v236
    v_mfma_f32_16x16x32_bf16 v[164:167], v[44:47], a[84:87], v[164:167]
    ds_read_b64_tr_b16 v[36:37], v96 offset:0
    v_add_f32 v13, v13, v237
    v_add_f32 v13, v13, v238
    v_add_f32 v13, v13, v239
    v_mfma_f32_16x16x32_bf16 v[168:171], v[40:43], a[72:75], v[168:171]
    buffer_load_dwordx4 v6, s[60:63], s99 offen offset:3072 lds
    s_add_u32 m0, s96, 98304
    v_rcp_f32 v13, v13
    v_mfma_f32_16x16x32_bf16 v[168:171], v[44:47], a[88:91], v[168:171]
    ds_read_b64_tr_b16 v[38:39], v96 offset:2048
    s_add_u32 s99, s17, 196608
    v_mul_f32 v224, v224, v13
    v_mul_f32 v225, v225, v13
    v_mfma_f32_16x16x32_bf16 v[172:175], v[40:43], a[76:79], v[172:175]
    buffer_load_dwordx4 v5, s[56:59], s99 offen lds
    v_mul_f32 v226, v226, v13
    v_mul_f32 v227, v227, v13
    v_mul_f32 v228, v228, v13
    v_mfma_f32_16x16x32_bf16 v[172:175], v[44:47], a[92:95], v[172:175]
    s_waitcnt lgkmcnt(4)
    v_mul_f32 v229, v229, v13
    v_mul_f32 v230, v230, v13
    v_mul_f32 v231, v231, v13
    v_mul_f32 v232, v232, v13
    v_mfma_f32_16x16x32_bf16 v[176:179], v[48:51], a[64:67], v[176:179]
    ds_read_b64_tr_b16 v[40:41], v101 offset:49152
    v_mul_f32 v233, v233, v13
    v_mul_f32 v234, v234, v13
    v_mul_f32 v235, v235, v13
    v_mfma_f32_16x16x32_bf16 v[176:179], v[52:55], a[80:83], v[176:179]
    ds_read_b64_tr_b16 v[42:43], v101 offset:51200
    v_mul_f32 v236, v236, v13
    v_mul_f32 v237, v237, v13
    v_mul_f32 v238, v238, v13
    v_mfma_f32_16x16x32_bf16 v[180:183], v[48:51], a[68:71], v[180:183]
    buffer_load_dwordx4 v6, s[56:59], s99 offen offset:1024 lds
    v_mul_f32 v239, v239, v13
    v_cvt_pk_bf16_f32 v208, v224, v225
    v_cvt_pk_bf16_f32 v209, v226, v227
    v_mfma_f32_16x16x32_bf16 v[180:183], v[52:55], a[84:87], v[180:183]
    ds_read_b64_tr_b16 v[44:45], v97 offset:0
    v_cvt_pk_bf16_f32 v210, v228, v229
    v_cvt_pk_bf16_f32 v211, v230, v231
    v_cvt_pk_bf16_f32 v212, v232, v233
    v_mfma_f32_16x16x32_bf16 v[184:187], v[48:51], a[72:75], v[184:187]
    buffer_load_dwordx4 v5, s[60:63], s99 offen offset:2048 lds
    v_cvt_pk_bf16_f32 v213, v234, v235
    v_cvt_pk_bf16_f32 v214, v236, v237
    v_cvt_pk_bf16_f32 v215, v238, v239
    v_mfma_f32_16x16x32_bf16 v[184:187], v[52:55], a[88:91], v[184:187]
    ds_read_b64_tr_b16 v[46:47], v97 offset:2048
    v_max3_f32 v12, v240, v241, v242
    v_max3_f32 v12, v12, v243, v244
    v_max3_f32 v12, v12, v245, v246
    v_mfma_f32_16x16x32_bf16 v[188:191], v[48:51], a[76:79], v[188:191]
    buffer_load_dwordx4 v6, s[60:63], s99 offen offset:3072 lds
    v_max3_f32 v12, v12, v247, v248
    v_max3_f32 v12, v12, v249, v250
    v_max3_f32 v12, v12, v251, v252
    v_mfma_f32_16x16x32_bf16 v[188:191], v[52:55], a[92:95], v[188:191]
    s_waitcnt lgkmcnt(4)
    v_max3_f32 v12, v12, v253, v254
    v_max_f32 v12, v12, v255
    v_mul_f32 v12, s98, v12
    v_fma_f32 v240, v240, s97, v12
    s_waitcnt vmcnt(12)
    v_cmp_gt_u32 vcc, 3, v21
    s_nop 0
    s_cbranch_vccnz L_slowB4
L_okB4:
    v_mfma_f32_16x16x32_bf16 v[128:131], v[32:35], a[96:99], v[128:131]
    ds_read_b64_tr_b16 v[48:49], v102 offset:49152
    v_exp_f32 v240, v240
    v_fma_f32 v241, v241, s97, v12
    s_waitcnt vmcnt(11)
    v_mfma_f32_16x16x32_bf16 v[128:131], v[36:39], a[112:115], v[128:131]
    ds_read_b64_tr_b16 v[50:51], v102 offset:51200
    buffer_load_dwordx4 v[112:115], v24, s[72:75], s13 offen offset:0 sc1
    v_mfma_f32_16x16x32_bf16 v[132:135], v[32:35], a[100:103], v[132:135]
    buffer_load_dwordx4 v[116:119], v24, s[72:75], s13 offen offset:16 sc1
    v_exp_f32 v241, v241
    v_fma_f32 v242, v242, s97, v12
    s_waitcnt vmcnt(12)
    v_mfma_f32_16x16x32_bf16 v[132:135], v[36:39], a[116:119], v[132:135]
    ds_read_b64_tr_b16 v[52:53], v98 offset:0
    v_exp_f32 v242, v242
    v_fma_f32 v243, v243, s97, v12
    v_mfma_f32_16x16x32_bf16 v[136:139], v[32:35], a[104:107], v[136:139]
    buffer_load_dwordx4 v[120:123], v24, s[72:75], s13 offen offset:1088 sc1
    v_exp_f32 v243, v243
    v_fma_f32 v244, v244, s97, v12
    s_waitcnt vmcnt(12)
    v_mfma_f32_16x16x32_bf16 v[136:139], v[36:39], a[120:123], v[136:139]
    buffer_load_dwordx4 v[124:127], v24, s[72:75], s13 offen offset:1104 sc1
    v_exp_f32 v244, v244
    v_fma_f32 v245, v245, s97, v12
    v_mfma_f32_16x16x32_bf16 v[140:143], v[32:35], a[108:111], v[140:143]
    buffer_load_dword v16, v25, s[72:75], s24 offen offset:0 sc1
    v_exp_f32 v245, v245
    v_fma_f32 v246, v246, s97, v12
    s_waitcnt vmcnt(13)
    v_mfma_f32_16x16x32_bf16 v[140:143], v[36:39], a[124:127], v[140:143]
    ds_read_b64_tr_b16 v[54:55], v98 offset:2048
    s_waitcnt lgkmcnt(4)
    v_exp_f32 v246, v246
    v_mfma_f32_16x16x32_bf16 v[144:147], v[40:43], a[96:99], v[144:147]
    ds_read_b64_tr_b16 v[32:33], v103 offset:49152
    v_fma_f32 v247, v247, s97, v12
    v_exp_f32 v247, v247
    v_mfma_f32_16x16x32_bf16 v[144:147], v[44:47], a[112:115], v[144:147]
    ds_read_b64_tr_b16 v[34:35], v103 offset:51200
    buffer_load_dword v17, v25, s[72:75], s24 offen offset:128 sc1
    v_mfma_f32_16x16x32_bf16 v[148:151], v[40:43], a[100:103], v[148:151]
    s_add_u32 s25, s15, 8192
    buffer_load_dwordx4 a[128:131], v108, s[72:75], s25 offen sc1
    v_mfma_f32_16x16x32_bf16 v[148:151], v[44:47], a[116:119], v[148:151]
    ds_read_b64_tr_b16 v[36:37], v99 offset:0
    v_fma_f32 v248, v248, s97, v12
    v_exp_f32 v248, v248
    v_fma_f32 v249, v249, s97, v12
    v_mfma_f32_16x16x32_bf16 v[152:155], v[40:43], a[104:107], v[152:155]
    buffer_load_dwordx4 a[132:135], v109, s[72:75], s25 offen sc1
    v_exp_f32 v249, v249
    v_fma_f32 v250, v250, s97, v12
    v_fma_f32 v251, v251, s97, v12
    v_mfma_f32_16x16x32_bf16 v[152:155], v[44:47], a[120:123], v[152:155]
    buffer_load_dwordx4 a[136:139], v110, s[72:75], s25 offen sc1
    v_exp_f32 v250, v250
    v_fma_f32 v252, v252, s97, v12
    v_mfma_f32_16x16x32_bf16 v[156:159], v[40:43], a[108:111], v[156:159]
    buffer_load_dwordx4 a[140:143], v111, s[72:75], s25 offen sc1
    s_add_u32 s25, s15, 12288
    v_exp_f32 v251, v251
    v_mfma_f32_16x16x32_bf16 v[156:159], v[44:47], a[124:127], v[156:159]
    ds_read_b64_tr_b16 v[38:39], v99 offset:2048
    s_waitcnt lgkmcnt(4)
    v_exp_f32 v252, v252
    v_fma_f32 v253, v253, s97, v12
    v_mfma_f32_16x16x32_bf16 v[160:163], v[48:51], a[96:99], v[160:163]
    ds_read_b64_tr_b16 v[40:41], v96 offset:16384
    v_exp_f32 v253, v253
    v_fma_f32 v254, v254, s97, v12
    v_fma_f32 v255, v255, s97, v12
    v_mfma_f32_16x16x32_bf16 v[160:163], v[52:55], a[112:115], v[160:163]
    buffer_load_dwordx4 a[144:147], v108, s[72:75], s25 offen sc1
    v_exp_f32 v254, v254
    v_add_f32 v13, v240, v241
    v_mfma_f32_16x16x32_bf16 v[164:167], v[48:51], a[100:103], v[164:167]
    ds_read_b64_tr_b16 v[42:43], v96 offset:18432
    v_exp_f32 v255, v255
    v_add_f32 v13, v13, v242
    v_mfma_f32_16x16x32_bf16 v[164:167], v[52:55], a[116:119], v[164:167]
    buffer_load_dwordx4 a[148:151], v109, s[72:75], s25 offen sc1
    v_add_f32 v13, v13, v243
    v_add_f32 v13, v13, v244
    v_add_f32 v13, v13, v245
    v_mfma_f32_16x16x32_bf16 v[168:171], v[48:51], a[104:107], v[168:171]
    ds_read_b64_tr_b16 v[44:45], v96 offset:32768
    v_add_f32 v13, v13, v246
    v_add_f32 v13, v13, v247
    v_add_f32 v13, v13, v248
    v_mfma_f32_16x16x32_bf16 v[168:171], v[52:55], a[120:123], v[168:171]
    buffer_load_dwordx4 a[152:155], v110, s[72:75], s25 offen sc1
    v_add_f32 v13, v13, v249
    v_add_f32 v13, v13, v250
    v_add_f32 v13, v13, v251
    v_mfma_f32_16x16x32_bf16 v[172:175], v[48:51], a[108:111], v[172:175]
    buffer_load_dwordx4 a[156:159], v111, s[72:75], s25 offen sc1
    s_add_u32 s25, s15, 49152
    v_add_f32 v13, v13, v252
    v_add_f32 v13, v13, v253
    v_mfma_f32_16x16x32_bf16 v[172:175], v[52:55], a[124:127], v[172:175]
    ds_read_b64_tr_b16 v[46:47], v96 offset:34816
    s_waitcnt lgkmcnt(4)
    v_add_f32 v13, v13, v254
    v_add_f32 v13, v13, v255
    v_mfma_f32_16x16x32_bf16 v[176:179], v[32:35], a[96:99], v[176:179]
    ds_read_b64_tr_b16 v[48:49], v97 offset:16384
    v_rcp_f32 v13, v13
    v_mfma_f32_16x16x32_bf16 v[176:179], v[36:39], a[112:115], v[176:179]
    buffer_load_dwordx4 a[160:163], v108, s[72:75], s25 offen sc1
    v_mul_f32 v240, v240, v13
    v_mul_f32 v241, v241, v13
    v_mul_f32 v242, v242, v13
    v_mul_f32 v243, v243, v13
    v_mfma_f32_16x16x32_bf16 v[180:183], v[32:35], a[100:103], v[180:183]
    ds_read_b64_tr_b16 v[50:51], v97 offset:18432
    v_mul_f32 v244, v244, v13
    v_mul_f32 v245, v245, v13
    v_mul_f32 v246, v246, v13
    v_mul_f32 v247, v247, v13
    v_mfma_f32_16x16x32_bf16 v[180:183], v[36:39], a[116:119], v[180:183]
    buffer_load_dwordx4 a[164:167], v109, s[72:75], s25 offen sc1
    v_mul_f32 v248, v248, v13
    v_mul_f32 v249, v249, v13
    v_mul_f32 v250, v250, v13
    v_mul_f32 v251, v251, v13
    v_mfma_f32_16x16x32_bf16 v[184:187], v[32:35], a[104:107], v[184:187]
    ds_read_b64_tr_b16 v[52:53], v97 offset:32768
    v_mul_f32 v252, v252, v13
    v_mul_f32 v253, v253, v13
    v_mul_f32 v254, v254, v13
    v_mfma_f32_16x16x32_bf16 v[184:187], v[36:39], a[120:123], v[184:187]
    buffer_load_dwordx4 a[168:171], v110, s[72:75], s25 offen sc1
    v_mul_f32 v255, v255, v13
    v_cvt_pk_bf16_f32 v216, v240, v241
    v_cvt_pk_bf16_f32 v217, v242, v243
    v_mfma_f32_16x16x32_bf16 v[188:191], v[32:35], a[108:111], v[188:191]
    buffer_load_dwordx4 a[172:175], v111, s[72:75], s25 offen sc1
    v_cvt_pk_bf16_f32 v218, v244, v245
    v_cvt_pk_bf16_f32 v219, v246, v247
    v_cvt_pk_bf16_f32 v220, v248, v249
    v_mfma_f32_16x16x32_bf16 v[188:191], v[36:39], a[124:127], v[188:191]
    ds_read_b64_tr_b16 v[54:55], v97 offset:34816
    s_waitcnt lgkmcnt(4)
    v_cvt_pk_bf16_f32 v221, v250, v251
    v_cvt_pk_bf16_f32 v222, v252, v253
    v_cvt_pk_bf16_f32 v223, v254, v255
    s_add_u32 s25, s15, 53248
    buffer_load_dwordx4 a[176:179], v108, s[72:75], s25 offen sc1
    buffer_load_dwordx4 a[180:183], v109, s[72:75], s25 offen sc1
    buffer_load_dwordx4 a[184:187], v110, s[72:75], s25 offen sc1
    buffer_load_dwordx4 a[188:191], v111, s[72:75], s25 offen sc1
    v_lshlrev_b32 v1, 3, v0
    v_sub_u32 v56, v108, v1
    v_sub_u32 v57, v109, v1
    v_sub_u32 v58, v110, v1
    v_sub_u32 v59, v111, v1
    s_waitcnt vmcnt(21)
    v_max3_u32 v12, v112, v113, v114
    s_waitcnt vmcnt(20)
    v_max3_u32 v12, v12, v115, v116
    v_max3_u32 v12, v12, v117, v118
    s_waitcnt vmcnt(19)
    v_max3_u32 v12, v12, v119, v120
    v_max3_u32 v12, v12, v121, v122
    s_waitcnt vmcnt(18)
    v_max3_u32 v12, v12, v123, v124
    v_max3_u32 v12, v12, v125, v126
    v_max_u32 v12, v12, v127
    v_cmp_eq_u32 vcc, -1, v12
    s_nop 0
    s_cbranch_vccnz L_slowkv
L_okkv:
    buffer_load_dword v22, v18, s[72:75], 0 offen sc1
    v_mfma_f32_32x32x16_bf16 v[224:239], v[112:115], v[192:195], 0
    v_mfma_f32_32x32x16_bf16 v[224:239], v[116:119], v[196:199], v[224:239]
    v_mfma_f32_32x32x16_bf16 v[240:255], v[120:123], v[200:203], 0
    v_mfma_f32_32x32x16_bf16 v[240:255], v[124:127], v[204:207], v[240:255]
    s_nop 9
    v_add_f32 v232, 0x358637bd, v232
    v_rcp_f32 v232, v232
    s_waitcnt vmcnt(18)
    v_mul_f32 v232, v232, v16
    v_mul_f32 v224, v224, v232
    v_mul_f32 v225, v225, v232
    s_add_u32 m0, s96, 81920
    s_add_u32 s99, s17, 229376
    buffer_load_dwordx4 v5, s[56:59], s99 offen lds
    v_mul_f32 v226, v226, v232
    v_mul_f32 v227, v227, v232
    v_mul_f32 v228, v228, v232
    v_mul_f32 v229, v229, v232
    v_mul_f32 v230, v230, v232
    v_mul_f32 v231, v231, v232
    v_cvt_pk_bf16_f32 v64, v224, v225
    v_cvt_pk_bf16_f32 v65, v226, v227
    v_cvt_pk_bf16_f32 v66, v228, v229
    v_cvt_pk_bf16_f32 v67, v230, v231
    v_add_f32 v248, 0x358637bd, v248
    v_rcp_f32 v248, v248
    s_nop 0
    v_mul_f32 v248, v248, v16
    buffer_load_dwordx4 v6, s[56:59], s99 offen offset:1024 lds
    v_mul_f32 v240, v240, v248
    v_mul_f32 v241, v241, v248
    v_mul_f32 v242, v242, v248
    v_mul_f32 v243, v243, v248
    v_mul_f32 v244, v244, v248
    v_mul_f32 v245, v245, v248
    v_mul_f32 v246, v246, v248
    v_mul_f32 v247, v247, v248
    v_cvt_pk_bf16_f32 v68, v240, v241
    v_cvt_pk_bf16_f32 v69, v242, v243
    v_cvt_pk_bf16_f32 v70, v244, v245
    v_cvt_pk_bf16_f32 v71, v246, v247
    v_permlane16_swap_b32 v64, v68
    v_permlane16_swap_b32 v65, v69
    buffer_load_dwordx4 v5, s[60:63], s99 offen offset:2048 lds
    v_permlane16_swap_b32 v66, v70
    v_permlane16_swap_b32 v67, v71
    buffer_store_dwordx4 v[64:67], v11, s[72:75], s23 offen offset:0 sc1
    buffer_store_dwordx4 v[68:71], v11, s[72:75], s23 offen offset:1024 sc1
    v_mfma_f32_32x32x16_bf16 v[224:239], v[112:115], v[208:211], 0
    v_mfma_f32_32x32x16_bf16 v[224:239], v[116:119], v[212:215], v[224:239]
    v_mfma_f32_32x32x16_bf16 v[240:255], v[120:123], v[216:219], 0
    v_mfma_f32_32x32x16_bf16 v[240:255], v[124:127], v[220:223], v[240:255]
    buffer_load_dwordx4 v6, s[60:63], s99 offen offset:3072 lds
    s_nop 8
    v_add_f32 v232, 0x358637bd, v232
    v_rcp_f32 v232, v232
    s_waitcnt vmcnt(23)
    v_mul_f32 v232, v232, v17
    v_mul_f32 v224, v224, v232
    v_mul_f32 v225, v225, v232
    v_mul_f32 v226, v226, v232
    v_mul_f32 v227, v227, v232
    v_mul_f32 v228, v228, v232
    v_mul_f32 v229, v229, v232
    v_mul_f32 v230, v230, v232
    v_mul_f32 v231, v231, v232
    v_cvt_pk_bf16_f32 v72, v224, v225
    v_cvt_pk_bf16_f32 v73, v226, v227
    v_cvt_pk_bf16_f32 v74, v228, v229
    v_cvt_pk_bf16_f32 v75, v230, v231
    v_add_f32 v248, 0x358637bd, v248
    v_rcp_f32 v248, v248
    s_nop 0
    v_mul_f32 v248, v248, v17
    v_mul_f32 v240, v240, v248
    v_mul_f32 v241, v241, v248
    v_mul_f32 v242, v242, v248
    v_mul_f32 v243, v243, v248
    v_mul_f32 v244, v244, v248
    v_mul_f32 v245, v245, v248
    v_mul_f32 v246, v246, v248
    v_mul_f32 v247, v247, v248
    v_cvt_pk_bf16_f32 v76, v240, v241
    v_cvt_pk_bf16_f32 v77, v242, v243
    v_cvt_pk_bf16_f32 v78, v244, v245
    v_cvt_pk_bf16_f32 v79, v246, v247
    v_permlane16_swap_b32 v72, v76
    v_permlane16_swap_b32 v73, v77
    v_permlane16_swap_b32 v74, v78
    v_permlane16_swap_b32 v75, v79
    buffer_store_dwordx4 v[72:75], v11, s[72:75], s23 offen offset:2048 sc1
    buffer_store_dwordx4 v[76:79], v11, s[72:75], s23 offen offset:3072 sc1
    s_waitcnt vmcnt(8)
    v_cmp_gt_u32 vcc, 3, v22
    s_nop 0
    s_cbranch_vccnz L_slowB5
L_okB5:
    v_mfma_f32_16x16x32_bf16 v[128:131], v[40:43], a[128:131], v[128:131]
    ds_read_b64_tr_b16 v[32:33], v98 offset:16384
    s_add_u32 s25, s15, 24576
    buffer_load_dwordx2 a[192:193], v56, s[72:75], s25 offen sc1
    v_mfma_f32_16x16x32_bf16 v[128:131], v[44:47], a[144:147], v[128:131]
    ds_read_b64_tr_b16 v[34:35], v98 offset:18432
    buffer_load_dwordx2 a[194:195], v56, s[72:75], s25 offen offset:512 sc1
    v_mfma_f32_16x16x32_bf16 v[132:135], v[40:43], a[132:135], v[132:135]
    ds_read_b64_tr_b16 v[36:37], v98 offset:32768
    buffer_load_dwordx2 a[196:197], v57, s[72:75], s25 offen sc1
    v_mfma_f32_16x16x32_bf16 v[132:135], v[44:47], a[148:151], v[132:135]
    ds_read_b64_tr_b16 v[38:39], v98 offset:34816
    buffer_load_dwordx2 a[198:199], v57, s[72:75], s25 offen offset:512 sc1
    v_mfma_f32_16x16x32_bf16 v[136:139], v[40:43], a[136:139], v[136:139]
    buffer_load_dwordx2 a[200:201], v58, s[72:75], s25 offen sc1
    v_mfma_f32_16x16x32_bf16 v[136:139], v[44:47], a[152:155], v[136:139]
    buffer_load_dwordx2 a[202:203], v58, s[72:75], s25 offen offset:512 sc1
    v_mfma_f32_16x16x32_bf16 v[140:143], v[40:43], a[140:143], v[140:143]
    buffer_load_dwordx2 a[204:205], v59, s[72:75], s25 offen sc1
    v_mfma_f32_16x16x32_bf16 v[140:143], v[44:47], a[156:159], v[140:143]
    buffer_load_dwordx2 a[206:207], v59, s[72:75], s25 offen offset:512 sc1
    s_waitcnt lgkmcnt(4)
    v_mfma_f32_16x16x32_bf16 v[144:147], v[48:51], a[128:131], v[144:147]
    ds_read_b64_tr_b16 v[40:41], v99 offset:16384
    s_add_u32 s25, s15, 28672
    buffer_load_dwordx2 a[208:209], v56, s[72:75], s25 offen sc1
    v_mfma_f32_16x16x32_bf16 v[144:147], v[52:55], a[144:147], v[144:147]
    ds_read_b64_tr_b16 v[42:43], v99 offset:18432
    buffer_load_dwordx2 a[210:211], v56, s[72:75], s25 offen offset:512 sc1
    v_mfma_f32_16x16x32_bf16 v[148:151], v[48:51], a[132:135], v[148:151]
    ds_read_b64_tr_b16 v[44:45], v99 offset:32768
    buffer_load_dwordx2 a[212:213], v57, s[72:75], s25 offen sc1
    v_mfma_f32_16x16x32_bf16 v[148:151], v[52:55], a[148:151], v[148:151]
    ds_read_b64_tr_b16 v[46:47], v99 offset:34816
    buffer_load_dwordx2 a[214:215], v57, s[72:75], s25 offen offset:512 sc1
    v_mfma_f32_16x16x32_bf16 v[152:155], v[48:51], a[136:139], v[152:155]
    buffer_load_dwordx2 a[216:217], v58, s[72:75], s25 offen sc1
    v_mfma_f32_16x16x32_bf16 v[152:155], v[52:55], a[152:155], v[152:155]
    buffer_load_dwordx2 a[218:219], v58, s[72:75], s25 offen offset:512 sc1
    v_mfma_f32_16x16x32_bf16 v[156:159], v[48:51], a[140:143], v[156:159]
    buffer_load_dwordx2 a[220:221], v59, s[72:75], s25 offen sc1
    v_mfma_f32_16x16x32_bf16 v[156:159], v[52:55], a[156:159], v[156:159]
    buffer_load_dwordx2 a[222:223], v59, s[72:75], s25 offen offset:512 sc1
    s_waitcnt lgkmcnt(4)
    v_cmp_gt_u32 vcc, 1, v23
    s_nop 0
    s_cbranch_vccnz L_slowB6
L_okB6:
    v_mfma_f32_16x16x32_bf16 v[160:163], v[32:35], a[128:131], v[160:163]
    ds_read_b64_tr_b16 v[48:49], v104 offset:0
    v_and_b32 v1, 15, v0
    v_mfma_f32_16x16x32_bf16 v[160:163], v[36:39], a[144:147], v[160:163]
    ds_read_b64_tr_b16 v[50:51], v104 offset:2048
    v_lshlrev_b32 v1, 2, v1
    v_mfma_f32_16x16x32_bf16 v[164:167], v[32:35], a[132:135], v[164:167]
    ds_read_b64_tr_b16 v[52:53], v104 offset:16384
    s_lshl_b32 s100, s7, 6
    v_add_u32 v1, s100, v1
    v_mfma_f32_16x16x32_bf16 v[164:167], v[36:39], a[148:151], v[164:167]
    ds_read_b64_tr_b16 v[54:55], v104 offset:18432
    s_lshl_b32 s100, s94, 8
    s_add_u32 s100, s100, 10485760
    v_xor_b32 v2, 0, v1
    v_mfma_f32_16x16x32_bf16 v[168:171], v[32:35], a[136:139], v[168:171]
    buffer_load_dword v28, v2, s[72:75], s100 offen sc1
    v_mfma_f32_16x16x32_bf16 v[168:171], v[36:39], a[152:155], v[168:171]
    v_xor_b32 v2, 64, v1
    v_mfma_f32_16x16x32_bf16 v[172:175], v[32:35], a[140:143], v[172:175]
    buffer_load_dword v29, v2, s[72:75], s100 offen sc1
    v_mfma_f32_16x16x32_bf16 v[172:175], v[36:39], a[156:159], v[172:175]
    v_xor_b32 v2, 128, v1
    s_waitcnt lgkmcnt(4)
    v_mfma_f32_16x16x32_bf16 v[176:179], v[40:43], a[128:131], v[176:179]
    ds_read_b64_tr_b16 v[32:33], v105 offset:0
    buffer_load_dword v30, v2, s[72:75], s100 offen sc1
    v_mfma_f32_16x16x32_bf16 v[176:179], v[44:47], a[144:147], v[176:179]
    ds_read_b64_tr_b16 v[34:35], v105 offset:2048
    v_xor_b32 v2, 192, v1
    v_mfma_f32_16x16x32_bf16 v[180:183], v[40:43], a[132:135], v[180:183]
    ds_read_b64_tr_b16 v[36:37], v105 offset:16384
    buffer_load_dword v31, v2, s[72:75], s100 offen sc1
    v_mfma_f32_16x16x32_bf16 v[180:183], v[44:47], a[148:151], v[180:183]
    s_add_u32 m0, s96, 65536
    s_add_u32 s99, s18, 0
    buffer_load_dwordx4 v14, s[64:67], s99 offen lds
    v_mfma_f32_16x16x32_bf16 v[184:187], v[40:43], a[136:139], v[184:187]
    buffer_load_dwordx4 v15, s[64:67], s99 offen offset:1024 lds
    v_mfma_f32_16x16x32_bf16 v[184:187], v[44:47], a[152:155], v[184:187]
    buffer_load_dwordx4 v14, s[68:71], s99 offen offset:2048 lds
    v_mfma_f32_16x16x32_bf16 v[188:191], v[40:43], a[140:143], v[188:191]
    buffer_load_dwordx4 v15, s[68:71], s99 offen offset:3072 lds
    v_mfma_f32_16x16x32_bf16 v[188:191], v[44:47], a[156:159], v[188:191]
    ds_read_b64_tr_b16 v[38:39], v105 offset:18432
    s_waitcnt lgkmcnt(4)
    v_mfma_f32_16x16x32_bf16 v[128:131], v[48:51], a[160:163], v[128:131]
    ds_read_b64_tr_b16 v[40:41], v106 offset:0
    s_add_u32 m0, s96, 49152
    v_mfma_f32_16x16x32_bf16 v[128:131], v[52:55], a[176:179], v[128:131]
    s_add_u32 s99, s18, 32768
    buffer_load_dwordx4 v14, s[64:67], s99 offen lds
    v_mfma_f32_16x16x32_bf16 v[132:135], v[48:51], a[164:167], v[132:135]
    ds_read_b64_tr_b16 v[42:43], v106 offset:2048
    v_mfma_f32_16x16x32_bf16 v[132:135], v[52:55], a[180:183], v[132:135]
    buffer_load_dwordx4 v15, s[64:67], s99 offen offset:1024 lds
    v_mfma_f32_16x16x32_bf16 v[136:139], v[48:51], a[168:171], v[136:139]
    ds_read_b64_tr_b16 v[44:45], v106 offset:16384
    v_mfma_f32_16x16x32_bf16 v[136:139], v[52:55], a[184:187], v[136:139]
    buffer_load_dwordx4 v14, s[68:71], s99 offen offset:2048 lds
    v_mfma_f32_16x16x32_bf16 v[140:143], v[48:51], a[172:175], v[140:143]
    buffer_load_dwordx4 v15, s[68:71], s99 offen offset:3072 lds
    s_add_u32 s25, s16, 0
    v_mfma_f32_16x16x32_bf16 v[140:143], v[52:55], a[188:191], v[140:143]
    ds_read_b64_tr_b16 v[46:47], v106 offset:18432
    s_waitcnt lgkmcnt(4)
    v_mfma_f32_16x16x32_bf16 v[144:147], v[32:35], a[160:163], v[144:147]
    ds_read_b64_tr_b16 v[48:49], v107 offset:0
    v_mfma_f32_16x16x32_bf16 v[144:147], v[36:39], a[176:179], v[144:147]
    buffer_load_dwordx4 a[224:227], v108, s[72:75], s25 offen sc1
    v_mfma_f32_16x16x32_bf16 v[148:151], v[32:35], a[164:167], v[148:151]
    ds_read_b64_tr_b16 v[50:51], v107 offset:2048
    v_mfma_f32_16x16x32_bf16 v[148:151], v[36:39], a[180:183], v[148:151]
    buffer_load_dwordx4 a[228:231], v109, s[72:75], s25 offen sc1
    v_mfma_f32_16x16x32_bf16 v[152:155], v[32:35], a[168:171], v[152:155]
    ds_read_b64_tr_b16 v[52:53], v107 offset:16384
    v_mfma_f32_16x16x32_bf16 v[152:155], v[36:39], a[184:187], v[152:155]
    buffer_load_dwordx4 a[232:235], v110, s[72:75], s25 offen sc1
    v_mfma_f32_16x16x32_bf16 v[156:159], v[32:35], a[172:175], v[156:159]
    buffer_load_dwordx4 a[236:239], v111, s[72:75], s25 offen sc1
    s_add_u32 s25, s16, 4096
    v_mfma_f32_16x16x32_bf16 v[156:159], v[36:39], a[188:191], v[156:159]
    ds_read_b64_tr_b16 v[54:55], v107 offset:18432
    s_waitcnt lgkmcnt(4)
    v_mfma_f32_16x16x32_bf16 v[160:163], v[40:43], a[160:163], v[160:163]
    ds_read_b64_tr_b16 v[32:33], v100 offset:32768
    v_mfma_f32_16x16x32_bf16 v[160:163], v[44:47], a[176:179], v[160:163]
    buffer_load_dwordx4 a[240:243], v108, s[72:75], s25 offen sc1
    v_mfma_f32_16x16x32_bf16 v[164:167], v[40:43], a[164:167], v[164:167]
    ds_read_b64_tr_b16 v[34:35], v100 offset:34816
    v_mfma_f32_16x16x32_bf16 v[164:167], v[44:47], a[180:183], v[164:167]
    buffer_load_dwordx4 a[244:247], v109, s[72:75], s25 offen sc1
    v_mfma_f32_16x16x32_bf16 v[168:171], v[40:43], a[168:171], v[168:171]
    s_waitcnt vmcnt(36)
    ds_read_b64_tr_b16 v[36:37], v100 offset:16384
    v_mfma_f32_16x16x32_bf16 v[168:171], v[44:47], a[184:187], v[168:171]
    buffer_load_dwordx4 a[248:251], v110, s[72:75], s25 offen sc1
    v_mfma_f32_16x16x32_bf16 v[172:175], v[40:43], a[172:175], v[172:175]
    buffer_load_dwordx4 a[252:255], v111, s[72:75], s25 offen sc1
    s_add_u32 m0, s96, 114688
    v_mfma_f32_16x16x32_bf16 v[172:175], v[44:47], a[188:191], v[172:175]
    ds_read_b64_tr_b16 v[38:39], v100 offset:18432
    s_waitcnt lgkmcnt(4)
    v_mfma_f32_16x16x32_bf16 v[176:179], v[48:51], a[160:163], v[176:179]
    ds_read_b64_tr_b16 v[40:41], v101 offset:32768
    s_add_u32 s99, s18, 65536
    v_mfma_f32_16x16x32_bf16 v[176:179], v[52:55], a[176:179], v[176:179]
    buffer_load_dwordx4 v14, s[64:67], s99 offen lds
    v_mfma_f32_16x16x32_bf16 v[180:183], v[48:51], a[164:167], v[180:183]
    ds_read_b64_tr_b16 v[42:43], v101 offset:34816
    v_mfma_f32_16x16x32_bf16 v[180:183], v[52:55], a[180:183], v[180:183]
    buffer_load_dwordx4 v15, s[64:67], s99 offen offset:1024 lds
    v_mfma_f32_16x16x32_bf16 v[184:187], v[48:51], a[168:171], v[184:187]
    ds_read_b64_tr_b16 v[44:45], v101 offset:16384
    v_mfma_f32_16x16x32_bf16 v[184:187], v[52:55], a[184:187], v[184:187]
    buffer_load_dwordx4 v14, s[68:71], s99 offen offset:2048 lds
    v_mfma_f32_16x16x32_bf16 v[188:191], v[48:51], a[172:175], v[188:191]
    buffer_load_dwordx4 v15, s[68:71], s99 offen offset:3072 lds
    v_mfma_f32_16x16x32_bf16 v[188:191], v[52:55], a[188:191], v[188:191]
    ds_read_b64_tr_b16 v[46:47], v101 offset:18432
    s_waitcnt lgkmcnt(4)
    s_waitcnt vmcnt(23)
    v_sub_f32 v28, 1.0, v28
    s_waitcnt vmcnt(22)
    v_sub_f32 v29, 1.0, v29
    s_waitcnt vmcnt(21)
    v_sub_f32 v30, 1.0, v30
    s_waitcnt vmcnt(20)
    v_sub_f32 v31, 1.0, v31
    v_mfma_f32_16x16x32_bf16 v[128:131], v[32:35], a[192:195], v[128:131]
    ds_read_b64_tr_b16 v[48:49], v102 offset:32768
    s_add_u32 m0, s96, 0
    v_mfma_f32_16x16x32_bf16 v[128:131], v[36:39], a[208:211], v[128:131]
    ds_read_b64_tr_b16 v[50:51], v102 offset:34816
    s_add_u32 s99, s18, 98304
    v_mfma_f32_16x16x32_bf16 v[132:135], v[32:35], a[196:199], v[132:135]
    buffer_load_dwordx4 v14, s[64:67], s99 offen lds
    v_mfma_f32_16x16x32_bf16 v[132:135], v[36:39], a[212:215], v[132:135]
    ds_read_b64_tr_b16 v[52:53], v102 offset:16384
    v_mfma_f32_16x16x32_bf16 v[136:139], v[32:35], a[200:203], v[136:139]
    buffer_load_dwordx4 v15, s[64:67], s99 offen offset:1024 lds
    v_mfma_f32_16x16x32_bf16 v[136:139], v[36:39], a[216:219], v[136:139]
    ds_read_b64_tr_b16 v[54:55], v102 offset:18432
    v_mfma_f32_16x16x32_bf16 v[140:143], v[32:35], a[204:207], v[140:143]
    buffer_load_dwordx4 v14, s[68:71], s99 offen offset:2048 lds
    v_mfma_f32_16x16x32_bf16 v[140:143], v[36:39], a[220:223], v[140:143]
    s_waitcnt lgkmcnt(4)
    v_mfma_f32_16x16x32_bf16 v[144:147], v[40:43], a[192:195], v[144:147]
    ds_read_b64_tr_b16 v[32:33], v103 offset:32768
    v_mul_f32 v128, v28, v128
    v_mfma_f32_16x16x32_bf16 v[144:147], v[44:47], a[208:211], v[144:147]
    ds_read_b64_tr_b16 v[34:35], v103 offset:34816
    v_mul_f32 v129, v28, v129
    v_mfma_f32_16x16x32_bf16 v[148:151], v[40:43], a[196:199], v[148:151]
    buffer_load_dwordx4 v15, s[68:71], s99 offen offset:3072 lds
    s_add_u32 s25, s16, 8192
    v_mfma_f32_16x16x32_bf16 v[148:151], v[44:47], a[212:215], v[148:151]
    ds_read_b64_tr_b16 v[36:37], v103 offset:16384
    v_mul_f32 v130, v28, v130
    v_mfma_f32_16x16x32_bf16 v[152:155], v[40:43], a[200:203], v[152:155]
    buffer_load_dwordx4 a[0:3], v108, s[72:75], s25 offen sc1
    v_mul_f32 v131, v28, v131
    v_mfma_f32_16x16x32_bf16 v[152:155], v[44:47], a[216:219], v[152:155]
    ds_read_b64_tr_b16 v[38:39], v103 offset:18432
    v_mul_f32 v132, v29, v132
    v_mfma_f32_16x16x32_bf16 v[156:159], v[40:43], a[204:207], v[156:159]
    buffer_load_dwordx4 a[4:7], v109, s[72:75], s25 offen sc1
    v_mul_f32 v133, v29, v133
    v_mfma_f32_16x16x32_bf16 v[156:159], v[44:47], a[220:223], v[156:159]
    s_waitcnt lgkmcnt(4)
    v_mul_f32 v134, v29, v134
    v_mul_f32 v135, v29, v135
    v_mfma_f32_16x16x32_bf16 v[160:163], v[48:51], a[192:195], v[160:163]
    s_waitcnt vmcnt(22)
    ds_read_b64_tr_b16 v[40:41], v100 offset:0
    v_mul_f32 v144, v28, v144
    v_mfma_f32_16x16x32_bf16 v[160:163], v[52:55], a[208:211], v[160:163]
    ds_read_b64_tr_b16 v[42:43], v100 offset:2048
    v_mul_f32 v145, v28, v145
    v_mfma_f32_16x16x32_bf16 v[164:167], v[48:51], a[196:199], v[164:167]
    buffer_load_dwordx4 a[8:11], v110, s[72:75], s25 offen sc1
    v_mul_f32 v146, v28, v146
    v_mfma_f32_16x16x32_bf16 v[164:167], v[52:55], a[212:215], v[164:167]
    s_waitcnt vmcnt(19)
    ds_read_b64_tr_b16 v[44:45], v96 offset:49152
    v_mul_f32 v147, v28, v147
    v_mfma_f32_16x16x32_bf16 v[168:171], v[48:51], a[200:203], v[168:171]
    buffer_load_dwordx4 a[12:15], v111, s[72:75], s25 offen sc1
    s_add_u32 s25, s16, 12288
    v_mfma_f32_16x16x32_bf16 v[168:171], v[52:55], a[216:219], v[168:171]
    ds_read_b64_tr_b16 v[46:47], v96 offset:51200
    v_mul_f32 v148, v29, v148
    v_mfma_f32_16x16x32_bf16 v[172:175], v[48:51], a[204:207], v[172:175]
    buffer_load_dwordx4 a[16:19], v108, s[72:75], s25 offen sc1
    v_mul_f32 v149, v29, v149
    v_mfma_f32_16x16x32_bf16 v[172:175], v[52:55], a[220:223], v[172:175]
    s_waitcnt lgkmcnt(4)
    v_mul_f32 v150, v29, v150
    v_mul_f32 v151, v29, v151
    v_mfma_f32_16x16x32_bf16 v[176:179], v[32:35], a[192:195], v[176:179]
    ds_read_b64_tr_b16 v[48:49], v101 offset:0
    v_mul_f32 v160, v28, v160
    v_mfma_f32_16x16x32_bf16 v[176:179], v[36:39], a[208:211], v[176:179]
    ds_read_b64_tr_b16 v[50:51], v101 offset:2048
    v_mul_f32 v161, v28, v161
    v_mfma_f32_16x16x32_bf16 v[180:183], v[32:35], a[196:199], v[180:183]
    buffer_load_dwordx4 a[20:23], v109, s[72:75], s25 offen sc1
    v_mul_f32 v162, v28, v162
    v_mfma_f32_16x16x32_bf16 v[180:183], v[36:39], a[212:215], v[180:183]
    ds_read_b64_tr_b16 v[52:53], v97 offset:49152
    v_mul_f32 v163, v28, v163
    v_mfma_f32_16x16x32_bf16 v[184:187], v[32:35], a[200:203], v[184:187]
    buffer_load_dwordx4 a[24:27], v110, s[72:75], s25 offen sc1
    v_mul_f32 v164, v29, v164
    v_mfma_f32_16x16x32_bf16 v[184:187], v[36:39], a[216:219], v[184:187]
    ds_read_b64_tr_b16 v[54:55], v97 offset:51200
    v_mul_f32 v165, v29, v165
    v_mfma_f32_16x16x32_bf16 v[188:191], v[32:35], a[204:207], v[188:191]
    buffer_load_dwordx4 a[28:31], v111, s[72:75], s25 offen sc1
    v_mul_f32 v166, v29, v166
    v_mfma_f32_16x16x32_bf16 v[188:191], v[36:39], a[220:223], v[188:191]
    s_waitcnt lgkmcnt(4)
    v_mul_f32 v167, v29, v167
    v_mul_f32 v168, v30, v168
    s_waitcnt vmcnt(16)
    v_accvgpr_read_b32 v3, a224
    v_accvgpr_read_b32 v4, a228
    v_max_u32 v7, v3, v4
    v_accvgpr_read_b32 v3, a232
    v_accvgpr_read_b32 v4, a236
    v_max3_u32 v7, v7, v3, v4
    v_accvgpr_read_b32 v3, a240
    v_accvgpr_read_b32 v4, a244
    v_max3_u32 v7, v7, v3, v4
    v_accvgpr_read_b32 v3, a248
    v_accvgpr_read_b32 v4, a252
    v_max3_u32 v7, v7, v3, v4
    v_cmp_eq_u32 vcc, -1, v7
    s_nop 0
    s_cbranch_vccnz L_slowfcB7
L_okfcB7:
    v_mul_f32 v136, v30, v136
    v_mul_f32 v137, v30, v137
    v_mul_f32 v138, v30, v138
    v_mul_f32 v139, v30, v139
    v_mul_f32 v140, v31, v140
    v_mul_f32 v141, v31, v141
    v_mul_f32 v142, v31, v142
    v_mul_f32 v143, v31, v143
    v_mfma_f32_16x16x32_bf16 v[128:131], v[40:43], a[224:227], v[128:131]
    ds_read_b64_tr_b16 v[32:33], v102 offset:0
    v_mul_f32 v176, v28, v176
    v_mfma_f32_16x16x32_bf16 v[128:131], v[44:47], a[240:243], v[128:131]
    ds_read_b64_tr_b16 v[34:35], v102 offset:2048
    v_mul_f32 v177, v28, v177
    v_mfma_f32_16x16x32_bf16 v[132:135], v[40:43], a[228:231], v[132:135]
    ds_read_b64_tr_b16 v[36:37], v98 offset:49152
    v_mul_f32 v178, v28, v178
    v_mfma_f32_16x16x32_bf16 v[132:135], v[44:47], a[244:247], v[132:135]
    ds_read_b64_tr_b16 v[38:39], v98 offset:51200
    v_mul_f32 v179, v28, v179
    v_mfma_f32_16x16x32_bf16 v[136:139], v[40:43], a[232:235], v[136:139]
    v_mul_f32 v180, v29, v180
    v_mul_f32 v181, v29, v181
    v_mfma_f32_16x16x32_bf16 v[136:139], v[44:47], a[248:251], v[136:139]
    v_mul_f32 v182, v29, v182
    v_mul_f32 v183, v29, v183
    v_mfma_f32_16x16x32_bf16 v[140:143], v[40:43], a[236:239], v[140:143]
    v_mul_f32 v184, v30, v184
    v_mul_f32 v185, v30, v185
    v_mfma_f32_16x16x32_bf16 v[140:143], v[44:47], a[252:255], v[140:143]
    s_waitcnt lgkmcnt(4)
    v_mul_f32 v186, v30, v186
    v_mul_f32 v187, v30, v187
    v_mul_f32 v152, v30, v152
    v_mul_f32 v153, v30, v153
    v_mul_f32 v154, v30, v154
    v_mul_f32 v155, v30, v155
    v_mul_f32 v156, v31, v156
    v_mul_f32 v157, v31, v157
    v_mul_f32 v158, v31, v158
    v_mul_f32 v159, v31, v159
    v_mfma_f32_16x16x32_bf16 v[144:147], v[48:51], a[224:227], v[144:147]
    ds_read_b64_tr_b16 v[40:41], v103 offset:0
    v_mul_f32 v188, v31, v188
    v_mfma_f32_16x16x32_bf16 v[144:147], v[52:55], a[240:243], v[144:147]
    ds_read_b64_tr_b16 v[42:43], v103 offset:2048
    v_mul_f32 v189, v31, v189
    v_mfma_f32_16x16x32_bf16 v[148:151], v[48:51], a[228:231], v[148:151]
    ds_read_b64_tr_b16 v[44:45], v99 offset:49152
    v_mul_f32 v190, v31, v190
    v_mfma_f32_16x16x32_bf16 v[148:151], v[52:55], a[244:247], v[148:151]
    ds_read_b64_tr_b16 v[46:47], v99 offset:51200
    v_mul_f32 v191, v31, v191
    v_mfma_f32_16x16x32_bf16 v[152:155], v[48:51], a[232:235], v[152:155]
    s_lshl_b32 s100, s7, 14
    v_mul_f32 v169, v30, v169
    v_mul_f32 v170, v30, v170
    v_mfma_f32_16x16x32_bf16 v[152:155], v[52:55], a[248:251], v[152:155]
    v_mul_f32 v171, v30, v171
    v_mul_f32 v172, v31, v172
    v_mfma_f32_16x16x32_bf16 v[156:159], v[48:51], a[236:239], v[156:159]
    v_mul_f32 v173, v31, v173
    v_mul_f32 v174, v31, v174
    v_mfma_f32_16x16x32_bf16 v[156:159], v[52:55], a[252:255], v[156:159]
    s_waitcnt lgkmcnt(4)
    v_mul_f32 v175, v31, v175
    v_add_u32 v224, s96, v11
    v_mfma_f32_16x16x32_bf16 v[160:163], v[32:35], a[224:227], v[160:163]
    s_waitcnt vmcnt(12)
    ds_read_b64_tr_b16 v[48:49], v100 offset:49152
    v_xor_b32 v225, 4096, v224
    v_mfma_f32_16x16x32_bf16 v[160:163], v[36:39], a[240:243], v[160:163]
    ds_read_b64_tr_b16 v[50:51], v100 offset:51200
    v_xor_b32 v226, 8192, v224
    v_mfma_f32_16x16x32_bf16 v[164:167], v[32:35], a[228:231], v[164:167]
    s_waitcnt vmcnt(8)
    ds_read_b64_tr_b16 v[52:53], v96 offset:0
    v_xor_b32 v227, 12288, v224
    v_mfma_f32_16x16x32_bf16 v[164:167], v[36:39], a[244:247], v[164:167]
    ds_read_b64_tr_b16 v[54:55], v96 offset:2048
    v_and_b32 v228, 15, v0
    v_mfma_f32_16x16x32_bf16 v[168:171], v[32:35], a[232:235], v[168:171]
    v_lshlrev_b32 v228, 10, v228
    v_bfe_u32 v229, v0, 4, 1
    v_mfma_f32_16x16x32_bf16 v[168:171], v[36:39], a[248:251], v[168:171]
    v_lshl_add_u32 v228, v229, 5, v228
    v_lshrrev_b32 v229, 5, v0
    v_mfma_f32_16x16x32_bf16 v[172:175], v[32:35], a[236:239], v[172:175]
    v_lshl_add_u32 v228, v229, 4, v228
    v_mfma_f32_16x16x32_bf16 v[172:175], v[36:39], a[252:255], v[172:175]
    s_waitcnt lgkmcnt(4)
    v_mfma_f32_16x16x32_bf16 v[176:179], v[40:43], a[224:227], v[176:179]
    ds_read_b64_tr_b16 v[32:33], v101 offset:49152
    v_mfma_f32_16x16x32_bf16 v[176:179], v[44:47], a[240:243], v[176:179]
    ds_read_b64_tr_b16 v[34:35], v101 offset:51200
    v_mfma_f32_16x16x32_bf16 v[180:183], v[40:43], a[228:231], v[180:183]
    ds_read_b64_tr_b16 v[36:37], v97 offset:0
    v_mfma_f32_16x16x32_bf16 v[180:183], v[44:47], a[244:247], v[180:183]
    ds_read_b64_tr_b16 v[38:39], v97 offset:2048
    v_mfma_f32_16x16x32_bf16 v[184:187], v[40:43], a[232:235], v[184:187]
    v_mfma_f32_16x16x32_bf16 v[184:187], v[44:47], a[248:251], v[184:187]
    v_mfma_f32_16x16x32_bf16 v[188:191], v[40:43], a[236:239], v[188:191]
    v_mfma_f32_16x16x32_bf16 v[188:191], v[44:47], a[252:255], v[188:191]
    s_waitcnt lgkmcnt(4)
    s_waitcnt vmcnt(0)
    v_accvgpr_read_b32 v3, a0
    v_accvgpr_read_b32 v4, a4
    v_max_u32 v7, v3, v4
    v_accvgpr_read_b32 v3, a8
    v_accvgpr_read_b32 v4, a12
    v_max3_u32 v7, v7, v3, v4
    v_accvgpr_read_b32 v3, a16
    v_accvgpr_read_b32 v4, a20
    v_max3_u32 v7, v7, v3, v4
    v_accvgpr_read_b32 v3, a24
    v_accvgpr_read_b32 v4, a28
    v_max3_u32 v7, v7, v3, v4
    v_cmp_eq_u32 vcc, -1, v7
    s_nop 0
    s_cbranch_vccnz L_slowfcB8
L_okfcB8:
    v_mfma_f32_16x16x32_bf16 v[128:131], v[48:51], a[0:3], v[128:131]
    ds_read_b64_tr_b16 v[40:41], v102 offset:49152
    v_mfma_f32_16x16x32_bf16 v[128:131], v[52:55], a[16:19], v[128:131]
    ds_read_b64_tr_b16 v[42:43], v102 offset:51200
    v_mfma_f32_16x16x32_bf16 v[132:135], v[48:51], a[4:7], v[132:135]
    ds_read_b64_tr_b16 v[44:45], v98 offset:0
    v_mfma_f32_16x16x32_bf16 v[132:135], v[52:55], a[20:23], v[132:135]
    ds_read_b64_tr_b16 v[46:47], v98 offset:2048
    v_mfma_f32_16x16x32_bf16 v[136:139], v[48:51], a[8:11], v[136:139]
    v_mfma_f32_16x16x32_bf16 v[136:139], v[52:55], a[24:27], v[136:139]
    v_mfma_f32_16x16x32_bf16 v[140:143], v[48:51], a[12:15], v[140:143]
    v_mfma_f32_16x16x32_bf16 v[140:143], v[52:55], a[28:31], v[140:143]
    s_waitcnt lgkmcnt(4)
    v_mfma_f32_16x16x32_bf16 v[144:147], v[32:35], a[0:3], v[144:147]
    ds_read_b64_tr_b16 v[48:49], v103 offset:49152
    v_mfma_f32_16x16x32_bf16 v[144:147], v[36:39], a[16:19], v[144:147]
    ds_read_b64_tr_b16 v[50:51], v103 offset:51200
    v_mfma_f32_16x16x32_bf16 v[148:151], v[32:35], a[4:7], v[148:151]
    ds_read_b64_tr_b16 v[52:53], v99 offset:0
    v_mfma_f32_16x16x32_bf16 v[148:151], v[36:39], a[20:23], v[148:151]
    ds_read_b64_tr_b16 v[54:55], v99 offset:2048
    v_mfma_f32_16x16x32_bf16 v[152:155], v[32:35], a[8:11], v[152:155]
    ds_write_b128 v224, v[132:135] offset:16384
    v_mfma_f32_16x16x32_bf16 v[152:155], v[36:39], a[24:27], v[152:155]
    ds_write_b128 v224, v[136:139] offset:32768
    v_mfma_f32_16x16x32_bf16 v[156:159], v[32:35], a[12:15], v[156:159]
    ds_write_b128 v224, v[140:143] offset:49152
    v_mfma_f32_16x16x32_bf16 v[156:159], v[36:39], a[28:31], v[156:159]
    s_waitcnt lgkmcnt(7)
    v_mfma_f32_16x16x32_bf16 v[160:163], v[40:43], a[0:3], v[160:163]
    ds_write_b128 v224, v[148:151] offset:17408
    v_mfma_f32_16x16x32_bf16 v[160:163], v[44:47], a[16:19], v[160:163]
    v_mfma_f32_16x16x32_bf16 v[164:167], v[40:43], a[4:7], v[164:167]
    ds_write_b128 v224, v[152:155] offset:33792
    v_mfma_f32_16x16x32_bf16 v[164:167], v[44:47], a[20:23], v[164:167]
    v_mfma_f32_16x16x32_bf16 v[168:171], v[40:43], a[8:11], v[168:171]
    v_mfma_f32_16x16x32_bf16 v[168:171], v[44:47], a[24:27], v[168:171]
    ds_write_b128 v224, v[156:159] offset:50176
    v_mfma_f32_16x16x32_bf16 v[172:175], v[40:43], a[12:15], v[172:175]
    v_mfma_f32_16x16x32_bf16 v[172:175], v[44:47], a[28:31], v[172:175]
    s_waitcnt lgkmcnt(6)
    v_mfma_f32_16x16x32_bf16 v[176:179], v[48:51], a[0:3], v[176:179]
    v_mfma_f32_16x16x32_bf16 v[176:179], v[52:55], a[16:19], v[176:179]
    v_mfma_f32_16x16x32_bf16 v[180:183], v[48:51], a[4:7], v[180:183]
    ds_write_b128 v224, v[164:167] offset:18432
    v_mfma_f32_16x16x32_bf16 v[180:183], v[52:55], a[20:23], v[180:183]
    ds_write_b128 v224, v[168:171] offset:34816
    v_mfma_f32_16x16x32_bf16 v[184:187], v[48:51], a[8:11], v[184:187]
    v_mfma_f32_16x16x32_bf16 v[184:187], v[52:55], a[24:27], v[184:187]
    ds_write_b128 v224, v[172:175] offset:51200
    v_mfma_f32_16x16x32_bf16 v[188:191], v[48:51], a[12:15], v[188:191]
    v_mfma_f32_16x16x32_bf16 v[188:191], v[52:55], a[28:31], v[188:191]
    s_nop 1
    ds_write_b128 v224, v[180:183] offset:19456
    s_nop 1
    ds_write_b128 v224, v[184:187] offset:35840
    s_nop 1
    ds_write_b128 v224, v[188:191] offset:52224
    s_waitcnt lgkmcnt(0)
    s_barrier
    ds_read_b128 v[64:67], v225 offset:16384
    ds_read_b128 v[68:71], v226 offset:32768
    ds_read_b128 v[72:75], v227 offset:49152
    ds_read_b128 v[76:79], v225 offset:17408
    ds_read_b128 v[80:83], v226 offset:33792
    ds_read_b128 v[84:87], v227 offset:50176
    ds_read_b128 v[88:91], v225 offset:18432
    ds_read_b128 v[92:95], v226 offset:34816
    ds_read_b128 v[112:115], v227 offset:51200
    ds_read_b128 v[116:119], v225 offset:19456
    ds_read_b128 v[120:123], v226 offset:35840
    ds_read_b128 v[124:127], v227 offset:52224
    s_waitcnt lgkmcnt(11)
    v_pk_add_f32 v[128:129], v[128:129], v[64:65]
    v_pk_add_f32 v[130:131], v[130:131], v[66:67]
    s_waitcnt lgkmcnt(10)
    v_pk_add_f32 v[128:129], v[128:129], v[68:69]
    v_pk_add_f32 v[130:131], v[130:131], v[70:71]
    s_waitcnt lgkmcnt(9)
    v_pk_add_f32 v[128:129], v[128:129], v[72:73]
    v_pk_add_f32 v[130:131], v[130:131], v[74:75]
    v_cvt_pk_bf16_f32 v192, v128, v129
    v_cvt_pk_bf16_f32 v193, v130, v131
    s_waitcnt lgkmcnt(8)
    v_pk_add_f32 v[144:145], v[144:145], v[76:77]
    v_pk_add_f32 v[146:147], v[146:147], v[78:79]
    s_waitcnt lgkmcnt(7)
    v_pk_add_f32 v[144:145], v[144:145], v[80:81]
    v_pk_add_f32 v[146:147], v[146:147], v[82:83]
    s_waitcnt lgkmcnt(6)
    v_pk_add_f32 v[144:145], v[144:145], v[84:85]
    v_pk_add_f32 v[146:147], v[146:147], v[86:87]
    v_cvt_pk_bf16_f32 v194, v144, v145
    v_cvt_pk_bf16_f32 v195, v146, v147
    s_nop 0
    v_permlane16_swap_b32 v192, v194
    v_permlane16_swap_b32 v193, v195
    buffer_store_dwordx4 v[192:195], v228, s[76:79], s100 offen offset:0
    s_waitcnt lgkmcnt(5)
    v_pk_add_f32 v[160:161], v[160:161], v[88:89]
    v_pk_add_f32 v[162:163], v[162:163], v[90:91]
    s_waitcnt lgkmcnt(4)
    v_pk_add_f32 v[160:161], v[160:161], v[92:93]
    v_pk_add_f32 v[162:163], v[162:163], v[94:95]
    s_waitcnt lgkmcnt(3)
    v_pk_add_f32 v[160:161], v[160:161], v[112:113]
    v_pk_add_f32 v[162:163], v[162:163], v[114:115]
    v_cvt_pk_bf16_f32 v196, v160, v161
    v_cvt_pk_bf16_f32 v197, v162, v163
    s_waitcnt lgkmcnt(2)
    v_pk_add_f32 v[176:177], v[176:177], v[116:117]
    v_pk_add_f32 v[178:179], v[178:179], v[118:119]
    s_waitcnt lgkmcnt(1)
    v_pk_add_f32 v[176:177], v[176:177], v[120:121]
    v_pk_add_f32 v[178:179], v[178:179], v[122:123]
    s_waitcnt lgkmcnt(0)
    v_pk_add_f32 v[176:177], v[176:177], v[124:125]
    v_pk_add_f32 v[178:179], v[178:179], v[126:127]
    v_cvt_pk_bf16_f32 v198, v176, v177
    v_cvt_pk_bf16_f32 v199, v178, v179
    s_nop 0
    v_permlane16_swap_b32 v196, v198
    v_permlane16_swap_b32 v197, v199
    buffer_store_dwordx4 v[196:199], v228, s[76:79], s100 offen offset:64
    s_endpgm

L_slowB0:

    s_mov_b32 s19, 0
L_loopB0:
    buffer_load_dword v21, v23, s[80:83], 0 offen offset:64 sc1
    s_waitcnt vmcnt(0)
    v_cmp_gt_u32 vcc, 1, v21
    s_nop 1
    s_cbranch_vccz L_okB0
    s_add_u32 s19, s19, 1
    s_cmp_lt_u32 s19, 262144
    s_cbranch_scc1 L_loopB0
    s_branch L_okB0
L_slowB1:

    s_mov_b32 s19, 0
L_loopB1:
    buffer_load_dword v21, v18, s[72:75], 0 offen offset:1024 sc1
    s_waitcnt vmcnt(0)
    v_cmp_gt_u32 vcc, 2, v21
    s_nop 1
    s_cbranch_vccz L_okB1
    s_add_u32 s19, s19, 1
    s_cmp_lt_u32 s19, 262144
    s_cbranch_scc1 L_loopB1
    s_branch L_okB1
L_slowB2:

    s_mov_b32 s19, 0
L_loopB2:
    buffer_load_dword v22, v20, s[72:75], 0 offen sc1
    s_waitcnt vmcnt(0)
    v_cmp_gt_u32 vcc, 1, v22
    s_nop 1
    s_cbranch_vccz L_okB2
    s_add_u32 s19, s19, 1
    s_cmp_lt_u32 s19, 262144
    s_cbranch_scc1 L_loopB2
    s_branch L_okB2
L_slowB3:

    s_mov_b32 s19, 0
L_loopB3:
    buffer_load_dword v22, v18, s[72:75], 0 offen sc1
    s_waitcnt vmcnt(0)
    v_cmp_gt_u32 vcc, 2, v22
    s_nop 1
    s_cbranch_vccz L_okB3
    s_add_u32 s19, s19, 1
    s_cmp_lt_u32 s19, 262144
    s_cbranch_scc1 L_loopB3
    s_branch L_okB3
L_slowB4:

    s_mov_b32 s19, 0
L_loopB4:
    buffer_load_dword v21, v18, s[72:75], 0 offen offset:1024 sc1
    s_waitcnt vmcnt(0)
    v_cmp_gt_u32 vcc, 3, v21
    s_nop 1
    s_cbranch_vccz L_okB4
    s_add_u32 s19, s19, 1
    s_cmp_lt_u32 s19, 262144
    s_cbranch_scc1 L_loopB4
    s_branch L_okB4
L_slowkv:

    s_mov_b32 s19, 0
L_loopkv:
    buffer_load_dwordx4 v[112:115], v24, s[72:75], s13 offen offset:0 sc1
    buffer_load_dwordx4 v[116:119], v24, s[72:75], s13 offen offset:16 sc1
    buffer_load_dwordx4 v[120:123], v24, s[72:75], s13 offen offset:1088 sc1
    buffer_load_dwordx4 v[124:127], v24, s[72:75], s13 offen offset:1104 sc1
    s_waitcnt vmcnt(0)
    v_max3_u32 v12, v112, v113, v114
    v_max3_u32 v12, v12, v115, v116
    v_max3_u32 v12, v12, v117, v118
    v_max3_u32 v12, v12, v119, v120
    v_max3_u32 v12, v12, v121, v122
    v_max3_u32 v12, v12, v123, v124
    v_max3_u32 v12, v12, v125, v126
    v_max_u32 v12, v12, v127
    v_cmp_eq_u32 vcc, -1, v12
    s_nop 1
    s_cbranch_vccz L_okkv
    s_add_u32 s19, s19, 1
    s_cmp_lt_u32 s19, 65536
    s_cbranch_scc1 L_loopkv
    s_branch L_okkv
L_slowB5:

    s_mov_b32 s19, 0
L_loopB5:
    buffer_load_dword v22, v18, s[72:75], 0 offen sc1
    s_waitcnt vmcnt(0)
    v_cmp_gt_u32 vcc, 3, v22
    s_nop 1
    s_cbranch_vccz L_okB5
    s_add_u32 s19, s19, 1
    s_cmp_lt_u32 s19, 262144
    s_cbranch_scc1 L_loopB5
    s_branch L_okB5
L_slowB6:

    s_mov_b32 s19, 0
L_loopB6:
    buffer_load_dword v23, v19, s[72:75], 0 offen sc1
    s_waitcnt vmcnt(0)
    v_cmp_gt_u32 vcc, 1, v23
    s_nop 1
    s_cbranch_vccz L_okB6
    s_add_u32 s19, s19, 1
    s_cmp_lt_u32 s19, 262144
    s_cbranch_scc1 L_loopB6
    s_branch L_okB6
L_slowfcB7:

    s_mov_b32 s19, 0
L_loopfcB7:
    s_add_u32 s101, s16, 0
    buffer_load_dwordx4 a[224:227], v108, s[72:75], s101 offen sc1
    buffer_load_dwordx4 a[228:231], v109, s[72:75], s101 offen sc1
    buffer_load_dwordx4 a[232:235], v110, s[72:75], s101 offen sc1
    buffer_load_dwordx4 a[236:239], v111, s[72:75], s101 offen sc1
    s_add_u32 s101, s16, 4096
    buffer_load_dwordx4 a[240:243], v108, s[72:75], s101 offen sc1
    buffer_load_dwordx4 a[244:247], v109, s[72:75], s101 offen sc1
    buffer_load_dwordx4 a[248:251], v110, s[72:75], s101 offen sc1
    buffer_load_dwordx4 a[252:255], v111, s[72:75], s101 offen sc1
    s_waitcnt vmcnt(0)
    v_accvgpr_read_b32 v3, a224
    v_accvgpr_read_b32 v4, a228
    v_max_u32 v7, v3, v4
    v_accvgpr_read_b32 v3, a232
    v_accvgpr_read_b32 v4, a236
    v_max3_u32 v7, v7, v3, v4
    v_accvgpr_read_b32 v3, a240
    v_accvgpr_read_b32 v4, a244
    v_max3_u32 v7, v7, v3, v4
    v_accvgpr_read_b32 v3, a248
    v_accvgpr_read_b32 v4, a252
    v_max3_u32 v7, v7, v3, v4
    v_cmp_eq_u32 vcc, -1, v7
    s_nop 1
    s_cbranch_vccz L_okfcB7
    s_add_u32 s19, s19, 1
    s_cmp_lt_u32 s19, 65536
    s_cbranch_scc1 L_loopfcB7
    s_branch L_okfcB7
L_slowfcB8:

    s_mov_b32 s19, 0
L_loopfcB8:
    s_add_u32 s101, s16, 8192
    buffer_load_dwordx4 a[0:3], v108, s[72:75], s101 offen sc1
    buffer_load_dwordx4 a[4:7], v109, s[72:75], s101 offen sc1
    buffer_load_dwordx4 a[8:11], v110, s[72:75], s101 offen sc1
    buffer_load_dwordx4 a[12:15], v111, s[72:75], s101 offen sc1
    s_add_u32 s101, s16, 12288
    buffer_load_dwordx4 a[16:19], v108, s[72:75], s101 offen sc1
    buffer_load_dwordx4 a[20:23], v109, s[72:75], s101 offen sc1
    buffer_load_dwordx4 a[24:27], v110, s[72:75], s101 offen sc1
    buffer_load_dwordx4 a[28:31], v111, s[72:75], s101 offen sc1
    s_waitcnt vmcnt(0)
    v_accvgpr_read_b32 v3, a0
    v_accvgpr_read_b32 v4, a4
    v_max_u32 v7, v3, v4
    v_accvgpr_read_b32 v3, a8
    v_accvgpr_read_b32 v4, a12
    v_max3_u32 v7, v7, v3, v4
    v_accvgpr_read_b32 v3, a16
    v_accvgpr_read_b32 v4, a20
    v_max3_u32 v7, v7, v3, v4
    v_accvgpr_read_b32 v3, a24
    v_accvgpr_read_b32 v4, a28
    v_max3_u32 v7, v7, v3, v4
    v_cmp_eq_u32 vcc, -1, v7
    s_nop 1
    s_cbranch_vccz L_okfcB8
    s_add_u32 s19, s19, 1
    s_cmp_lt_u32 s19, 65536
    s_cbranch_scc1 L_loopfcB8
    s_branch L_okfcB8

L_endB:
L_exit:
    s_endpgm
.section .rodata,"a"
.p2align 6
.amdhsa_kernel gated_mix__linear_kernel_hedgehog__glu_gated_glu__prompt_kernel
  .amdhsa_next_free_vgpr 512
  .amdhsa_next_free_sgpr 102
  .amdhsa_accum_offset 256
  .amdhsa_group_segment_fixed_size 0
  .amdhsa_kernarg_size 96
  .amdhsa_user_sgpr_count 2
  .amdhsa_user_sgpr_kernarg_segment_ptr 1
  .amdhsa_system_sgpr_workgroup_id_x 1
.end_amdhsa_kernel
```
